```python
import torch

def _softmax(x, axis=-1):
    return torch.softmax(x, dim=axis)
def _gelu(x):
    return torch.nn.functional.gelu(x, approximate="tanh")
def _silu(x):
    return torch.nn.functional.silu(x)
def _sigmoid(x):
    return torch.sigmoid(x)
def _layernorm(x, axis=-1, eps=1e-5):
    m = x.mean(dim=axis, keepdim=True)
    v = x.var(dim=axis, keepdim=True, unbiased=False)
    return (x - m) / torch.sqrt(v + eps)
def _scatter_add(tgt, idx, src, axis=0):
    return tgt.clone().index_add_(axis, idx, src)
def _segment_sum(src, seg, n):
    out = torch.zeros((n,) + src.shape[1:], dtype=src.dtype)
    return out.index_add_(0, seg, src)
def _pad(x, pw):
    flat = tuple(v for pair in reversed(pw) for v in pair)
    return torch.nn.functional.pad(x, flat)

kernel_name = 'gated_mix__ssm_conv_s5__glu_gated_geglu__prompt'

def setup_inputs():

    _w = (lambda a: (lambda t: t.to(torch.bfloat16) if t.is_floating_point() else t)(torch.as_tensor(a)))
    def _A_setup():
        B, S, D = 1, 2048, 1024
        P = D
        Lambda_re = -0.5 * (lambda _x: torch.exp(torch.as_tensor(_x)))((lambda *s: torch.randn(*s, dtype=torch.bfloat16) * 0.4)(P))
        Lambda_im = (lambda *s: torch.randn(*s, dtype=torch.bfloat16) * 0.8)(P) * 1.0
        B_re = (lambda *s: torch.randn(*s, dtype=torch.bfloat16) * 0.4)(P, D) * (D ** -0.5)
        B_im = (lambda *s: torch.randn(*s, dtype=torch.bfloat16) * 0.4)(P, D) * (D ** -0.5)
        C_re = (lambda *s: torch.randn(*s, dtype=torch.bfloat16) * 0.4)(D, P) * (P ** -0.5)
        C_im = (lambda *s: torch.randn(*s, dtype=torch.bfloat16) * 0.4)(D, P) * (P ** -0.5)
        log_dt = (lambda *s: torch.randn(*s, dtype=torch.bfloat16) * 0.4)(P) * 0.3 - 2.0
        Dskip = (lambda *s: torch.randn(*s, dtype=torch.bfloat16) * 0.1)(D)
        return {
            "x": _w((lambda *s: torch.randn(*s, dtype=torch.bfloat16) * 0.05)(B, S, D)),
            "Lambda_re": _w(Lambda_re),
            "Lambda_im": _w(Lambda_im),
            "B_re": _w(B_re),
            "B_im": _w(B_im),
            "C_re": _w(C_re),
            "C_im": _w(C_im),
            "log_dt": _w(log_dt),
            "Dskip": _w(Dskip),
        }
    _A_in = _A_setup()

    def _B_setup():
        B, S, Dm, Df = 1, 2048, 1024, 3584
        return {
            "x": _w((lambda *s: torch.randn(*s, dtype=torch.bfloat16) * 0.05)(B, S, Dm)),
            "w_gate": _w((lambda *s: torch.randn(*s, dtype=torch.bfloat16) * 3.2)(Dm, Df) * (Dm ** -0.5)),
            "w_up": _w((lambda *s: torch.randn(*s, dtype=torch.bfloat16) * 3.2)(Dm, Df) * (Dm ** -0.5)),
            "w_down": _w((lambda *s: torch.randn(*s, dtype=torch.bfloat16) * 3.2)(Df, Dm) * (Df ** -0.5)),
        }
    _B_in = _B_setup()

    return {
        "A_x": _A_in["x"],
        "A_Lambda_re": _A_in["Lambda_re"],
        "A_Lambda_im": _A_in["Lambda_im"],
        "A_B_re": _A_in["B_re"],
        "A_B_im": _A_in["B_im"],
        "A_C_re": _A_in["C_re"],
        "A_C_im": _A_in["C_im"],
        "A_log_dt": _A_in["log_dt"],
        "A_Dskip": _A_in["Dskip"],
        "B_x": _B_in["x"],
        "B_w_gate": _B_in["w_gate"],
        "B_w_up": _B_in["w_up"],
        "B_w_down": _B_in["w_down"],
        "gate_w": _w((lambda *s: torch.randn(*s, dtype=torch.bfloat16) * 0.05)(1024) * 16.0),
    }

def reference(A_x, A_Lambda_re, A_Lambda_im, A_B_re, A_B_im, A_C_re, A_C_im, A_log_dt, A_Dskip, B_x, B_w_gate, B_w_up, B_w_down, gate_w):
    def _A_ref(x, Lambda_re, Lambda_im, B_re, B_im, C_re, C_im, log_dt, Dskip):
        Bsz, L, H = x.shape
        Lam = Lambda_re + 1j * Lambda_im
        Bmat = B_re + 1j * B_im
        Cmat = C_re + 1j * C_im
        dt = torch.exp(log_dt)
        Lam_bar = torch.exp(dt * Lam)
        B_bar = ((Lam_bar - 1.0) / Lam)[:, None] * Bmat
        Bu = torch.einsum("bld,pd->blp", x + 0j, B_bar)
        h = torch.zeros_like(Bu[:, 0, :])
        hs = []
        for t in range(L):
            h = Lam_bar[None, :] * h + Bu[:, t, :]
            hs.append(h)
        hseq = torch.stack(hs, 1)
        y = 2.0 * torch.einsum("blp,dp->bld", hseq, Cmat).real + x * Dskip[None, None, :]
        return y

    def _B_ref(x, w_gate, w_up, w_down):
        g = torch.einsum("bsd,df->bsf", x, w_gate)
        u = torch.einsum("bsd,df->bsf", x, w_up)
        h = _gelu(g) * u
        return torch.einsum("bsf,fd->bsd", h, w_down)

    x = A_x
    g = _sigmoid((x * gate_w).sum(-1, keepdims=True))
    a = _A_ref(x, A_Lambda_re, A_Lambda_im, A_B_re, A_B_im, A_C_re, A_C_im, A_log_dt, A_Dskip)
    b = _B_ref(x, B_w_gate, B_w_up, B_w_down)
    return g * a + (1 - g) * b
```

```asm
; @launch kernel=gated_mix__ssm_conv_s5__glu_gated_geglu__prompt_kernel grid=(256,1,1) block=(256,1,1) lds=163840
.amdgcn_target "amdgcn-amd-amdhsa--gfx950"
.text
.globl gated_mix__ssm_conv_s5__glu_gated_geglu__prompt_kernel
.p2align 8
.type gated_mix__ssm_conv_s5__glu_gated_geglu__prompt_kernel,@function
gated_mix__ssm_conv_s5__glu_gated_geglu__prompt_kernel:
s_cmp_ge_u32 s2, 256
s_cbranch_scc1 KF_end
s_load_dwordx16 s[36:51], s[0:1], 0
s_load_dwordx8 s[52:59], s[0:1], 80
s_load_dwordx4 s[60:63], s[0:1], 120
s_load_dwordx2 s[80:81], s[0:1], 64
s_load_dwordx2 s[96:97], s[0:1], 112
v_lshrrev_b32 v1, 6, v0
v_and_b32 v0, 63, v0
v_readfirstlane_b32 s3, v1
s_and_b32 s98, s2, 3
s_and_b32 s66, s2, 4
s_bfe_u32 s67, s2, 0x20003
s_add_u32 s4, s66, s67
s_lshr_b32 s99, s2, 5
s_lshl_b32 s5, s98, 3
s_add_u32 s5, s5, s99
s_xor_b32 s100, s98, 3
s_lshr_b32 s6, s3, 1
s_and_b32 s7, s3, 1
v_lshrrev_b32 v25, 3, v0
v_and_b32 v26, 7, v0
v_lshrrev_b32 v27, 2, v25
v_lshlrev_b32 v27, 5, v27
v_and_b32 v28, 1, v25
v_lshl_add_u32 v27, v28, 4, v27
v_lshrrev_b32 v28, 1, v25
v_and_b32 v29, 1, v28
v_add_u32 v27, v27, v29
v_xor_b32 v29, v26, v28
v_lshlrev_b32 v29, 4, v29
v_xor_b32 v30, 64, v29
s_lshl_b32 s66, s4, 8
s_lshl_b32 s67, s6, 7
s_add_u32 s66, s66, s67
s_lshl_b32 s67, s7, 3
s_add_u32 s66, s66, s67
v_add_u32 v27, s66, v27
v_lshlrev_b32 v27, 11, v27
v_add_u32 v2, v27, v29
v_add_u32_e64 v31, v27, v30
v_add_u32 v3, 130048, v31
v_add_u32 v4, 2048, v2
v_add_u32 v5, 132096, v31
v_add_u32 v6, 8192, v2
v_add_u32 v7, 138240, v31
v_add_u32 v8, 10240, v2
v_add_u32 v9, 140288, v31
s_lshl_b32 s66, s5, 5
s_lshl_b32 s67, s7, 4
s_add_u32 s66, s66, s67
v_add_u32 v27, s66, v25
v_lshlrev_b32 v27, 11, v27
v_add_u32 v17, v27, v29
v_add_u32_e64 v18, v27, v30
v_add_u32 v18, 15360, v18
s_mul_i32 s67, s5, 224
s_mul_i32 s68, s7, 229376
s_add_u32 s67, s67, s68
s_movk_i32 s68, 7168
v_add_u32_e64 v25, 0, v0
v_mul_u32_u24 v26, 4682, v25
v_lshrrev_b32 v26, 16, v26
v_mul_u32_u24 v27, 14, v26
v_sub_u32 v27, v25, v27
v_and_b32 v28, 19, v26
v_and_b32_e64 v29, 4, v26
v_lshl_or_b32 v28, v29, 1, v28
v_and_b32 v29, 8, v26
v_lshrrev_b32 v29, 1, v29
v_or_b32 v28, v28, v29
s_sub_u32 s69, s67, 0
v_mul_u32_u24_e64 v28, s68, v28
v_lshl_add_u32 v28, v27, 4, v28
v_add_u32 v10, s69, v28
v_add_u32 v25, 64, v0
v_mul_u32_u24 v26, 4682, v25
v_lshrrev_b32 v26, 16, v26
v_mul_u32_u24 v27, 14, v26
v_sub_u32 v27, v25, v27
v_and_b32 v28, 19, v26
v_and_b32_e64 v29, 4, v26
v_lshl_or_b32 v28, v29, 1, v28
v_and_b32 v29, 8, v26
v_lshrrev_b32 v29, 1, v29
v_or_b32_e64 v28, v28, v29
s_sub_u32 s69, s67, 1024
v_mul_u32_u24_e64 v28, s68, v28
v_lshl_add_u32 v28, v27, 4, v28
v_add_u32_e64 v11, s69, v28
v_add_u32 v25, 128, v0
v_mul_u32_u24 v26, 4682, v25
v_lshrrev_b32 v26, 16, v26
v_mul_u32_u24 v27, 14, v26
v_sub_u32 v27, v25, v27
v_and_b32 v28, 19, v26
v_and_b32_e64 v29, 4, v26
v_lshl_or_b32 v28, v29, 1, v28
v_and_b32 v29, 8, v26
v_lshrrev_b32 v29, 1, v29
v_or_b32_e64 v28, v28, v29
s_sub_u32 s69, s67, 2048
v_mul_u32_u24_e64 v28, s68, v28
v_lshl_add_u32 v28, v27, 4, v28
v_add_u32_e64 v12, s69, v28
v_add_u32 v25, 192, v0
v_mul_u32_u24 v26, 4682, v25
v_lshrrev_b32 v26, 16, v26
v_mul_u32_u24 v27, 14, v26
v_sub_u32 v27, v25, v27
v_and_b32 v28, 19, v26
v_and_b32_e64 v29, 4, v26
v_lshl_or_b32 v28, v29, 1, v28
v_and_b32 v29, 8, v26
v_lshrrev_b32 v29, 1, v29
v_or_b32_e64 v28, v28, v29
s_sub_u32 s69, s67, 3072
v_mul_u32_u24_e64 v28, s68, v28
v_lshl_add_u32 v28, v27, 4, v28
v_add_u32_e64 v13, s69, v28
v_add_u32 v25, 256, v0
v_mul_u32_u24 v26, 4682, v25
v_lshrrev_b32 v26, 16, v26
v_mul_u32_u24 v27, 14, v26
v_sub_u32 v27, v25, v27
v_and_b32 v28, 19, v26
v_and_b32_e64 v29, 4, v26
v_lshl_or_b32 v28, v29, 1, v28
v_and_b32 v29, 8, v26
v_lshrrev_b32 v29, 1, v29
v_or_b32 v28, v28, v29
s_sub_u32 s69, s67, 0
v_mul_u32_u24_e64 v28, s68, v28
v_lshl_add_u32 v28, v27, 4, v28
v_add_u32_e64 v14, s69, v28
v_add_u32 v25, 320, v0
v_mul_u32_u24 v26, 4682, v25
v_lshrrev_b32 v26, 16, v26
v_mul_u32_u24 v27, 14, v26
v_sub_u32 v27, v25, v27
v_and_b32 v28, 19, v26
v_and_b32_e64 v29, 4, v26
v_lshl_or_b32 v28, v29, 1, v28
v_and_b32 v29, 8, v26
v_lshrrev_b32 v29, 1, v29
v_or_b32_e64 v28, v28, v29
s_sub_u32 s69, s67, 1024
v_mul_u32_u24_e64 v28, s68, v28
v_lshl_add_u32 v28, v27, 4, v28
v_add_u32_e64 v15, s69, v28
v_add_u32 v25, 384, v0
v_mul_u32_u24 v26, 4682, v25
v_lshrrev_b32 v26, 16, v26
v_mul_u32_u24 v27, 14, v26
v_sub_u32 v27, v25, v27
v_and_b32 v28, 19, v26
v_and_b32_e64 v29, 4, v26
v_lshl_or_b32 v28, v29, 1, v28
v_and_b32 v29, 8, v26
v_lshrrev_b32 v29, 1, v29
v_or_b32_e64 v28, v28, v29
s_sub_u32 s69, s67, 2048
v_mul_u32_u24_e64 v28, s68, v28
v_lshl_add_u32 v28, v27, 4, v28
v_add_u32 v16, s69, v28
s_lshl_b32 s34, s3, 13
s_mul_i32 s35, s6, 14352
s_mul_i32 s67, s7, 7168
s_add_u32 s35, s35, s67
s_add_u32 s35, s35, 65536
s_lshl_b32 s64, s3, 11
s_add_u32 s64, s64, 122912
s_mov_b32 s32, 0
s_mov_b32 s33, 0
s_and_b32 s76, s4, 3
s_lshl_b32 s76, s76, 3
s_add_u32 s76, s76, s99
s_lshl_b32 s76, s76, 2
s_add_u32 s76, s76, s3
s_lshl_b32 s75, s76, 1
s_lshl_b32 s77, s98, 8
s_add_u32 s75, s75, s77
s_lshl_b32 s75, s75, 11
s_lshr_b32 s77, s76, 1
s_mul_i32 s77, s77, 7168
s_mul_i32 s78, s98, 1792
s_add_u32 s77, s77, s78
s_sub_u32 s77, s77, 1536
s_and_b32 s79, s4, 4
s_lshl_b32 s79, s79, 8
s_lshl_b32 s78, s76, 3
s_add_u32 s79, s79, s78
s_lshl_b32 s79, s79, 11
s_and_b32 s76, s76, 1
v_cmp_gt_u32 vcc, 42, v0
v_mov_b32 v28, 128
v_mov_b32 v29, 0
v_cndmask_b32 v24, 0, v0, vcc
v_lshlrev_b32 v30, 11, v24
v_add_u32 v30, s79, v30
v_cmp_le_u32 s[70:71], 8, v24
v_cmp_le_u32 s[72:73], 10, v24
v_cmp_le_u32 vcc, 12, v24
v_and_b32 v31, 1, v24
v_lshlrev_b32 v31, 11, v31
v_add_u32 v31, s75, v31
v_cndmask_b32 v30, v30, v31, s[70:71]
v_lshlrev_b32 v31, 7, v24
v_add_u32 v31, s77, v31
v_cndmask_b32_e64 v30, v30, v31, vcc
v_mov_b32 v31, 458752
v_cndmask_b32 v28, v28, v31, vcc
v_mov_b32 v31, 0
s_waitcnt lgkmcnt(0)
s_mov_b32 s8, s36
s_and_b32 s9, s37, 0xffff
s_mov_b32 s10, 4194304
s_mov_b32 s11, 0x20000
s_cmp_eq_u32 s6, 0
s_cselect_b32 s68, s42, s44
s_cselect_b32 s69, s43, s45
s_mov_b32 s16, s68
s_and_b32 s17, s69, 0xffff
s_mov_b32 s18, 2097152
s_mov_b32 s19, 0x20000
s_cmp_eq_u32 s6, 0
s_cselect_b32 s68, s52, s54
s_cselect_b32 s69, s53, s55
s_mov_b32 s12, s68
s_and_b32 s13, s69, 0xffff
s_mov_b32 s14, 7340032
s_mov_b32 s15, 0x20000
s_add_u32 m0, s64, 0
s_nop 0
buffer_load_dwordx4 v17, s[16:19], s32 offen offset:0 lds
buffer_load_dwordx4 v18, s[16:19], s32 offen offset:1024 lds
s_add_u32 m0, s34, 0
s_nop 0
buffer_load_dwordx4 v2, s[8:11], s32 offen offset:0 lds
buffer_load_dwordx4 v3, s[8:11], s32 offen offset:1024 lds
buffer_load_dwordx4 v4, s[8:11], s32 offen offset:2048 lds
buffer_load_dwordx4 v5, s[8:11], s32 offen offset:3072 lds
s_add_u32 m0, s34, 4096
s_nop 0
buffer_load_dwordx4 v6, s[8:11], s32 offen offset:0 lds
buffer_load_dwordx4 v7, s[8:11], s32 offen offset:1024 lds
buffer_load_dwordx4 v8, s[8:11], s32 offen offset:2048 lds
buffer_load_dwordx4 v9, s[8:11], s32 offen offset:3072 lds
s_add_u32 s32, s32, 128
s_cmp_eq_u32 s76, 0
s_cselect_b32 s78, s52, s54
s_cselect_b32 s79, s53, s55
v_mov_b32 v26, s36
v_mov_b32 v27, s37
v_mov_b32 v1, s42
v_mov_b32 v25, s43
v_cndmask_b32 v26, v26, v1, s[70:71]
v_cndmask_b32 v27, v27, v25, s[70:71]
v_mov_b32 v1, s44
v_mov_b32 v25, s45
v_cndmask_b32 v26, v26, v1, s[72:73]
v_cndmask_b32 v27, v27, v25, s[72:73]
v_mov_b32 v1, s78
v_mov_b32 v25, s79
v_cndmask_b32 v26, v26, v1, vcc
v_cndmask_b32 v27, v27, v25, vcc
v_lshl_add_u64 v[26:27], v[30:31], 0, v[26:27]
v_lshl_add_u64 v[26:27], v[28:29], 0, v[26:27]
s_lshl_b32 s74, s2, 2
s_add_u32 s74, s74, s3
s_mul_i32 s75, s74, 7168
s_sub_u32 s75, s75, 36608
s_lshl_b32 s76, s74, 11
s_sub_u32 s77, s76, 15872
s_sub_u32 s76, s76, 16896
v_cmp_le_u32 vcc, 26, v24
v_mul_u32_u24 v30, 1408, v24
v_add_u32 v30, s75, v30
v_mov_b32 v32, s56
v_mov_b32_e64 v33, s57
v_lshl_add_u64 v[32:33], v[30:31], 0, v[32:33]
v_cndmask_b32 v26, v26, v32, vcc
v_cndmask_b32 v27, v27, v33, vcc
v_mov_b32 v1, 128
v_cndmask_b32 v28, v28, v1, vcc
v_cmp_le_u32 vcc, 31, v24
v_lshlrev_b32 v30, 9, v24
v_add_u32 v30, s77, v30
v_mov_b32 v32, s46
v_mov_b32 v33, s47
v_lshl_add_u64 v[32:33], v[30:31], 0, v[32:33]
v_cndmask_b32 v26, v26, v32, vcc
v_cndmask_b32 v27, v27, v33, vcc
v_cmp_le_u32 vcc, 33, v24
v_lshlrev_b32 v30, 9, v24
v_add_u32 v30, s76, v30
v_mov_b32 v32, s48
v_mov_b32_e64 v33, s49
v_lshl_add_u64 v[32:33], v[30:31], 0, v[32:33]
v_cndmask_b32 v26, v26, v32, vcc
v_cndmask_b32 v27, v27, v33, vcc
v_cmp_le_u32 vcc, 35, v24
v_lshlrev_b32 v30, 9, v24
v_subrev_u32 v30, 17920, v30
v_mov_b32 v32, s58
v_mov_b32 v33, s59
v_lshl_add_u64 v[32:33], v[30:31], 0, v[32:33]
v_cndmask_b32 v26, v26, v32, vcc
v_cndmask_b32 v27, v27, v33, vcc
s_lshl_b32 s75, s5, 6
s_lshl_b32 s76, s4, 20
v_cmp_le_u32 vcc, 37, v24
v_mov_b32 v30, s75
v_mov_b32 v32, s38
v_mov_b32 v33, s39
v_lshl_add_u64 v[32:33], v[30:31], 0, v[32:33]
v_cndmask_b32 v26, v26, v32, vcc
v_cndmask_b32 v27, v27, v33, vcc
v_mov_b32 v1, 0
v_cndmask_b32 v28, v28, v1, vcc
v_cmp_le_u32 vcc, 38, v24
s_nop 0
v_mov_b32 v32, s40
v_mov_b32 v33, s41
v_lshl_add_u64 v[32:33], v[30:31], 0, v[32:33]
v_cndmask_b32 v26, v26, v32, vcc
v_cndmask_b32 v27, v27, v33, vcc
v_cmp_le_u32 vcc, 39, v24
s_nop 0
v_mov_b32 v32, s50
v_mov_b32 v33, s51
v_lshl_add_u64 v[32:33], v[30:31], 0, v[32:33]
v_cndmask_b32 v26, v26, v32, vcc
v_cndmask_b32 v27, v27, v33, vcc
v_cmp_le_u32 vcc, 40, v24
v_mov_b32 v30, s76
v_mov_b32 v32, s96
v_mov_b32 v33, s97
v_lshl_add_u64 v[32:33], v[30:31], 0, v[32:33]
v_cndmask_b32 v26, v26, v32, vcc
v_cndmask_b32 v27, v27, v33, vcc
v_cmp_le_u32 vcc, 41, v24
v_mov_b32 v30, 0
v_mov_b32 v32, s80
v_mov_b32 v33, s81
v_lshl_add_u64 v[32:33], v[30:31], 0, v[32:33]
v_cndmask_b32 v26, v26, v32, vcc
v_cndmask_b32 v27, v27, v33, vcc
v_mov_b32 v1, 128
v_cndmask_b32 v28, v28, v1, vcc
v_cmp_le_u32 vcc, 42, v0
v_readlane_b32 s75, v26, 41
v_readlane_b32 s76, v27, 41
s_nop 1
v_mov_b32 v32, s75
v_mov_b32 v33, s76
v_cndmask_b32 v26, v26, v32, vcc
v_cndmask_b32 v27, v27, v33, vcc
v_and_b32 v34, 15, v0
v_lshrrev_b32 v35, 4, v0
v_lshrrev_b32 v36, 1, v34
v_xor_b32 v36, v36, v35
v_lshlrev_b32 v36, 4, v36
v_lshl_add_u32 v36, v34, 7, v36
s_lshl_b32 s67, s6, 14
v_add_u32 v19, s67, v36
v_xor_b32 v20, 64, v19
s_lshl_b32 s67, s7, 11
s_add_u32 s67, s67, 122912
v_xor_b32 v37, 64, v36
v_add_u32 v23, s67, v36
v_add_u32 v24, s67, v37
v_lshrrev_b32 v36, 5, v0
v_lshlrev_b32 v36, 4, v36
v_and_b32 v37, 1, v35
v_lshl_add_u32 v36, v37, 2, v36
v_bfe_u32 v37, v0, 2, 2
v_add_u32_e64 v36, v36, v37
v_mul_u32_u24 v36, 224, v36
s_mul_i32 s67, s7, 112
s_add_u32 s67, s67, 65536
v_add_u32 v36, s67, v36
v_and_b32 v37, 3, v0
v_lshl_add_u32 v21, v37, 3, v36
v_and_b32_e64 v37, 1, v0
v_lshl_add_u32 v36, v37, 3, v36
v_bfe_u32 v37, v0, 1, 1
v_mul_u32_u24 v37, 14352, v37
v_add_u32 v36, 96, v36
v_add_u32 v22, v36, v37
s_mov_b32 s20, s62
s_and_b32 s21, s63, 0xffff
s_mov_b32 s22, 58720256
s_mov_b32 s23, 0x20000
s_mov_b32 s24, s60
s_and_b32 s25, s61, 0xffff
s_mov_b32 s26, 256
s_mov_b32 s27, 0x20000
s_add_u32 s68, s62, 24133632
s_addc_u32 s69, s63, 0
s_mov_b32 s28, s68
s_and_b32 s29, s69, 0xffff
s_mov_b32 s30, 131072
s_mov_b32 s31, 0x20000
s_lshl_b32 s70, s4, 8
s_lshl_b32 s67, s5, 3
s_add_u32 s70, s70, s67
s_lshl_b32 s67, s3, 1
s_add_u32 s70, s70, s67
s_and_b32 s73, s70, 0xff80
s_bfe_u32 s67, s70, 0x30004
s_lshl_b32 s67, s67, 1
s_add_u32 s73, s73, s67
s_bfe_u32 s67, s70, 0x20002
s_lshl_b32 s67, s67, 5
s_add_u32 s73, s73, s67
s_bfe_u32 s67, s70, 0x10001
s_add_u32 s73, s73, s67
s_lshl_b32 s73, s73, 11
s_add_u32 s72, s73, 32768
s_lshl_b32 s70, s70, 3
s_add_u32 s70, s70, 24117248
s_lshl_b32 s66, s4, 3
s_add_u32 s66, s66, s99
s_lshl_b32 s66, s66, 2
s_add_u32 s66, s66, s98
s_lshl_b32 s66, s66, 2
s_add_u32 s66, s66, s3
s_mul_i32 s101, s66, 12288
s_add_u32 s101, s101, 25165824
v_lshlrev_b32 v25, 4, v0
v_accvgpr_write_b32 a0, 0
v_accvgpr_write_b32 a1, 0
v_accvgpr_write_b32 a2, 0
v_accvgpr_write_b32 a3, 0
v_accvgpr_write_b32 a4, 0
v_accvgpr_write_b32 a5, 0
v_accvgpr_write_b32 a6, 0
v_accvgpr_write_b32 a7, 0
v_accvgpr_write_b32 a8, 0
v_accvgpr_write_b32 a9, 0
v_accvgpr_write_b32 a10, 0
v_accvgpr_write_b32 a11, 0
v_accvgpr_write_b32 a12, 0
v_accvgpr_write_b32 a13, 0
v_accvgpr_write_b32 a14, 0
v_accvgpr_write_b32 a15, 0
v_accvgpr_write_b32 a16, 0
v_accvgpr_write_b32 a17, 0
v_accvgpr_write_b32 a18, 0
v_accvgpr_write_b32 a19, 0
v_accvgpr_write_b32 a20, 0
v_accvgpr_write_b32 a21, 0
v_accvgpr_write_b32 a22, 0
v_accvgpr_write_b32 a23, 0
v_accvgpr_write_b32 a24, 0
v_accvgpr_write_b32 a25, 0
v_accvgpr_write_b32 a26, 0
v_accvgpr_write_b32 a27, 0
v_accvgpr_write_b32 a28, 0
v_accvgpr_write_b32 a29, 0
v_accvgpr_write_b32 a30, 0
v_accvgpr_write_b32 a31, 0
v_accvgpr_write_b32 a32, 0
v_accvgpr_write_b32 a33, 0
v_accvgpr_write_b32 a34, 0
v_accvgpr_write_b32 a35, 0
v_accvgpr_write_b32 a36, 0
v_accvgpr_write_b32 a37, 0
v_accvgpr_write_b32 a38, 0
v_accvgpr_write_b32 a39, 0
v_accvgpr_write_b32 a40, 0
v_accvgpr_write_b32 a41, 0
v_accvgpr_write_b32 a42, 0
v_accvgpr_write_b32 a43, 0
v_accvgpr_write_b32 a44, 0
v_accvgpr_write_b32 a45, 0
v_accvgpr_write_b32 a46, 0
v_accvgpr_write_b32 a47, 0
v_accvgpr_write_b32 a48, 0
v_accvgpr_write_b32 a49, 0
v_accvgpr_write_b32 a50, 0
v_accvgpr_write_b32 a51, 0
v_accvgpr_write_b32 a52, 0
v_accvgpr_write_b32 a53, 0
v_accvgpr_write_b32 a54, 0
v_accvgpr_write_b32 a55, 0
v_accvgpr_write_b32 a56, 0
v_accvgpr_write_b32 a57, 0
v_accvgpr_write_b32 a58, 0
v_accvgpr_write_b32 a59, 0
v_accvgpr_write_b32 a60, 0
v_accvgpr_write_b32 a61, 0
v_accvgpr_write_b32 a62, 0
v_accvgpr_write_b32 a63, 0
v_accvgpr_write_b32 a246, -1
v_accvgpr_write_b32 a247, -1
v_accvgpr_write_b32 a248, -1
v_accvgpr_write_b32 a249, -1
s_mov_b32 s77, 24264704
s_lshl_b32 s78, s2, 2
s_add_u32 s78, s78, s3
s_getpc_b64 s[74:75]
KF_pc0:
s_lshl_b32 s76, s3, 13
v_lshlrev_b32 v1, 7, v0
v_add_u32 v1, s76, v1
s_add_u32 m0, s35, 0
s_nop 0
buffer_load_dwordx4 v10, s[12:15], s33 offen offset:0 lds
buffer_load_dwordx4 v11, s[12:15], s33 offen offset:1024 lds
buffer_load_dwordx4 v12, s[12:15], s33 offen offset:2048 lds
buffer_load_dwordx4 v13, s[12:15], s33 offen offset:3072 lds
s_add_u32 m0, s35, 4096
s_nop 0
s_nop 0
buffer_load_dwordx4 v14, s[12:15], s33 offen offset:0 lds
buffer_load_dwordx4 v15, s[12:15], s33 offen offset:1024 lds
buffer_load_dwordx4 v16, s[12:15], s33 offen offset:2048 lds
s_add_u32 s33, s33, 458752
s_mov_b64 exec, 0x3ffffff
global_load_dword a254, v[26:27], off
v_lshl_add_u64 v[26:27], v[28:29], 0, v[26:27]
s_mov_b64 exec, -1
s_mov_b64 exec, 0x3ffffff
global_load_dword a254, v[26:27], off
v_lshl_add_u64 v[26:27], v[28:29], 0, v[26:27]
s_mov_b64 exec, -1
buffer_load_dword a250, off, s[20:23], s77 sc1
global_load_dword a255, v1, s[74:75]
s_add_u32 s74, s74, 0x8000
s_addc_u32 s75, s75, 0
v_min_u32 v1, KF_end-KF_pc0-0x8000, v1
s_waitcnt vmcnt(11)
s_barrier
s_nop 0
ds_read_b128 a[192:195], v23 offset:0
ds_read_b128 a[196:199], v24 offset:0
ds_read_b128 a[64:67], v19 offset:0
ds_read_b128 a[96:99], v20 offset:0
ds_read_b128 a[68:71], v19 offset:2048
ds_read_b128 a[100:103], v20 offset:2048
ds_read_b128 a[72:75], v19 offset:4096
ds_read_b128 a[104:107], v20 offset:4096
ds_read_b128 a[76:79], v19 offset:6144
ds_read_b128 a[108:111], v20 offset:6144
ds_read_b128 a[200:203], v23 offset:4096
ds_read_b128 a[204:207], v24 offset:4096
ds_read_b128 a[80:83], v19 offset:8192
ds_read_b128 a[112:115], v20 offset:8192
ds_read_b128 a[84:87], v19 offset:10240
s_waitcnt lgkmcnt(14)
ds_read_b128 a[116:119], v20 offset:10240
s_waitcnt lgkmcnt(14)
ds_read_b128 a[88:91], v19 offset:12288
s_waitcnt lgkmcnt(14)
ds_read_b128 a[120:123], v20 offset:12288
s_waitcnt lgkmcnt(14)
ds_read_b128 a[92:95], v19 offset:14336
s_waitcnt lgkmcnt(14)
ds_read_b128 a[124:127], v20 offset:14336
v_mfma_f32_16x16x32_bf16 v[32:35], a[64:67], a[192:195], 0
s_add_u32 m0, s35, 28688
v_mfma_f32_16x16x32_bf16 v[32:35], a[96:99], a[196:199], v[32:35]
buffer_load_dwordx4 v10, s[12:15], s33 offen offset:0 lds
v_mfma_f32_16x16x32_bf16 v[36:39], a[68:71], a[192:195], 0
s_waitcnt lgkmcnt(14)
v_mfma_f32_16x16x32_bf16 v[36:39], a[100:103], a[196:199], v[36:39]
s_waitcnt lgkmcnt(13)
v_mfma_f32_16x16x32_bf16 v[40:43], a[72:75], a[192:195], 0
s_waitcnt lgkmcnt(12)
v_mfma_f32_16x16x32_bf16 v[40:43], a[104:107], a[196:199], v[40:43]
s_waitcnt lgkmcnt(11)
v_mfma_f32_16x16x32_bf16 v[44:47], a[76:79], a[192:195], 0
s_waitcnt lgkmcnt(10)
v_mfma_f32_16x16x32_bf16 v[44:47], a[108:111], a[196:199], v[44:47]
s_waitcnt lgkmcnt(0)
v_mfma_f32_16x16x32_bf16 v[48:51], a[80:83], a[192:195], 0
buffer_load_dwordx4 v11, s[12:15], s33 offen offset:1024 lds
v_mfma_f32_16x16x32_bf16 v[48:51], a[112:115], a[196:199], v[48:51]
v_mfma_f32_16x16x32_bf16 v[52:55], a[84:87], a[192:195], 0
v_mfma_f32_16x16x32_bf16 v[52:55], a[116:119], a[196:199], v[52:55]
v_mfma_f32_16x16x32_bf16 v[56:59], a[88:91], a[192:195], 0
buffer_load_dwordx4 v12, s[12:15], s33 offen offset:2048 lds
v_mfma_f32_16x16x32_bf16 v[56:59], a[120:123], a[196:199], v[56:59]
v_mfma_f32_16x16x32_bf16 v[60:63], a[92:95], a[192:195], 0
v_mfma_f32_16x16x32_bf16 v[60:63], a[124:127], a[196:199], v[60:63]
s_waitcnt vmcnt(7)
s_barrier
v_mfma_f32_16x16x32_bf16 v[64:67], a[64:67], a[200:203], 0
buffer_load_dwordx4 v13, s[12:15], s33 offen offset:3072 lds
v_mfma_f32_16x16x32_bf16 v[64:67], a[96:99], a[204:207], v[64:67]
ds_read_b64_tr_b16 a[208:209], v21 offset:0
v_mfma_f32_16x16x32_bf16 v[68:71], a[68:71], a[200:203], 0
ds_read_b64_tr_b16 a[210:211], v21 offset:1792
v_mfma_f32_16x16x32_bf16 v[68:71], a[100:103], a[204:207], v[68:71]
s_add_u32 m0, s34, 32768
v_mfma_f32_16x16x32_bf16 v[72:75], a[72:75], a[200:203], 0
ds_read_b64_tr_b16 a[212:213], v21 offset:7168
v_mfma_f32_16x16x32_bf16 v[72:75], a[104:107], a[204:207], v[72:75]
ds_read_b64_tr_b16 a[214:215], v21 offset:8960
v_mfma_f32_16x16x32_bf16 v[76:79], a[76:79], a[200:203], 0
buffer_load_dwordx4 v2, s[8:11], s32 offen offset:0 lds
v_mfma_f32_16x16x32_bf16 v[76:79], a[108:111], a[204:207], v[76:79]
ds_read_b64_tr_b16 a[192:193], v21 offset:14352
v_mfma_f32_16x16x32_bf16 v[80:83], a[80:83], a[200:203], 0
ds_read_b64_tr_b16 a[194:195], v21 offset:16144
v_mfma_f32_16x16x32_bf16 v[80:83], a[112:115], a[204:207], v[80:83]
ds_read_b64_tr_b16 a[196:197], v21 offset:21520
v_mfma_f32_16x16x32_bf16 v[84:87], a[84:87], a[200:203], 0
buffer_load_dwordx4 v3, s[8:11], s32 offen offset:1024 lds
v_mfma_f32_16x16x32_bf16 v[84:87], a[116:119], a[204:207], v[84:87]
ds_read_b64_tr_b16 a[198:199], v21 offset:23312
v_mfma_f32_16x16x32_bf16 v[88:91], a[88:91], a[200:203], 0
v_mfma_f32_16x16x32_bf16 v[88:91], a[120:123], a[204:207], v[88:91]
v_mfma_f32_16x16x32_bf16 v[92:95], a[92:95], a[200:203], 0
buffer_load_dwordx4 v4, s[8:11], s32 offen offset:2048 lds
v_mfma_f32_16x16x32_bf16 v[92:95], a[124:127], a[204:207], v[92:95]
s_waitcnt lgkmcnt(3)
v_mfma_f32_16x16x32_bf16 v[96:99], a[208:211], a[64:67], 0
ds_read_b64_tr_b16 a[200:201], v21 offset:32
v_mfma_f32_16x16x32_bf16 v[96:99], a[212:215], a[96:99], v[96:99]
ds_read_b64_tr_b16 a[202:203], v21 offset:1824
v_mfma_f32_16x16x32_bf16 v[100:103], a[208:211], a[68:71], 0
buffer_load_dwordx4 v5, s[8:11], s32 offen offset:3072 lds
v_mfma_f32_16x16x32_bf16 v[100:103], a[212:215], a[100:103], v[100:103]
ds_read_b64_tr_b16 a[204:205], v21 offset:7200
v_mfma_f32_16x16x32_bf16 v[104:107], a[208:211], a[72:75], 0
ds_read_b64_tr_b16 a[206:207], v21 offset:8992
v_mfma_f32_16x16x32_bf16 v[104:107], a[212:215], a[104:107], v[104:107]
s_add_u32 m0, s64, 8192
v_mfma_f32_16x16x32_bf16 v[108:111], a[208:211], a[76:79], 0
buffer_load_dwordx4 v17, s[16:19], s32 offen offset:0 lds
v_mfma_f32_16x16x32_bf16 v[108:111], a[212:215], a[108:111], v[108:111]
v_mfma_f32_16x16x32_bf16 v[112:115], a[208:211], a[80:83], 0
v_mfma_f32_16x16x32_bf16 v[112:115], a[212:215], a[112:115], v[112:115]
v_mfma_f32_16x16x32_bf16 v[116:119], a[208:211], a[84:87], 0
buffer_load_dwordx4 v18, s[16:19], s32 offen offset:1024 lds
v_mfma_f32_16x16x32_bf16 v[116:119], a[212:215], a[116:119], v[116:119]
v_mfma_f32_16x16x32_bf16 v[120:123], a[208:211], a[88:91], 0
v_mfma_f32_16x16x32_bf16 v[120:123], a[212:215], a[120:123], v[120:123]
v_mfma_f32_16x16x32_bf16 v[124:127], a[208:211], a[92:95], 0
s_add_u32 m0, s35, 32784
v_mfma_f32_16x16x32_bf16 v[124:127], a[212:215], a[124:127], v[124:127]
s_waitcnt lgkmcnt(0)
v_mfma_f32_16x16x32_bf16 v[128:131], a[192:195], a[64:67], 0
v_mfma_f32_16x16x32_bf16 v[128:131], a[196:199], a[96:99], v[128:131]
buffer_load_dwordx4 v14, s[12:15], s33 offen offset:0 lds
v_mfma_f32_16x16x32_bf16 v[132:135], a[192:195], a[68:71], 0
ds_read_b64_tr_b16 a[208:209], v21 offset:14384
v_mfma_f32_16x16x32_bf16 v[132:135], a[196:199], a[100:103], v[132:135]
ds_read_b64_tr_b16 a[210:211], v21 offset:16176
v_mfma_f32_16x16x32_bf16 v[136:139], a[192:195], a[72:75], 0
ds_read_b64_tr_b16 a[212:213], v21 offset:21552
v_mfma_f32_16x16x32_bf16 v[136:139], a[196:199], a[104:107], v[136:139]
buffer_load_dwordx4 v15, s[12:15], s33 offen offset:1024 lds
v_mfma_f32_16x16x32_bf16 v[140:143], a[192:195], a[76:79], 0
ds_read_b64_tr_b16 a[214:215], v21 offset:23344
v_mfma_f32_16x16x32_bf16 v[140:143], a[196:199], a[108:111], v[140:143]
s_mov_b64 exec, 0x3ffffff
global_load_dword a254, v[26:27], off
v_lshl_add_u64 v[26:27], v[28:29], 0, v[26:27]
s_mov_b64 exec, -1
v_mfma_f32_16x16x32_bf16 v[144:147], a[192:195], a[80:83], 0
v_mfma_f32_16x16x32_bf16 v[144:147], a[196:199], a[112:115], v[144:147]
v_mfma_f32_16x16x32_bf16 v[148:151], a[192:195], a[84:87], 0
v_mfma_f32_16x16x32_bf16 v[148:151], a[196:199], a[116:119], v[148:151]
buffer_load_dwordx4 v16, s[12:15], s33 offen offset:2048 lds
v_mfma_f32_16x16x32_bf16 v[152:155], a[192:195], a[88:91], 0
s_add_u32 s33, s33, 458752
v_mfma_f32_16x16x32_bf16 v[152:155], a[196:199], a[120:123], v[152:155]
v_mfma_f32_16x16x32_bf16 v[156:159], a[192:195], a[92:95], 0
v_mfma_f32_16x16x32_bf16 v[156:159], a[196:199], a[124:127], v[156:159]
s_add_u32 m0, s34, 36864
v_mfma_f32_16x16x32_bf16 v[160:163], a[200:203], a[64:67], 0
buffer_load_dwordx4 v6, s[8:11], s32 offen offset:0 lds
v_mfma_f32_16x16x32_bf16 v[160:163], a[204:207], a[96:99], v[160:163]
ds_read_b64_tr_b16 a[192:193], v21 offset:64
v_mfma_f32_16x16x32_bf16 v[164:167], a[200:203], a[68:71], 0
ds_read_b64_tr_b16 a[194:195], v21 offset:1856
v_mfma_f32_16x16x32_bf16 v[164:167], a[204:207], a[100:103], v[164:167]
ds_read_b64_tr_b16 a[196:197], v21 offset:7232
v_mfma_f32_16x16x32_bf16 v[168:171], a[200:203], a[72:75], 0
buffer_load_dwordx4 v7, s[8:11], s32 offen offset:1024 lds
v_mfma_f32_16x16x32_bf16 v[168:171], a[204:207], a[104:107], v[168:171]
ds_read_b64_tr_b16 a[198:199], v21 offset:9024
v_mfma_f32_16x16x32_bf16 v[172:175], a[200:203], a[76:79], 0
v_mfma_f32_16x16x32_bf16 v[172:175], a[204:207], a[108:111], v[172:175]
v_mfma_f32_16x16x32_bf16 v[176:179], a[200:203], a[80:83], 0
buffer_load_dwordx4 v8, s[8:11], s32 offen offset:2048 lds
v_mfma_f32_16x16x32_bf16 v[176:179], a[204:207], a[112:115], v[176:179]
v_mfma_f32_16x16x32_bf16 v[180:183], a[200:203], a[84:87], 0
v_mfma_f32_16x16x32_bf16 v[180:183], a[204:207], a[116:119], v[180:183]
v_mfma_f32_16x16x32_bf16 v[184:187], a[200:203], a[88:91], 0
buffer_load_dwordx4 v9, s[8:11], s32 offen offset:3072 lds
v_mfma_f32_16x16x32_bf16 v[184:187], a[204:207], a[120:123], v[184:187]
s_add_u32 s32, s32, 128
v_mfma_f32_16x16x32_bf16 v[188:191], a[200:203], a[92:95], 0
v_mfma_f32_16x16x32_bf16 v[188:191], a[204:207], a[124:127], v[188:191]
s_waitcnt lgkmcnt(0)
v_mfma_f32_16x16x32_bf16 v[192:195], a[208:211], a[64:67], 0
global_load_dword a255, v1, s[74:75]
v_mfma_f32_16x16x32_bf16 v[192:195], a[212:215], a[96:99], v[192:195]
ds_read_b64_tr_b16 a[200:201], v21 offset:14416
v_mfma_f32_16x16x32_bf16 v[196:199], a[208:211], a[68:71], 0
ds_read_b64_tr_b16 a[202:203], v21 offset:16208
v_mfma_f32_16x16x32_bf16 v[196:199], a[212:215], a[100:103], v[196:199]
buffer_load_dword a255, off, s[20:23], s101 sc1
v_mfma_f32_16x16x32_bf16 v[200:203], a[208:211], a[72:75], 0
ds_read_b64_tr_b16 a[204:205], v21 offset:21584
v_mfma_f32_16x16x32_bf16 v[200:203], a[212:215], a[104:107], v[200:203]
ds_read_b64_tr_b16 a[206:207], v21 offset:23376
v_mfma_f32_16x16x32_bf16 v[204:207], a[208:211], a[76:79], 0
v_mfma_f32_16x16x32_bf16 v[204:207], a[212:215], a[108:111], v[204:207]
v_mfma_f32_16x16x32_bf16 v[208:211], a[208:211], a[80:83], 0
v_mfma_f32_16x16x32_bf16 v[208:211], a[212:215], a[112:115], v[208:211]
v_mfma_f32_16x16x32_bf16 v[212:215], a[208:211], a[84:87], 0
v_mfma_f32_16x16x32_bf16 v[212:215], a[212:215], a[116:119], v[212:215]
v_mfma_f32_16x16x32_bf16 v[216:219], a[208:211], a[88:91], 0
v_mfma_f32_16x16x32_bf16 v[216:219], a[212:215], a[120:123], v[216:219]
v_mfma_f32_16x16x32_bf16 v[220:223], a[208:211], a[92:95], 0
v_mfma_f32_16x16x32_bf16 v[220:223], a[212:215], a[124:127], v[220:223]
v_mfma_f32_16x16x32_bf16 v[224:227], a[192:195], a[64:67], 0
ds_read_b64_tr_b16 a[208:209], v22 offset:0
v_mfma_f32_16x16x32_bf16 v[224:227], a[196:199], a[96:99], v[224:227]
ds_read_b64_tr_b16 a[210:211], v22 offset:1792
v_mfma_f32_16x16x32_bf16 v[228:231], a[192:195], a[68:71], 0
ds_read_b64_tr_b16 a[212:213], v22 offset:7168
v_mfma_f32_16x16x32_bf16 v[228:231], a[196:199], a[100:103], v[228:231]
ds_read_b64_tr_b16 a[214:215], v22 offset:8960
v_mfma_f32_16x16x32_bf16 v[232:235], a[192:195], a[72:75], 0
v_mfma_f32_16x16x32_bf16 v[232:235], a[196:199], a[104:107], v[232:235]
v_mfma_f32_16x16x32_bf16 v[236:239], a[192:195], a[76:79], 0
v_mfma_f32_16x16x32_bf16 v[236:239], a[196:199], a[108:111], v[236:239]
v_mfma_f32_16x16x32_bf16 v[240:243], a[192:195], a[80:83], 0
v_mfma_f32_16x16x32_bf16 v[240:243], a[196:199], a[112:115], v[240:243]
v_mfma_f32_16x16x32_bf16 v[244:247], a[192:195], a[84:87], 0
v_mfma_f32_16x16x32_bf16 v[244:247], a[196:199], a[116:119], v[244:247]
v_mfma_f32_16x16x32_bf16 v[248:251], a[192:195], a[88:91], 0
v_mfma_f32_16x16x32_bf16 v[248:251], a[196:199], a[120:123], v[248:251]
v_mfma_f32_16x16x32_bf16 v[252:255], a[192:195], a[92:95], 0
v_mfma_f32_16x16x32_bf16 v[252:255], a[196:199], a[124:127], v[252:255]
s_mov_b32 s65, 6
KF_loop:
s_waitcnt lgkmcnt(0) vmcnt(2)
s_barrier
v_mfma_f32_16x16x32_bf16 a[0:3], a[200:203], a[64:67], a[0:3]
s_add_u32 m0, s35, 0
v_mfma_f32_16x16x32_bf16 a[0:3], a[204:207], a[96:99], a[0:3]
buffer_load_dwordx4 v10, s[12:15], s33 offen offset:0 lds
v_mfma_f32_16x16x32_bf16 a[4:7], a[200:203], a[68:71], a[4:7]
ds_read_b128 a[128:131], v19 offset:32768
v_mfma_f32_16x16x32_bf16 a[4:7], a[204:207], a[100:103], a[4:7]
ds_read_b128 a[192:195], v23 offset:8192
v_mfma_f32_16x16x32_bf16 a[8:11], a[200:203], a[72:75], a[8:11]
ds_read_b128 a[196:199], v24 offset:8192
v_mfma_f32_16x16x32_bf16 a[8:11], a[204:207], a[104:107], a[8:11]
ds_read_b128 a[160:163], v20 offset:32768
v_mfma_f32_16x16x32_bf16 a[12:15], a[200:203], a[76:79], a[12:15]
ds_read_b128 a[132:135], v19 offset:34816
v_mfma_f32_16x16x32_bf16 a[12:15], a[204:207], a[108:111], a[12:15]
buffer_load_dwordx4 v11, s[12:15], s33 offen offset:1024 lds
v_mfma_f32_16x16x32_bf16 a[16:19], a[200:203], a[80:83], a[16:19]
ds_read_b128 a[164:167], v20 offset:34816
v_mfma_f32_16x16x32_bf16 a[16:19], a[204:207], a[112:115], a[16:19]
ds_read_b128 a[136:139], v19 offset:36864
v_mfma_f32_16x16x32_bf16 a[20:23], a[200:203], a[84:87], a[20:23]
ds_read_b128 a[168:171], v20 offset:36864
v_mfma_f32_16x16x32_bf16 a[20:23], a[204:207], a[116:119], a[20:23]
ds_read_b128 a[140:143], v19 offset:38912
v_mfma_f32_16x16x32_bf16 a[24:27], a[200:203], a[88:91], a[24:27]
ds_read_b128 a[172:175], v20 offset:38912
v_mfma_f32_16x16x32_bf16 a[24:27], a[204:207], a[120:123], a[24:27]
buffer_load_dwordx4 v12, s[12:15], s33 offen offset:2048 lds
v_mfma_f32_16x16x32_bf16 a[28:31], a[200:203], a[92:95], a[28:31]
ds_read_b128 a[144:147], v19 offset:40960
v_mfma_f32_16x16x32_bf16 a[28:31], a[204:207], a[124:127], a[28:31]
ds_read_b128 a[176:179], v20 offset:40960
v_mfma_f32_16x16x32_bf16 a[32:35], a[208:211], a[64:67], a[32:35]
ds_read_b128 a[148:151], v19 offset:43008
v_mfma_f32_16x16x32_bf16 a[32:35], a[212:215], a[96:99], a[32:35]
ds_read_b128 a[180:183], v20 offset:43008
v_mfma_f32_16x16x32_bf16 a[36:39], a[208:211], a[68:71], a[36:39]
ds_read_b128 a[152:155], v19 offset:45056
v_mfma_f32_16x16x32_bf16 a[36:39], a[212:215], a[100:103], a[36:39]
buffer_load_dwordx4 v13, s[12:15], s33 offen offset:3072 lds
v_mfma_f32_16x16x32_bf16 a[40:43], a[208:211], a[72:75], a[40:43]
v_mfma_f32_16x16x32_bf16 a[40:43], a[212:215], a[104:107], a[40:43]
v_mfma_f32_16x16x32_bf16 a[44:47], a[208:211], a[76:79], a[44:47]
v_mfma_f32_16x16x32_bf16 a[44:47], a[212:215], a[108:111], a[44:47]
v_mfma_f32_16x16x32_bf16 a[48:51], a[208:211], a[80:83], a[48:51]
v_mfma_f32_16x16x32_bf16 a[48:51], a[212:215], a[112:115], a[48:51]
s_waitcnt lgkmcnt(1)
ds_read_b128 a[184:187], v20 offset:45056
v_mfma_f32_16x16x32_bf16 a[52:55], a[208:211], a[84:87], a[52:55]
s_add_u32 m0, s34, 0
v_mfma_f32_16x16x32_bf16 a[52:55], a[212:215], a[116:119], a[52:55]
ds_read_b128 a[156:159], v19 offset:47104
v_mfma_f32_16x16x32_bf16 a[56:59], a[208:211], a[88:91], a[56:59]
buffer_load_dwordx4 v2, s[8:11], s32 offen offset:0 lds
v_mfma_f32_16x16x32_bf16 a[56:59], a[212:215], a[120:123], a[56:59]
ds_read_b128 a[188:191], v20 offset:47104
v_mfma_f32_16x16x32_bf16 a[60:63], a[208:211], a[92:95], a[60:63]
ds_read_b128 a[200:203], v23 offset:12288
v_mfma_f32_16x16x32_bf16 a[60:63], a[212:215], a[124:127], a[60:63]
ds_read_b128 a[204:207], v24 offset:12288
v_mfma_f32_16x16x32_bf16 v[32:35], a[128:131], a[192:195], v[32:35]
buffer_load_dwordx4 v3, s[8:11], s32 offen offset:1024 lds
v_mfma_f32_16x16x32_bf16 v[32:35], a[160:163], a[196:199], v[32:35]
ds_read_b64_tr_b16 a[208:209], v21 offset:28688
v_mfma_f32_16x16x32_bf16 v[36:39], a[132:135], a[192:195], v[36:39]
ds_read_b64_tr_b16 a[210:211], v21 offset:30480
v_mfma_f32_16x16x32_bf16 v[36:39], a[164:167], a[196:199], v[36:39]
ds_read_b64_tr_b16 a[212:213], v21 offset:35856
v_mfma_f32_16x16x32_bf16 v[40:43], a[136:139], a[192:195], v[40:43]
buffer_load_dwordx4 v4, s[8:11], s32 offen offset:2048 lds
v_mfma_f32_16x16x32_bf16 v[40:43], a[168:171], a[196:199], v[40:43]
ds_read_b64_tr_b16 a[214:215], v21 offset:37648
v_mfma_f32_16x16x32_bf16 v[44:47], a[140:143], a[192:195], v[44:47]
v_mfma_f32_16x16x32_bf16 v[44:47], a[172:175], a[196:199], v[44:47]
v_mfma_f32_16x16x32_bf16 v[48:51], a[144:147], a[192:195], v[48:51]
v_mfma_f32_16x16x32_bf16 v[48:51], a[176:179], a[196:199], v[48:51]
v_mfma_f32_16x16x32_bf16 v[52:55], a[148:151], a[192:195], v[52:55]
v_mfma_f32_16x16x32_bf16 v[52:55], a[180:183], a[196:199], v[52:55]
buffer_load_dwordx4 v5, s[8:11], s32 offen offset:3072 lds
s_waitcnt lgkmcnt(1)
v_mfma_f32_16x16x32_bf16 v[56:59], a[152:155], a[192:195], v[56:59]
v_mfma_f32_16x16x32_bf16 v[56:59], a[184:187], a[196:199], v[56:59]
v_mfma_f32_16x16x32_bf16 v[60:63], a[156:159], a[192:195], v[60:63]
s_add_u32 m0, s64, 0
v_mfma_f32_16x16x32_bf16 v[60:63], a[188:191], a[196:199], v[60:63]
buffer_load_dwordx4 v17, s[16:19], s32 offen offset:0 lds
v_mfma_f32_16x16x32_bf16 v[64:67], a[128:131], a[200:203], v[64:67]
ds_read_b64_tr_b16 a[192:193], v21 offset:43040
v_mfma_f32_16x16x32_bf16 v[64:67], a[160:163], a[204:207], v[64:67]
ds_read_b64_tr_b16 a[194:195], v21 offset:44832
v_mfma_f32_16x16x32_bf16 v[68:71], a[132:135], a[200:203], v[68:71]
ds_read_b64_tr_b16 a[196:197], v21 offset:50208
v_mfma_f32_16x16x32_bf16 v[68:71], a[164:167], a[204:207], v[68:71]
buffer_load_dwordx4 v18, s[16:19], s32 offen offset:1024 lds
v_mfma_f32_16x16x32_bf16 v[72:75], a[136:139], a[200:203], v[72:75]
ds_read_b64_tr_b16 a[198:199], v21 offset:52000
v_mfma_f32_16x16x32_bf16 v[72:75], a[168:171], a[204:207], v[72:75]
v_mfma_f32_16x16x32_bf16 v[76:79], a[140:143], a[200:203], v[76:79]
v_mfma_f32_16x16x32_bf16 v[76:79], a[172:175], a[204:207], v[76:79]
v_mfma_f32_16x16x32_bf16 v[80:83], a[144:147], a[200:203], v[80:83]
s_add_u32 m0, s35, 4096
v_mfma_f32_16x16x32_bf16 v[80:83], a[176:179], a[204:207], v[80:83]
buffer_load_dwordx4 v14, s[12:15], s33 offen offset:0 lds
v_mfma_f32_16x16x32_bf16 v[84:87], a[148:151], a[200:203], v[84:87]
v_mfma_f32_16x16x32_bf16 v[84:87], a[180:183], a[204:207], v[84:87]
v_mfma_f32_16x16x32_bf16 v[88:91], a[152:155], a[200:203], v[88:91]
v_mfma_f32_16x16x32_bf16 v[88:91], a[184:187], a[204:207], v[88:91]
v_mfma_f32_16x16x32_bf16 v[92:95], a[156:159], a[200:203], v[92:95]
v_mfma_f32_16x16x32_bf16 v[92:95], a[188:191], a[204:207], v[92:95]
v_mfma_f32_16x16x32_bf16 v[96:99], a[208:211], a[128:131], v[96:99]
s_waitcnt lgkmcnt(0)
v_mfma_f32_16x16x32_bf16 v[96:99], a[212:215], a[160:163], v[96:99]
buffer_load_dwordx4 v15, s[12:15], s33 offen offset:1024 lds
v_mfma_f32_16x16x32_bf16 v[100:103], a[208:211], a[132:135], v[100:103]
ds_read_b64_tr_b16 a[200:201], v21 offset:28720
v_mfma_f32_16x16x32_bf16 v[100:103], a[212:215], a[164:167], v[100:103]
ds_read_b64_tr_b16 a[202:203], v21 offset:30512
v_mfma_f32_16x16x32_bf16 v[104:107], a[208:211], a[136:139], v[104:107]
ds_read_b64_tr_b16 a[204:205], v21 offset:35888
v_mfma_f32_16x16x32_bf16 v[104:107], a[212:215], a[168:171], v[104:107]
ds_read_b64_tr_b16 a[206:207], v21 offset:37680
v_mfma_f32_16x16x32_bf16 v[108:111], a[208:211], a[140:143], v[108:111]
v_mfma_f32_16x16x32_bf16 v[108:111], a[212:215], a[172:175], v[108:111]
buffer_load_dwordx4 v16, s[12:15], s33 offen offset:2048 lds
v_mfma_f32_16x16x32_bf16 v[112:115], a[208:211], a[144:147], v[112:115]
s_add_u32 s33, s33, 458752
v_mfma_f32_16x16x32_bf16 v[112:115], a[212:215], a[176:179], v[112:115]
v_mfma_f32_16x16x32_bf16 v[116:119], a[208:211], a[148:151], v[116:119]
v_mfma_f32_16x16x32_bf16 v[116:119], a[212:215], a[180:183], v[116:119]
s_add_u32 m0, s34, 4096
v_mfma_f32_16x16x32_bf16 v[120:123], a[208:211], a[152:155], v[120:123]
buffer_load_dwordx4 v6, s[8:11], s32 offen offset:0 lds
v_mfma_f32_16x16x32_bf16 v[120:123], a[212:215], a[184:187], v[120:123]
v_mfma_f32_16x16x32_bf16 v[124:127], a[208:211], a[156:159], v[124:127]
v_mfma_f32_16x16x32_bf16 v[124:127], a[212:215], a[188:191], v[124:127]
v_mfma_f32_16x16x32_bf16 v[128:131], a[192:195], a[128:131], v[128:131]
buffer_load_dwordx4 v7, s[8:11], s32 offen offset:1024 lds
v_mfma_f32_16x16x32_bf16 v[128:131], a[196:199], a[160:163], v[128:131]
ds_read_b64_tr_b16 a[208:209], v21 offset:43072
v_mfma_f32_16x16x32_bf16 v[132:135], a[192:195], a[132:135], v[132:135]
ds_read_b64_tr_b16 a[210:211], v21 offset:44864
v_mfma_f32_16x16x32_bf16 v[132:135], a[196:199], a[164:167], v[132:135]
ds_read_b64_tr_b16 a[212:213], v21 offset:50240
v_mfma_f32_16x16x32_bf16 v[136:139], a[192:195], a[136:139], v[136:139]
buffer_load_dwordx4 v8, s[8:11], s32 offen offset:2048 lds
v_mfma_f32_16x16x32_bf16 v[136:139], a[196:199], a[168:171], v[136:139]
ds_read_b64_tr_b16 a[214:215], v21 offset:52032
v_mfma_f32_16x16x32_bf16 v[140:143], a[192:195], a[140:143], v[140:143]
v_mfma_f32_16x16x32_bf16 v[140:143], a[196:199], a[172:175], v[140:143]
v_mfma_f32_16x16x32_bf16 v[144:147], a[192:195], a[144:147], v[144:147]
buffer_load_dwordx4 v9, s[8:11], s32 offen offset:3072 lds
v_mfma_f32_16x16x32_bf16 v[144:147], a[196:199], a[176:179], v[144:147]
s_add_u32 s32, s32, 128
v_mfma_f32_16x16x32_bf16 v[148:151], a[192:195], a[148:151], v[148:151]
v_mfma_f32_16x16x32_bf16 v[148:151], a[196:199], a[180:183], v[148:151]
v_mfma_f32_16x16x32_bf16 v[152:155], a[192:195], a[152:155], v[152:155]
v_mfma_f32_16x16x32_bf16 v[152:155], a[196:199], a[184:187], v[152:155]
global_load_dword a254, v[26:27], off
v_mfma_f32_16x16x32_bf16 v[156:159], a[192:195], a[156:159], v[156:159]
v_lshl_add_u64 v[26:27], v[28:29], 0, v[26:27]
v_mfma_f32_16x16x32_bf16 v[156:159], a[196:199], a[188:191], v[156:159]
s_waitcnt lgkmcnt(0)
v_mfma_f32_16x16x32_bf16 v[160:163], a[200:203], a[128:131], v[160:163]
ds_read_b64_tr_b16 a[192:193], v21 offset:28752
v_mfma_f32_16x16x32_bf16 v[160:163], a[204:207], a[160:163], v[160:163]
buffer_store_dwordx4 a[246:249], v25, s[20:23], s101 offen sc1
v_mfma_f32_16x16x32_bf16 v[164:167], a[200:203], a[132:135], v[164:167]
s_add_u32 s101, s101, 1024
v_mfma_f32_16x16x32_bf16 v[164:167], a[204:207], a[164:167], v[164:167]
ds_read_b64_tr_b16 a[194:195], v21 offset:30544
v_mfma_f32_16x16x32_bf16 v[168:171], a[200:203], a[136:139], v[168:171]
ds_read_b64_tr_b16 a[196:197], v21 offset:35920
v_mfma_f32_16x16x32_bf16 v[168:171], a[204:207], a[168:171], v[168:171]
ds_read_b64_tr_b16 a[198:199], v21 offset:37712
v_mfma_f32_16x16x32_bf16 v[172:175], a[200:203], a[140:143], v[172:175]
v_mfma_f32_16x16x32_bf16 v[172:175], a[204:207], a[172:175], v[172:175]
v_mfma_f32_16x16x32_bf16 v[176:179], a[200:203], a[144:147], v[176:179]
v_mfma_f32_16x16x32_bf16 v[176:179], a[204:207], a[176:179], v[176:179]
v_mfma_f32_16x16x32_bf16 v[180:183], a[200:203], a[148:151], v[180:183]
v_mfma_f32_16x16x32_bf16 v[180:183], a[204:207], a[180:183], v[180:183]
v_mfma_f32_16x16x32_bf16 v[184:187], a[200:203], a[152:155], v[184:187]
v_mfma_f32_16x16x32_bf16 v[184:187], a[204:207], a[184:187], v[184:187]
v_mfma_f32_16x16x32_bf16 v[188:191], a[200:203], a[156:159], v[188:191]
v_mfma_f32_16x16x32_bf16 v[188:191], a[204:207], a[188:191], v[188:191]
v_mfma_f32_16x16x32_bf16 v[192:195], a[208:211], a[128:131], v[192:195]
ds_read_b64_tr_b16 a[200:201], v21 offset:43104
v_mfma_f32_16x16x32_bf16 v[192:195], a[212:215], a[160:163], v[192:195]
ds_read_b64_tr_b16 a[202:203], v21 offset:44896
v_mfma_f32_16x16x32_bf16 v[196:199], a[208:211], a[132:135], v[196:199]
ds_read_b64_tr_b16 a[204:205], v21 offset:50272
v_mfma_f32_16x16x32_bf16 v[196:199], a[212:215], a[164:167], v[196:199]
ds_read_b64_tr_b16 a[206:207], v21 offset:52064
v_mfma_f32_16x16x32_bf16 v[200:203], a[208:211], a[136:139], v[200:203]
v_mfma_f32_16x16x32_bf16 v[200:203], a[212:215], a[168:171], v[200:203]
v_mfma_f32_16x16x32_bf16 v[204:207], a[208:211], a[140:143], v[204:207]
v_mfma_f32_16x16x32_bf16 v[204:207], a[212:215], a[172:175], v[204:207]
v_mfma_f32_16x16x32_bf16 v[208:211], a[208:211], a[144:147], v[208:211]
v_mfma_f32_16x16x32_bf16 v[208:211], a[212:215], a[176:179], v[208:211]
v_mfma_f32_16x16x32_bf16 v[212:215], a[208:211], a[148:151], v[212:215]
v_mfma_f32_16x16x32_bf16 v[212:215], a[212:215], a[180:183], v[212:215]
v_mfma_f32_16x16x32_bf16 v[216:219], a[208:211], a[152:155], v[216:219]
v_mfma_f32_16x16x32_bf16 v[216:219], a[212:215], a[184:187], v[216:219]
v_mfma_f32_16x16x32_bf16 v[220:223], a[208:211], a[156:159], v[220:223]
v_mfma_f32_16x16x32_bf16 v[220:223], a[212:215], a[188:191], v[220:223]
s_waitcnt lgkmcnt(0)
v_mfma_f32_16x16x32_bf16 v[224:227], a[192:195], a[128:131], v[224:227]
ds_read_b64_tr_b16 a[208:209], v22 offset:28688
v_mfma_f32_16x16x32_bf16 v[224:227], a[196:199], a[160:163], v[224:227]
ds_read_b64_tr_b16 a[210:211], v22 offset:30480
v_mfma_f32_16x16x32_bf16 v[228:231], a[192:195], a[132:135], v[228:231]
ds_read_b64_tr_b16 a[212:213], v22 offset:35856
v_mfma_f32_16x16x32_bf16 v[228:231], a[196:199], a[164:167], v[228:231]
ds_read_b64_tr_b16 a[214:215], v22 offset:37648
v_mfma_f32_16x16x32_bf16 v[232:235], a[192:195], a[136:139], v[232:235]
v_mfma_f32_16x16x32_bf16 v[232:235], a[196:199], a[168:171], v[232:235]
v_mfma_f32_16x16x32_bf16 v[236:239], a[192:195], a[140:143], v[236:239]
v_mfma_f32_16x16x32_bf16 v[236:239], a[196:199], a[172:175], v[236:239]
v_mfma_f32_16x16x32_bf16 v[240:243], a[192:195], a[144:147], v[240:243]
v_mfma_f32_16x16x32_bf16 v[240:243], a[196:199], a[176:179], v[240:243]
v_mfma_f32_16x16x32_bf16 v[244:247], a[192:195], a[148:151], v[244:247]
v_mfma_f32_16x16x32_bf16 v[244:247], a[196:199], a[180:183], v[244:247]
v_mfma_f32_16x16x32_bf16 v[248:251], a[192:195], a[152:155], v[248:251]
v_mfma_f32_16x16x32_bf16 v[248:251], a[196:199], a[184:187], v[248:251]
v_mfma_f32_16x16x32_bf16 v[252:255], a[192:195], a[156:159], v[252:255]
v_mfma_f32_16x16x32_bf16 v[252:255], a[196:199], a[188:191], v[252:255]
s_waitcnt lgkmcnt(0) vmcnt(2)
s_barrier
v_mfma_f32_16x16x32_bf16 a[0:3], a[200:203], a[128:131], a[0:3]
s_cmp_eq_u32 s78, 0
s_cbranch_scc1 KF_tag
KF_notag:
v_mfma_f32_16x16x32_bf16 a[0:3], a[204:207], a[160:163], a[0:3]
ds_read_b128 a[64:67], v19 offset:0
v_mfma_f32_16x16x32_bf16 a[4:7], a[200:203], a[132:135], a[4:7]
ds_read_b128 a[192:195], v23 offset:0
v_mfma_f32_16x16x32_bf16 a[4:7], a[204:207], a[164:167], a[4:7]
ds_read_b128 a[196:199], v24 offset:0
v_mfma_f32_16x16x32_bf16 a[8:11], a[200:203], a[136:139], a[8:11]
ds_read_b128 a[96:99], v20 offset:0
v_mfma_f32_16x16x32_bf16 a[8:11], a[204:207], a[168:171], a[8:11]
s_add_u32 m0, s35, 28688
v_mfma_f32_16x16x32_bf16 a[12:15], a[200:203], a[140:143], a[12:15]
buffer_load_dwordx4 v10, s[12:15], s33 offen offset:0 lds
v_mfma_f32_16x16x32_bf16 a[12:15], a[204:207], a[172:175], a[12:15]
ds_read_b128 a[68:71], v19 offset:2048
v_mfma_f32_16x16x32_bf16 a[16:19], a[200:203], a[144:147], a[16:19]
ds_read_b128 a[100:103], v20 offset:2048
v_mfma_f32_16x16x32_bf16 a[16:19], a[204:207], a[176:179], a[16:19]
ds_read_b128 a[72:75], v19 offset:4096
v_mfma_f32_16x16x32_bf16 a[20:23], a[200:203], a[148:151], a[20:23]
ds_read_b128 a[104:107], v20 offset:4096
v_mfma_f32_16x16x32_bf16 a[20:23], a[204:207], a[180:183], a[20:23]
ds_read_b128 a[76:79], v19 offset:6144
v_mfma_f32_16x16x32_bf16 a[24:27], a[200:203], a[152:155], a[24:27]
buffer_load_dwordx4 v11, s[12:15], s33 offen offset:1024 lds
v_mfma_f32_16x16x32_bf16 a[24:27], a[204:207], a[184:187], a[24:27]
ds_read_b128 a[108:111], v20 offset:6144
v_mfma_f32_16x16x32_bf16 a[28:31], a[200:203], a[156:159], a[28:31]
ds_read_b128 a[80:83], v19 offset:8192
v_mfma_f32_16x16x32_bf16 a[28:31], a[204:207], a[188:191], a[28:31]
ds_read_b128 a[112:115], v20 offset:8192
v_mfma_f32_16x16x32_bf16 a[32:35], a[208:211], a[128:131], a[32:35]
ds_read_b128 a[84:87], v19 offset:10240
v_mfma_f32_16x16x32_bf16 a[32:35], a[212:215], a[160:163], a[32:35]
ds_read_b128 a[116:119], v20 offset:10240
v_mfma_f32_16x16x32_bf16 a[36:39], a[208:211], a[132:135], a[36:39]
buffer_load_dwordx4 v12, s[12:15], s33 offen offset:2048 lds
v_mfma_f32_16x16x32_bf16 a[36:39], a[212:215], a[164:167], a[36:39]
ds_read_b128 a[88:91], v19 offset:12288
v_mfma_f32_16x16x32_bf16 a[40:43], a[208:211], a[136:139], a[40:43]
v_mfma_f32_16x16x32_bf16 a[40:43], a[212:215], a[168:171], a[40:43]
v_mfma_f32_16x16x32_bf16 a[44:47], a[208:211], a[140:143], a[44:47]
v_mfma_f32_16x16x32_bf16 a[44:47], a[212:215], a[172:175], a[44:47]
v_mfma_f32_16x16x32_bf16 a[48:51], a[208:211], a[144:147], a[48:51]
buffer_load_dwordx4 v13, s[12:15], s33 offen offset:3072 lds
v_mfma_f32_16x16x32_bf16 a[48:51], a[212:215], a[176:179], a[48:51]
v_mfma_f32_16x16x32_bf16 a[52:55], a[208:211], a[148:151], a[52:55]
s_waitcnt lgkmcnt(1)
ds_read_b128 a[120:123], v20 offset:12288
v_mfma_f32_16x16x32_bf16 a[52:55], a[212:215], a[180:183], a[52:55]
s_add_u32 m0, s34, 32768
v_mfma_f32_16x16x32_bf16 a[56:59], a[208:211], a[152:155], a[56:59]
buffer_load_dwordx4 v2, s[8:11], s32 offen offset:0 lds
v_mfma_f32_16x16x32_bf16 a[56:59], a[212:215], a[184:187], a[56:59]
ds_read_b128 a[92:95], v19 offset:14336
v_mfma_f32_16x16x32_bf16 a[60:63], a[208:211], a[156:159], a[60:63]
ds_read_b128 a[124:127], v20 offset:14336
v_mfma_f32_16x16x32_bf16 a[60:63], a[212:215], a[188:191], a[60:63]
ds_read_b128 a[200:203], v23 offset:4096
v_mfma_f32_16x16x32_bf16 v[32:35], a[64:67], a[192:195], v[32:35]
ds_read_b128 a[204:207], v24 offset:4096
v_mfma_f32_16x16x32_bf16 v[32:35], a[96:99], a[196:199], v[32:35]
buffer_load_dwordx4 v3, s[8:11], s32 offen offset:1024 lds
v_mfma_f32_16x16x32_bf16 v[36:39], a[68:71], a[192:195], v[36:39]
ds_read_b64_tr_b16 a[208:209], v21 offset:0
v_mfma_f32_16x16x32_bf16 v[36:39], a[100:103], a[196:199], v[36:39]
ds_read_b64_tr_b16 a[210:211], v21 offset:1792
v_mfma_f32_16x16x32_bf16 v[40:43], a[72:75], a[192:195], v[40:43]
ds_read_b64_tr_b16 a[212:213], v21 offset:7168
v_mfma_f32_16x16x32_bf16 v[40:43], a[104:107], a[196:199], v[40:43]
buffer_load_dwordx4 v4, s[8:11], s32 offen offset:2048 lds
v_mfma_f32_16x16x32_bf16 v[44:47], a[76:79], a[192:195], v[44:47]
v_mfma_f32_16x16x32_bf16 v[44:47], a[108:111], a[196:199], v[44:47]
v_mfma_f32_16x16x32_bf16 v[48:51], a[80:83], a[192:195], v[48:51]
v_mfma_f32_16x16x32_bf16 v[48:51], a[112:115], a[196:199], v[48:51]
v_mfma_f32_16x16x32_bf16 v[52:55], a[84:87], a[192:195], v[52:55]
buffer_load_dwordx4 v5, s[8:11], s32 offen offset:3072 lds
v_mfma_f32_16x16x32_bf16 v[52:55], a[116:119], a[196:199], v[52:55]
s_waitcnt lgkmcnt(1)
v_mfma_f32_16x16x32_bf16 v[56:59], a[88:91], a[192:195], v[56:59]
ds_read_b64_tr_b16 a[214:215], v21 offset:8960
v_mfma_f32_16x16x32_bf16 v[56:59], a[120:123], a[196:199], v[56:59]
s_add_u32 m0, s64, 8192
v_mfma_f32_16x16x32_bf16 v[60:63], a[92:95], a[192:195], v[60:63]
buffer_load_dwordx4 v17, s[16:19], s32 offen offset:0 lds
v_mfma_f32_16x16x32_bf16 v[60:63], a[124:127], a[196:199], v[60:63]
v_mfma_f32_16x16x32_bf16 v[64:67], a[64:67], a[200:203], v[64:67]
ds_read_b64_tr_b16 a[192:193], v21 offset:14352
v_mfma_f32_16x16x32_bf16 v[64:67], a[96:99], a[204:207], v[64:67]
ds_read_b64_tr_b16 a[194:195], v21 offset:16144
v_mfma_f32_16x16x32_bf16 v[68:71], a[68:71], a[200:203], v[68:71]
buffer_load_dwordx4 v18, s[16:19], s32 offen offset:1024 lds
v_mfma_f32_16x16x32_bf16 v[68:71], a[100:103], a[204:207], v[68:71]
ds_read_b64_tr_b16 a[196:197], v21 offset:21520
v_mfma_f32_16x16x32_bf16 v[72:75], a[72:75], a[200:203], v[72:75]
ds_read_b64_tr_b16 a[198:199], v21 offset:23312
v_mfma_f32_16x16x32_bf16 v[72:75], a[104:107], a[204:207], v[72:75]
v_mfma_f32_16x16x32_bf16 v[76:79], a[76:79], a[200:203], v[76:79]
v_mfma_f32_16x16x32_bf16 v[76:79], a[108:111], a[204:207], v[76:79]
s_add_u32 m0, s35, 32784
v_mfma_f32_16x16x32_bf16 v[80:83], a[80:83], a[200:203], v[80:83]
buffer_load_dwordx4 v14, s[12:15], s33 offen offset:0 lds
v_mfma_f32_16x16x32_bf16 v[80:83], a[112:115], a[204:207], v[80:83]
v_mfma_f32_16x16x32_bf16 v[84:87], a[84:87], a[200:203], v[84:87]
v_mfma_f32_16x16x32_bf16 v[84:87], a[116:119], a[204:207], v[84:87]
v_mfma_f32_16x16x32_bf16 v[88:91], a[88:91], a[200:203], v[88:91]
v_mfma_f32_16x16x32_bf16 v[88:91], a[120:123], a[204:207], v[88:91]
v_mfma_f32_16x16x32_bf16 v[92:95], a[92:95], a[200:203], v[92:95]
buffer_load_dwordx4 v15, s[12:15], s33 offen offset:1024 lds
v_mfma_f32_16x16x32_bf16 v[92:95], a[124:127], a[204:207], v[92:95]
v_mfma_f32_16x16x32_bf16 v[96:99], a[208:211], a[64:67], v[96:99]
s_waitcnt lgkmcnt(0)
v_mfma_f32_16x16x32_bf16 v[96:99], a[212:215], a[96:99], v[96:99]
ds_read_b64_tr_b16 a[200:201], v21 offset:32
v_mfma_f32_16x16x32_bf16 v[100:103], a[208:211], a[68:71], v[100:103]
ds_read_b64_tr_b16 a[202:203], v21 offset:1824
v_mfma_f32_16x16x32_bf16 v[100:103], a[212:215], a[100:103], v[100:103]
ds_read_b64_tr_b16 a[204:205], v21 offset:7200
v_mfma_f32_16x16x32_bf16 v[104:107], a[208:211], a[72:75], v[104:107]
buffer_load_dwordx4 v16, s[12:15], s33 offen offset:2048 lds
v_mfma_f32_16x16x32_bf16 v[104:107], a[212:215], a[104:107], v[104:107]
s_add_u32 s33, s33, 458752
v_mfma_f32_16x16x32_bf16 v[108:111], a[208:211], a[76:79], v[108:111]
ds_read_b64_tr_b16 a[206:207], v21 offset:8992
v_mfma_f32_16x16x32_bf16 v[108:111], a[212:215], a[108:111], v[108:111]
v_mfma_f32_16x16x32_bf16 v[112:115], a[208:211], a[80:83], v[112:115]
s_add_u32 m0, s34, 36864
v_mfma_f32_16x16x32_bf16 v[112:115], a[212:215], a[112:115], v[112:115]
buffer_load_dwordx4 v6, s[8:11], s32 offen offset:0 lds
v_mfma_f32_16x16x32_bf16 v[116:119], a[208:211], a[84:87], v[116:119]
v_mfma_f32_16x16x32_bf16 v[116:119], a[212:215], a[116:119], v[116:119]
v_mfma_f32_16x16x32_bf16 v[120:123], a[208:211], a[88:91], v[120:123]
v_mfma_f32_16x16x32_bf16 v[120:123], a[212:215], a[120:123], v[120:123]
buffer_load_dwordx4 v7, s[8:11], s32 offen offset:1024 lds
v_mfma_f32_16x16x32_bf16 v[124:127], a[208:211], a[92:95], v[124:127]
v_mfma_f32_16x16x32_bf16 v[124:127], a[212:215], a[124:127], v[124:127]
v_mfma_f32_16x16x32_bf16 v[128:131], a[192:195], a[64:67], v[128:131]
ds_read_b64_tr_b16 a[208:209], v21 offset:14384
v_mfma_f32_16x16x32_bf16 v[128:131], a[196:199], a[96:99], v[128:131]
buffer_load_dwordx4 v8, s[8:11], s32 offen offset:2048 lds
v_mfma_f32_16x16x32_bf16 v[132:135], a[192:195], a[68:71], v[132:135]
ds_read_b64_tr_b16 a[210:211], v21 offset:16176
v_mfma_f32_16x16x32_bf16 v[132:135], a[196:199], a[100:103], v[132:135]
ds_read_b64_tr_b16 a[212:213], v21 offset:21552
v_mfma_f32_16x16x32_bf16 v[136:139], a[192:195], a[72:75], v[136:139]
ds_read_b64_tr_b16 a[214:215], v21 offset:23344
v_mfma_f32_16x16x32_bf16 v[136:139], a[196:199], a[104:107], v[136:139]
buffer_load_dwordx4 v9, s[8:11], s32 offen offset:3072 lds
v_mfma_f32_16x16x32_bf16 v[140:143], a[192:195], a[76:79], v[140:143]
s_add_u32 s32, s32, 128
v_mfma_f32_16x16x32_bf16 v[140:143], a[196:199], a[108:111], v[140:143]
v_mfma_f32_16x16x32_bf16 v[144:147], a[192:195], a[80:83], v[144:147]
v_mfma_f32_16x16x32_bf16 v[144:147], a[196:199], a[112:115], v[144:147]
v_mfma_f32_16x16x32_bf16 v[148:151], a[192:195], a[84:87], v[148:151]
global_load_dword a254, v[26:27], off
v_mfma_f32_16x16x32_bf16 v[148:151], a[196:199], a[116:119], v[148:151]
v_lshl_add_u64 v[26:27], v[28:29], 0, v[26:27]
v_mfma_f32_16x16x32_bf16 v[152:155], a[192:195], a[88:91], v[152:155]
v_mfma_f32_16x16x32_bf16 v[152:155], a[196:199], a[120:123], v[152:155]
v_mfma_f32_16x16x32_bf16 v[156:159], a[192:195], a[92:95], v[156:159]
buffer_store_dwordx4 a[246:249], v25, s[20:23], s101 offen sc1
v_mfma_f32_16x16x32_bf16 v[156:159], a[196:199], a[124:127], v[156:159]
s_waitcnt lgkmcnt(0)
v_mfma_f32_16x16x32_bf16 v[160:163], a[200:203], a[64:67], v[160:163]
s_add_u32 s101, s101, 1024
v_mfma_f32_16x16x32_bf16 v[160:163], a[204:207], a[96:99], v[160:163]
s_sub_u32 s65, s65, 1
v_mfma_f32_16x16x32_bf16 v[164:167], a[200:203], a[68:71], v[164:167]
s_cmp_lg_u32 s65, 0
v_mfma_f32_16x16x32_bf16 v[164:167], a[204:207], a[100:103], v[164:167]
ds_read_b64_tr_b16 a[192:193], v21 offset:64
v_mfma_f32_16x16x32_bf16 v[168:171], a[200:203], a[72:75], v[168:171]
ds_read_b64_tr_b16 a[194:195], v21 offset:1856
v_mfma_f32_16x16x32_bf16 v[168:171], a[204:207], a[104:107], v[168:171]
ds_read_b64_tr_b16 a[196:197], v21 offset:7232
v_mfma_f32_16x16x32_bf16 v[172:175], a[200:203], a[76:79], v[172:175]
ds_read_b64_tr_b16 a[198:199], v21 offset:9024
v_mfma_f32_16x16x32_bf16 v[172:175], a[204:207], a[108:111], v[172:175]
v_mfma_f32_16x16x32_bf16 v[176:179], a[200:203], a[80:83], v[176:179]
v_mfma_f32_16x16x32_bf16 v[176:179], a[204:207], a[112:115], v[176:179]
v_mfma_f32_16x16x32_bf16 v[180:183], a[200:203], a[84:87], v[180:183]
v_mfma_f32_16x16x32_bf16 v[180:183], a[204:207], a[116:119], v[180:183]
v_mfma_f32_16x16x32_bf16 v[184:187], a[200:203], a[88:91], v[184:187]
v_mfma_f32_16x16x32_bf16 v[184:187], a[204:207], a[120:123], v[184:187]
v_mfma_f32_16x16x32_bf16 v[188:191], a[200:203], a[92:95], v[188:191]
v_mfma_f32_16x16x32_bf16 v[188:191], a[204:207], a[124:127], v[188:191]
v_mfma_f32_16x16x32_bf16 v[192:195], a[208:211], a[64:67], v[192:195]
ds_read_b64_tr_b16 a[200:201], v21 offset:14416
v_mfma_f32_16x16x32_bf16 v[192:195], a[212:215], a[96:99], v[192:195]
ds_read_b64_tr_b16 a[202:203], v21 offset:16208
v_mfma_f32_16x16x32_bf16 v[196:199], a[208:211], a[68:71], v[196:199]
ds_read_b64_tr_b16 a[204:205], v21 offset:21584
v_mfma_f32_16x16x32_bf16 v[196:199], a[212:215], a[100:103], v[196:199]
ds_read_b64_tr_b16 a[206:207], v21 offset:23376
v_mfma_f32_16x16x32_bf16 v[200:203], a[208:211], a[72:75], v[200:203]
v_mfma_f32_16x16x32_bf16 v[200:203], a[212:215], a[104:107], v[200:203]
v_mfma_f32_16x16x32_bf16 v[204:207], a[208:211], a[76:79], v[204:207]
v_mfma_f32_16x16x32_bf16 v[204:207], a[212:215], a[108:111], v[204:207]
v_mfma_f32_16x16x32_bf16 v[208:211], a[208:211], a[80:83], v[208:211]
v_mfma_f32_16x16x32_bf16 v[208:211], a[212:215], a[112:115], v[208:211]
v_mfma_f32_16x16x32_bf16 v[212:215], a[208:211], a[84:87], v[212:215]
v_mfma_f32_16x16x32_bf16 v[212:215], a[212:215], a[116:119], v[212:215]
v_mfma_f32_16x16x32_bf16 v[216:219], a[208:211], a[88:91], v[216:219]
v_mfma_f32_16x16x32_bf16 v[216:219], a[212:215], a[120:123], v[216:219]
v_mfma_f32_16x16x32_bf16 v[220:223], a[208:211], a[92:95], v[220:223]
v_mfma_f32_16x16x32_bf16 v[220:223], a[212:215], a[124:127], v[220:223]
s_waitcnt lgkmcnt(0)
v_mfma_f32_16x16x32_bf16 v[224:227], a[192:195], a[64:67], v[224:227]
ds_read_b64_tr_b16 a[208:209], v22 offset:0
v_mfma_f32_16x16x32_bf16 v[224:227], a[196:199], a[96:99], v[224:227]
ds_read_b64_tr_b16 a[210:211], v22 offset:1792
v_mfma_f32_16x16x32_bf16 v[228:231], a[192:195], a[68:71], v[228:231]
ds_read_b64_tr_b16 a[212:213], v22 offset:7168
v_mfma_f32_16x16x32_bf16 v[228:231], a[196:199], a[100:103], v[228:231]
ds_read_b64_tr_b16 a[214:215], v22 offset:8960
v_mfma_f32_16x16x32_bf16 v[232:235], a[192:195], a[72:75], v[232:235]
v_mfma_f32_16x16x32_bf16 v[232:235], a[196:199], a[104:107], v[232:235]
v_mfma_f32_16x16x32_bf16 v[236:239], a[192:195], a[76:79], v[236:239]
v_mfma_f32_16x16x32_bf16 v[236:239], a[196:199], a[108:111], v[236:239]
v_mfma_f32_16x16x32_bf16 v[240:243], a[192:195], a[80:83], v[240:243]
v_mfma_f32_16x16x32_bf16 v[240:243], a[196:199], a[112:115], v[240:243]
v_mfma_f32_16x16x32_bf16 v[244:247], a[192:195], a[84:87], v[244:247]
v_mfma_f32_16x16x32_bf16 v[244:247], a[196:199], a[116:119], v[244:247]
v_mfma_f32_16x16x32_bf16 v[248:251], a[192:195], a[88:91], v[248:251]
v_mfma_f32_16x16x32_bf16 v[248:251], a[196:199], a[120:123], v[248:251]
v_mfma_f32_16x16x32_bf16 v[252:255], a[192:195], a[92:95], v[252:255]
v_mfma_f32_16x16x32_bf16 v[252:255], a[196:199], a[124:127], v[252:255]
s_cbranch_scc1 KF_loop
s_waitcnt lgkmcnt(0) vmcnt(2)
s_barrier
v_mfma_f32_16x16x32_bf16 a[0:3], a[200:203], a[64:67], a[0:3]
s_add_u32 m0, s35, 0
v_mfma_f32_16x16x32_bf16 a[0:3], a[204:207], a[96:99], a[0:3]
buffer_load_dwordx4 v10, s[12:15], s33 offen offset:0 lds
v_mfma_f32_16x16x32_bf16 a[4:7], a[200:203], a[68:71], a[4:7]
ds_read_b128 a[128:131], v19 offset:32768
v_mfma_f32_16x16x32_bf16 a[4:7], a[204:207], a[100:103], a[4:7]
ds_read_b128 a[192:195], v23 offset:8192
v_mfma_f32_16x16x32_bf16 a[8:11], a[200:203], a[72:75], a[8:11]
ds_read_b128 a[196:199], v24 offset:8192
v_mfma_f32_16x16x32_bf16 a[8:11], a[204:207], a[104:107], a[8:11]
ds_read_b128 a[160:163], v20 offset:32768
v_mfma_f32_16x16x32_bf16 a[12:15], a[200:203], a[76:79], a[12:15]
ds_read_b128 a[132:135], v19 offset:34816
v_mfma_f32_16x16x32_bf16 a[12:15], a[204:207], a[108:111], a[12:15]
buffer_load_dwordx4 v11, s[12:15], s33 offen offset:1024 lds
v_mfma_f32_16x16x32_bf16 a[16:19], a[200:203], a[80:83], a[16:19]
ds_read_b128 a[164:167], v20 offset:34816
v_mfma_f32_16x16x32_bf16 a[16:19], a[204:207], a[112:115], a[16:19]
ds_read_b128 a[136:139], v19 offset:36864
v_mfma_f32_16x16x32_bf16 a[20:23], a[200:203], a[84:87], a[20:23]
ds_read_b128 a[168:171], v20 offset:36864
v_mfma_f32_16x16x32_bf16 a[20:23], a[204:207], a[116:119], a[20:23]
ds_read_b128 a[140:143], v19 offset:38912
v_mfma_f32_16x16x32_bf16 a[24:27], a[200:203], a[88:91], a[24:27]
ds_read_b128 a[172:175], v20 offset:38912
v_mfma_f32_16x16x32_bf16 a[24:27], a[204:207], a[120:123], a[24:27]
buffer_load_dwordx4 v12, s[12:15], s33 offen offset:2048 lds
v_mfma_f32_16x16x32_bf16 a[28:31], a[200:203], a[92:95], a[28:31]
ds_read_b128 a[144:147], v19 offset:40960
v_mfma_f32_16x16x32_bf16 a[28:31], a[204:207], a[124:127], a[28:31]
ds_read_b128 a[176:179], v20 offset:40960
v_mfma_f32_16x16x32_bf16 a[32:35], a[208:211], a[64:67], a[32:35]
ds_read_b128 a[148:151], v19 offset:43008
v_mfma_f32_16x16x32_bf16 a[32:35], a[212:215], a[96:99], a[32:35]
ds_read_b128 a[180:183], v20 offset:43008
v_mfma_f32_16x16x32_bf16 a[36:39], a[208:211], a[68:71], a[36:39]
ds_read_b128 a[152:155], v19 offset:45056
v_mfma_f32_16x16x32_bf16 a[36:39], a[212:215], a[100:103], a[36:39]
buffer_load_dwordx4 v13, s[12:15], s33 offen offset:3072 lds
v_mfma_f32_16x16x32_bf16 a[40:43], a[208:211], a[72:75], a[40:43]
v_mfma_f32_16x16x32_bf16 a[40:43], a[212:215], a[104:107], a[40:43]
v_mfma_f32_16x16x32_bf16 a[44:47], a[208:211], a[76:79], a[44:47]
v_mfma_f32_16x16x32_bf16 a[44:47], a[212:215], a[108:111], a[44:47]
v_mfma_f32_16x16x32_bf16 a[48:51], a[208:211], a[80:83], a[48:51]
v_mfma_f32_16x16x32_bf16 a[48:51], a[212:215], a[112:115], a[48:51]
s_waitcnt lgkmcnt(1)
ds_read_b128 a[184:187], v20 offset:45056
v_mfma_f32_16x16x32_bf16 a[52:55], a[208:211], a[84:87], a[52:55]
ds_read_b128 a[156:159], v19 offset:47104
v_mfma_f32_16x16x32_bf16 a[52:55], a[212:215], a[116:119], a[52:55]
s_add_u32 m0, s34, 0
v_mfma_f32_16x16x32_bf16 a[56:59], a[208:211], a[88:91], a[56:59]
ds_read_b128 a[188:191], v20 offset:47104
v_mfma_f32_16x16x32_bf16 a[56:59], a[212:215], a[120:123], a[56:59]
buffer_load_dwordx4 v2, s[8:11], s32 offen offset:0 lds
v_mfma_f32_16x16x32_bf16 a[60:63], a[208:211], a[92:95], a[60:63]
ds_read_b128 a[200:203], v23 offset:12288
v_mfma_f32_16x16x32_bf16 a[60:63], a[212:215], a[124:127], a[60:63]
ds_read_b128 a[204:207], v24 offset:12288
v_mfma_f32_16x16x32_bf16 v[32:35], a[128:131], a[192:195], v[32:35]
ds_read_b64_tr_b16 a[208:209], v21 offset:28688
v_mfma_f32_16x16x32_bf16 v[32:35], a[160:163], a[196:199], v[32:35]
buffer_load_dwordx4 v3, s[8:11], s32 offen offset:1024 lds
v_mfma_f32_16x16x32_bf16 v[36:39], a[132:135], a[192:195], v[36:39]
ds_read_b64_tr_b16 a[210:211], v21 offset:30480
v_mfma_f32_16x16x32_bf16 v[36:39], a[164:167], a[196:199], v[36:39]
ds_read_b64_tr_b16 a[212:213], v21 offset:35856
v_mfma_f32_16x16x32_bf16 v[40:43], a[136:139], a[192:195], v[40:43]
ds_read_b64_tr_b16 a[214:215], v21 offset:37648
v_mfma_f32_16x16x32_bf16 v[40:43], a[168:171], a[196:199], v[40:43]
buffer_load_dwordx4 v4, s[8:11], s32 offen offset:2048 lds
v_mfma_f32_16x16x32_bf16 v[44:47], a[140:143], a[192:195], v[44:47]
s_lshl_b32 s67, s5, 5
v_mfma_f32_16x16x32_bf16 v[44:47], a[172:175], a[196:199], v[44:47]
v_mfma_f32_16x16x32_bf16 v[48:51], a[144:147], a[192:195], v[48:51]
v_mfma_f32_16x16x32_bf16 v[48:51], a[176:179], a[196:199], v[48:51]
v_mfma_f32_16x16x32_bf16 v[52:55], a[148:151], a[192:195], v[52:55]
v_mfma_f32_16x16x32_bf16 v[52:55], a[180:183], a[196:199], v[52:55]
buffer_load_dwordx4 v5, s[8:11], s32 offen offset:3072 lds
s_waitcnt lgkmcnt(1)
v_mfma_f32_16x16x32_bf16 v[56:59], a[152:155], a[192:195], v[56:59]
s_lshl_b32 s66, s7, 4
v_mfma_f32_16x16x32_bf16 v[56:59], a[184:187], a[196:199], v[56:59]
s_add_u32 s66, s66, s67
v_mfma_f32_16x16x32_bf16 v[60:63], a[156:159], a[192:195], v[60:63]
s_add_u32 m0, s64, 0
v_mfma_f32_16x16x32_bf16 v[60:63], a[188:191], a[196:199], v[60:63]
buffer_load_dwordx4 v17, s[16:19], s32 offen offset:0 lds
v_mfma_f32_16x16x32_bf16 v[64:67], a[128:131], a[200:203], v[64:67]
v_and_b32_e64 v25, 15, v0
v_mfma_f32_16x16x32_bf16 v[64:67], a[160:163], a[204:207], v[64:67]
v_add_u32_e64 v25, s66, v25
v_mfma_f32_16x16x32_bf16 v[68:71], a[132:135], a[200:203], v[68:71]
v_lshlrev_b32_e64 v25, 1, v25
v_mfma_f32_16x16x32_bf16 v[68:71], a[164:167], a[204:207], v[68:71]
buffer_load_dwordx4 v18, s[16:19], s32 offen offset:1024 lds
v_mfma_f32_16x16x32_bf16 v[72:75], a[136:139], a[200:203], v[72:75]
v_and_b32_e64 v30, 31, v0
v_mfma_f32_16x16x32_bf16 v[72:75], a[168:171], a[204:207], v[72:75]
v_add_u32_e64 v30, s67, v30
v_mfma_f32_16x16x32_bf16 v[76:79], a[140:143], a[200:203], v[76:79]
v_lshlrev_b32_e64 v30, 1, v30
v_mfma_f32_16x16x32_bf16 v[76:79], a[172:175], a[204:207], v[76:79]
v_lshlrev_b32_e64 v31, 4, v0
v_mfma_f32_16x16x32_bf16 v[80:83], a[144:147], a[200:203], v[80:83]
s_add_u32 m0, s35, 4096
v_mfma_f32_16x16x32_bf16 v[80:83], a[176:179], a[204:207], v[80:83]
buffer_load_dwordx4 v14, s[12:15], s33 offen offset:0 lds
v_mfma_f32_16x16x32_bf16 v[84:87], a[148:151], a[200:203], v[84:87]
ds_read_b64_tr_b16 a[192:193], v21 offset:43040
v_mfma_f32_16x16x32_bf16 v[84:87], a[180:183], a[204:207], v[84:87]
ds_read_b64_tr_b16 a[194:195], v21 offset:44832
v_mfma_f32_16x16x32_bf16 v[88:91], a[152:155], a[200:203], v[88:91]
ds_read_b64_tr_b16 a[196:197], v21 offset:50208
v_mfma_f32_16x16x32_bf16 v[88:91], a[184:187], a[204:207], v[88:91]
ds_read_b64_tr_b16 a[198:199], v21 offset:52000
v_mfma_f32_16x16x32_bf16 v[92:95], a[156:159], a[200:203], v[92:95]
v_mfma_f32_16x16x32_bf16 v[92:95], a[188:191], a[204:207], v[92:95]
v_mfma_f32_16x16x32_bf16 v[96:99], a[208:211], a[128:131], v[96:99]
s_waitcnt lgkmcnt(4)
v_mfma_f32_16x16x32_bf16 v[96:99], a[212:215], a[160:163], v[96:99]
buffer_load_dwordx4 v15, s[12:15], s33 offen offset:1024 lds
v_mfma_f32_16x16x32_bf16 v[100:103], a[208:211], a[132:135], v[100:103]
ds_read_b64_tr_b16 a[200:201], v21 offset:28720
v_mfma_f32_16x16x32_bf16 v[100:103], a[212:215], a[164:167], v[100:103]
ds_read_b64_tr_b16 a[202:203], v21 offset:30512
v_mfma_f32_16x16x32_bf16 v[104:107], a[208:211], a[136:139], v[104:107]
ds_read_b64_tr_b16 a[204:205], v21 offset:35888
v_mfma_f32_16x16x32_bf16 v[104:107], a[212:215], a[168:171], v[104:107]
ds_read_b64_tr_b16 a[206:207], v21 offset:37680
v_mfma_f32_16x16x32_bf16 v[108:111], a[208:211], a[140:143], v[108:111]
v_mfma_f32_16x16x32_bf16 v[108:111], a[212:215], a[172:175], v[108:111]
buffer_load_dwordx4 v16, s[12:15], s33 offen offset:2048 lds
v_mfma_f32_16x16x32_bf16 v[112:115], a[208:211], a[144:147], v[112:115]
s_add_u32 s33, s33, 458752
v_mfma_f32_16x16x32_bf16 v[112:115], a[212:215], a[176:179], v[112:115]
v_mfma_f32_16x16x32_bf16 v[116:119], a[208:211], a[148:151], v[116:119]
v_mfma_f32_16x16x32_bf16 v[116:119], a[212:215], a[180:183], v[116:119]
s_add_u32 m0, s34, 4096
v_mfma_f32_16x16x32_bf16 v[120:123], a[208:211], a[152:155], v[120:123]
buffer_load_dwordx4 v6, s[8:11], s32 offen offset:0 lds
v_mfma_f32_16x16x32_bf16 v[120:123], a[212:215], a[184:187], v[120:123]
v_mfma_f32_16x16x32_bf16 v[124:127], a[208:211], a[156:159], v[124:127]
v_mfma_f32_16x16x32_bf16 v[124:127], a[212:215], a[188:191], v[124:127]
s_waitcnt lgkmcnt(0)
v_mfma_f32_16x16x32_bf16 v[128:131], a[192:195], a[128:131], v[128:131]
v_mfma_f32_16x16x32_bf16 v[128:131], a[196:199], a[160:163], v[128:131]
buffer_load_dwordx4 v7, s[8:11], s32 offen offset:1024 lds
v_mfma_f32_16x16x32_bf16 v[132:135], a[192:195], a[132:135], v[132:135]
ds_read_b64_tr_b16 a[208:209], v21 offset:43072
v_mfma_f32_16x16x32_bf16 v[132:135], a[196:199], a[164:167], v[132:135]
ds_read_b64_tr_b16 a[210:211], v21 offset:44864
v_mfma_f32_16x16x32_bf16 v[136:139], a[192:195], a[136:139], v[136:139]
ds_read_b64_tr_b16 a[212:213], v21 offset:50240
v_mfma_f32_16x16x32_bf16 v[136:139], a[196:199], a[168:171], v[136:139]
buffer_load_dwordx4 v8, s[8:11], s32 offen offset:2048 lds
v_mfma_f32_16x16x32_bf16 v[140:143], a[192:195], a[140:143], v[140:143]
ds_read_b64_tr_b16 a[214:215], v21 offset:52032
v_mfma_f32_16x16x32_bf16 v[140:143], a[196:199], a[172:175], v[140:143]
v_mfma_f32_16x16x32_bf16 v[144:147], a[192:195], a[144:147], v[144:147]
v_mfma_f32_16x16x32_bf16 v[144:147], a[196:199], a[176:179], v[144:147]
buffer_load_dwordx4 v9, s[8:11], s32 offen offset:3072 lds
v_mfma_f32_16x16x32_bf16 v[148:151], a[192:195], a[148:151], v[148:151]
s_add_u32 s32, s32, 128
v_mfma_f32_16x16x32_bf16 v[148:151], a[196:199], a[180:183], v[148:151]
v_mfma_f32_16x16x32_bf16 v[152:155], a[192:195], a[152:155], v[152:155]
v_mfma_f32_16x16x32_bf16 v[152:155], a[196:199], a[184:187], v[152:155]
global_load_dwordx4 a[216:219], v31, s[58:59]
v_mfma_f32_16x16x32_bf16 v[156:159], a[192:195], a[156:159], v[156:159]
v_mfma_f32_16x16x32_bf16 v[156:159], a[196:199], a[188:191], v[156:159]
v_mfma_f32_16x16x32_bf16 v[160:163], a[200:203], a[128:131], v[160:163]
global_load_dwordx4 a[220:223], v31, s[58:59] offset:1024
v_mfma_f32_16x16x32_bf16 v[160:163], a[204:207], a[160:163], v[160:163]
ds_read_b64_tr_b16 a[192:193], v21 offset:28752
v_mfma_f32_16x16x32_bf16 v[164:167], a[200:203], a[132:135], v[164:167]
ds_read_b64_tr_b16 a[194:195], v21 offset:30544
v_mfma_f32_16x16x32_bf16 v[164:167], a[204:207], a[164:167], v[164:167]
buffer_load_dwordx4 a[224:227], v31, s[8:11], s73 offen
v_mfma_f32_16x16x32_bf16 v[168:171], a[200:203], a[136:139], v[168:171]
ds_read_b64_tr_b16 a[196:197], v21 offset:35920
v_mfma_f32_16x16x32_bf16 v[168:171], a[204:207], a[168:171], v[168:171]
ds_read_b64_tr_b16 a[198:199], v21 offset:37712
v_mfma_f32_16x16x32_bf16 v[172:175], a[200:203], a[140:143], v[172:175]
buffer_load_dwordx4 a[228:231], v31, s[8:11], s73 offen offset:1024
v_mfma_f32_16x16x32_bf16 v[172:175], a[204:207], a[172:175], v[172:175]
v_mfma_f32_16x16x32_bf16 v[176:179], a[200:203], a[144:147], v[176:179]
v_mfma_f32_16x16x32_bf16 v[176:179], a[204:207], a[176:179], v[176:179]
buffer_load_dwordx4 a[232:235], v31, s[8:11], s72 offen
v_mfma_f32_16x16x32_bf16 v[180:183], a[200:203], a[148:151], v[180:183]
v_mfma_f32_16x16x32_bf16 v[180:183], a[204:207], a[180:183], v[180:183]
v_mfma_f32_16x16x32_bf16 v[184:187], a[200:203], a[152:155], v[184:187]
buffer_load_dwordx4 a[236:239], v31, s[8:11], s72 offen offset:1024
v_mfma_f32_16x16x32_bf16 v[184:187], a[204:207], a[184:187], v[184:187]
v_mfma_f32_16x16x32_bf16 v[188:191], a[200:203], a[156:159], v[188:191]
v_mfma_f32_16x16x32_bf16 v[188:191], a[204:207], a[188:191], v[188:191]
s_waitcnt lgkmcnt(0)
v_mfma_f32_16x16x32_bf16 v[192:195], a[208:211], a[128:131], v[192:195]
global_load_ushort a240, v25, s[38:39]
v_mfma_f32_16x16x32_bf16 v[192:195], a[212:215], a[160:163], v[192:195]
ds_read_b64_tr_b16 a[200:201], v21 offset:43104
v_mfma_f32_16x16x32_bf16 v[196:199], a[208:211], a[132:135], v[196:199]
ds_read_b64_tr_b16 a[202:203], v21 offset:44896
v_mfma_f32_16x16x32_bf16 v[196:199], a[212:215], a[164:167], v[196:199]
global_load_ushort a241, v25, s[40:41]
v_mfma_f32_16x16x32_bf16 v[200:203], a[208:211], a[136:139], v[200:203]
ds_read_b64_tr_b16 a[204:205], v21 offset:50272
v_mfma_f32_16x16x32_bf16 v[200:203], a[212:215], a[168:171], v[200:203]
ds_read_b64_tr_b16 a[206:207], v21 offset:52064
v_mfma_f32_16x16x32_bf16 v[204:207], a[208:211], a[140:143], v[204:207]
global_load_ushort a242, v25, s[50:51]
v_mfma_f32_16x16x32_bf16 v[204:207], a[212:215], a[172:175], v[204:207]
v_mfma_f32_16x16x32_bf16 v[208:211], a[208:211], a[144:147], v[208:211]
v_mfma_f32_16x16x32_bf16 v[208:211], a[212:215], a[176:179], v[208:211]
global_load_ushort a243, v30, s[38:39]
v_mfma_f32_16x16x32_bf16 v[212:215], a[208:211], a[148:151], v[212:215]
v_mfma_f32_16x16x32_bf16 v[212:215], a[212:215], a[180:183], v[212:215]
v_mfma_f32_16x16x32_bf16 v[216:219], a[208:211], a[152:155], v[216:219]
global_load_ushort a244, v30, s[40:41]
v_mfma_f32_16x16x32_bf16 v[216:219], a[212:215], a[184:187], v[216:219]
v_mfma_f32_16x16x32_bf16 v[220:223], a[208:211], a[156:159], v[220:223]
v_mfma_f32_16x16x32_bf16 v[220:223], a[212:215], a[188:191], v[220:223]
v_mfma_f32_16x16x32_bf16 v[224:227], a[192:195], a[128:131], v[224:227]
global_load_ushort a245, v30, s[50:51]
v_mfma_f32_16x16x32_bf16 v[224:227], a[196:199], a[160:163], v[224:227]
ds_read_b64_tr_b16 a[208:209], v22 offset:28688
v_mfma_f32_16x16x32_bf16 v[228:231], a[192:195], a[132:135], v[228:231]
ds_read_b64_tr_b16 a[210:211], v22 offset:30480
v_mfma_f32_16x16x32_bf16 v[228:231], a[196:199], a[164:167], v[228:231]
buffer_load_dwordx2 a[252:253], off, s[24:27], 0 sc1
v_mfma_f32_16x16x32_bf16 v[232:235], a[192:195], a[136:139], v[232:235]
ds_read_b64_tr_b16 a[212:213], v22 offset:35856
v_mfma_f32_16x16x32_bf16 v[232:235], a[196:199], a[168:171], v[232:235]
ds_read_b64_tr_b16 a[214:215], v22 offset:37648
v_mfma_f32_16x16x32_bf16 v[236:239], a[192:195], a[140:143], v[236:239]
v_mfma_f32_16x16x32_bf16 v[236:239], a[196:199], a[172:175], v[236:239]
v_mfma_f32_16x16x32_bf16 v[240:243], a[192:195], a[144:147], v[240:243]
v_mfma_f32_16x16x32_bf16 v[240:243], a[196:199], a[176:179], v[240:243]
v_mfma_f32_16x16x32_bf16 v[244:247], a[192:195], a[148:151], v[244:247]
v_mfma_f32_16x16x32_bf16 v[244:247], a[196:199], a[180:183], v[244:247]
v_mfma_f32_16x16x32_bf16 v[248:251], a[192:195], a[152:155], v[248:251]
v_mfma_f32_16x16x32_bf16 v[248:251], a[196:199], a[184:187], v[248:251]
v_mfma_f32_16x16x32_bf16 v[252:255], a[192:195], a[156:159], v[252:255]
v_mfma_f32_16x16x32_bf16 v[252:255], a[196:199], a[188:191], v[252:255]
s_waitcnt lgkmcnt(0) vmcnt(13)
s_barrier
v_mfma_f32_16x16x32_bf16 a[0:3], a[200:203], a[128:131], a[0:3]
ds_read_b128 a[64:67], v19 offset:0
ds_read_b128 a[192:195], v23 offset:0
v_mfma_f32_16x16x32_bf16 a[0:3], a[204:207], a[160:163], a[0:3]
ds_read_b128 a[196:199], v24 offset:0
s_add_u32 m0, s35, 28688
v_mfma_f32_16x16x32_bf16 a[4:7], a[200:203], a[132:135], a[4:7]
ds_read_b128 a[96:99], v20 offset:0
buffer_load_dwordx4 v10, s[12:15], s33 offen offset:0 lds
v_mfma_f32_16x16x32_bf16 a[4:7], a[204:207], a[164:167], a[4:7]
ds_read_b128 a[68:71], v19 offset:2048
ds_read_b128 a[100:103], v20 offset:2048
v_mfma_f32_16x16x32_bf16 a[8:11], a[200:203], a[136:139], a[8:11]
ds_read_b128 a[72:75], v19 offset:4096
ds_read_b128 a[104:107], v20 offset:4096
v_mfma_f32_16x16x32_bf16 a[8:11], a[204:207], a[168:171], a[8:11]
ds_read_b128 a[76:79], v19 offset:6144
ds_read_b128 a[108:111], v20 offset:6144
v_mfma_f32_16x16x32_bf16 a[12:15], a[200:203], a[140:143], a[12:15]
ds_read_b128 a[80:83], v19 offset:8192
ds_read_b128 a[112:115], v20 offset:8192
v_mfma_f32_16x16x32_bf16 a[12:15], a[204:207], a[172:175], a[12:15]
ds_read_b128 a[84:87], v19 offset:10240
ds_read_b128 a[116:119], v20 offset:10240
v_mfma_f32_16x16x32_bf16 a[16:19], a[200:203], a[144:147], a[16:19]
buffer_load_dwordx4 v11, s[12:15], s33 offen offset:1024 lds
ds_read_b128 a[88:91], v19 offset:12288
v_mfma_f32_16x16x32_bf16 a[16:19], a[204:207], a[176:179], a[16:19]
s_waitcnt lgkmcnt(12)
ds_read_b128 a[120:123], v20 offset:12288
v_mfma_f32_16x16x32_bf16 a[20:23], a[200:203], a[148:151], a[20:23]
ds_read_b128 a[92:95], v19 offset:14336
ds_read_b128 a[124:127], v20 offset:14336
v_mfma_f32_16x16x32_bf16 a[20:23], a[204:207], a[180:183], a[20:23]
v_mfma_f32_16x16x32_bf16 a[24:27], a[200:203], a[152:155], a[24:27]
v_mfma_f32_16x16x32_bf16 a[24:27], a[204:207], a[184:187], a[24:27]
v_mfma_f32_16x16x32_bf16 a[28:31], a[200:203], a[156:159], a[28:31]
buffer_load_dwordx4 v12, s[12:15], s33 offen offset:2048 lds
v_mfma_f32_16x16x32_bf16 a[28:31], a[204:207], a[188:191], a[28:31]
v_mfma_f32_16x16x32_bf16 a[32:35], a[208:211], a[128:131], a[32:35]
s_waitcnt lgkmcnt(3)
ds_read_b128 a[200:203], v23 offset:4096
v_mfma_f32_16x16x32_bf16 a[32:35], a[212:215], a[160:163], a[32:35]
ds_read_b128 a[204:207], v24 offset:4096
v_mfma_f32_16x16x32_bf16 a[36:39], a[208:211], a[132:135], a[36:39]
v_mfma_f32_16x16x32_bf16 a[36:39], a[212:215], a[164:167], a[36:39]
v_mfma_f32_16x16x32_bf16 a[40:43], a[208:211], a[136:139], a[40:43]
buffer_load_dwordx4 v13, s[12:15], s33 offen offset:3072 lds
v_mfma_f32_16x16x32_bf16 a[40:43], a[212:215], a[168:171], a[40:43]
v_mfma_f32_16x16x32_bf16 a[44:47], a[208:211], a[140:143], a[44:47]
v_mfma_f32_16x16x32_bf16 a[44:47], a[212:215], a[172:175], a[44:47]
s_add_u32 m0, s34, 32768
v_mfma_f32_16x16x32_bf16 a[48:51], a[208:211], a[144:147], a[48:51]
buffer_load_dwordx4 v2, s[8:11], s32 offen offset:0 lds
v_mfma_f32_16x16x32_bf16 a[48:51], a[212:215], a[176:179], a[48:51]
v_mfma_f32_16x16x32_bf16 a[52:55], a[208:211], a[148:151], a[52:55]
v_mfma_f32_16x16x32_bf16 a[52:55], a[212:215], a[180:183], a[52:55]
v_mfma_f32_16x16x32_bf16 a[56:59], a[208:211], a[152:155], a[56:59]
buffer_load_dwordx4 v3, s[8:11], s32 offen offset:1024 lds
v_mfma_f32_16x16x32_bf16 a[56:59], a[212:215], a[184:187], a[56:59]
s_waitcnt vmcnt(6)
v_mfma_f32_16x16x32_bf16 a[60:63], a[208:211], a[156:159], a[60:63]
v_accvgpr_read_b32 v1, a216
v_lshlrev_b32_e64 v27, 16, v1
v_mfma_f32_16x16x32_bf16 a[60:63], a[212:215], a[188:191], a[60:63]
v_and_b32 v29, 0xffff0000, v1
v_accvgpr_read_b32 v25, a224
v_mfma_f32_16x16x32_bf16 v[32:35], a[64:67], a[192:195], v[32:35]
buffer_load_dwordx4 v4, s[8:11], s32 offen offset:2048 lds
ds_read_b64_tr_b16 a[208:209], v21 offset:0
v_mfma_f32_16x16x32_bf16 v[32:35], a[96:99], a[196:199], v[32:35]
ds_read_b64_tr_b16 a[210:211], v21 offset:1792
ds_read_b64_tr_b16 a[212:213], v21 offset:7168
v_mfma_f32_16x16x32_bf16 v[36:39], a[68:71], a[192:195], v[36:39]
ds_read_b64_tr_b16 a[214:215], v21 offset:8960
v_lshlrev_b32_e64 v30, 16, v25
v_mfma_f32_16x16x32_bf16 v[36:39], a[100:103], a[196:199], v[36:39]
v_and_b32 v31, 0xffff0000, v25
v_mul_f32_e64 v30, v30, v27
v_mfma_f32_16x16x32_bf16 v[40:43], a[72:75], a[192:195], v[40:43]
buffer_load_dwordx4 v5, s[8:11], s32 offen offset:3072 lds
v_mul_f32_e64 v31, v31, v29
v_mfma_f32_16x16x32_bf16 v[40:43], a[104:107], a[196:199], v[40:43]
v_cvt_pk_bf16_f32 v25, v30, v31
v_lshlrev_b32_e64 v30, 16, v25
v_mfma_f32_16x16x32_bf16 v[44:47], a[76:79], a[192:195], v[44:47]
v_and_b32 v31, 0xffff0000, v25
v_add_f32_e64 v26, v30, v31
v_mfma_f32_16x16x32_bf16 v[44:47], a[108:111], a[196:199], v[44:47]
s_add_u32 m0, s64, 8192
v_accvgpr_read_b32 v25, a232
v_mfma_f32_16x16x32_bf16 v[48:51], a[80:83], a[192:195], v[48:51]
buffer_load_dwordx4 v17, s[16:19], s32 offen offset:0 lds
v_lshlrev_b32_e64 v30, 16, v25
v_mfma_f32_16x16x32_bf16 v[48:51], a[112:115], a[196:199], v[48:51]
v_and_b32 v31, 0xffff0000, v25
v_mul_f32_e64 v30, v30, v27
v_mfma_f32_16x16x32_bf16 v[52:55], a[84:87], a[192:195], v[52:55]
v_mul_f32_e64 v31, v31, v29
v_cvt_pk_bf16_f32 v25, v30, v31
v_mfma_f32_16x16x32_bf16 v[52:55], a[116:119], a[196:199], v[52:55]
v_lshlrev_b32_e64 v30, 16, v25
v_and_b32 v31, 0xffff0000, v25
v_mfma_f32_16x16x32_bf16 v[56:59], a[88:91], a[192:195], v[56:59]
buffer_load_dwordx4 v18, s[16:19], s32 offen offset:1024 lds
s_waitcnt lgkmcnt(0)
v_mfma_f32_16x16x32_bf16 v[56:59], a[120:123], a[196:199], v[56:59]
v_add_f32 v28, v30, v31
v_accvgpr_read_b32 v1, a217
v_mfma_f32_16x16x32_bf16 v[60:63], a[92:95], a[192:195], v[60:63]
v_lshlrev_b32_e64 v27, 16, v1
v_and_b32 v29, 0xffff0000, v1
v_mfma_f32_16x16x32_bf16 v[60:63], a[124:127], a[196:199], v[60:63]
v_accvgpr_read_b32 v25, a225
v_lshlrev_b32_e64 v30, 16, v25
v_mfma_f32_16x16x32_bf16 v[64:67], a[64:67], a[200:203], v[64:67]
ds_read_b64_tr_b16 a[192:193], v21 offset:14352
ds_read_b64_tr_b16 a[194:195], v21 offset:16144
v_mfma_f32_16x16x32_bf16 v[64:67], a[96:99], a[204:207], v[64:67]
ds_read_b64_tr_b16 a[196:197], v21 offset:21520
ds_read_b64_tr_b16 a[198:199], v21 offset:23312
v_mfma_f32_16x16x32_bf16 v[68:71], a[68:71], a[200:203], v[68:71]
s_add_u32 m0, s35, 32784
v_and_b32 v31, 0xffff0000, v25
v_mfma_f32_16x16x32_bf16 v[68:71], a[100:103], a[204:207], v[68:71]
buffer_load_dwordx4 v14, s[12:15], s33 offen offset:0 lds
v_mfma_f32_16x16x32_bf16 v[72:75], a[72:75], a[200:203], v[72:75]
v_mul_f32_e64 v30, v30, v27
v_mfma_f32_16x16x32_bf16 v[72:75], a[104:107], a[204:207], v[72:75]
v_mul_f32_e64 v31, v31, v29
v_mfma_f32_16x16x32_bf16 v[76:79], a[76:79], a[200:203], v[76:79]
v_cvt_pk_bf16_f32 v25, v30, v31
v_mfma_f32_16x16x32_bf16 v[76:79], a[108:111], a[204:207], v[76:79]
v_lshlrev_b32_e64 v30, 16, v25
v_mfma_f32_16x16x32_bf16 v[80:83], a[80:83], a[200:203], v[80:83]
v_and_b32 v31, 0xffff0000, v25
v_mfma_f32_16x16x32_bf16 v[80:83], a[112:115], a[204:207], v[80:83]
buffer_load_dwordx4 v15, s[12:15], s33 offen offset:1024 lds
v_mfma_f32_16x16x32_bf16 v[84:87], a[84:87], a[200:203], v[84:87]
v_add_f32_e64 v26, v26, v30
v_mfma_f32_16x16x32_bf16 v[84:87], a[116:119], a[204:207], v[84:87]
v_add_f32_e64 v26, v26, v31
v_mfma_f32_16x16x32_bf16 v[88:91], a[88:91], a[200:203], v[88:91]
v_accvgpr_read_b32 v25, a233
v_mfma_f32_16x16x32_bf16 v[88:91], a[120:123], a[204:207], v[88:91]
v_lshlrev_b32_e64 v30, 16, v25
v_mfma_f32_16x16x32_bf16 v[92:95], a[92:95], a[200:203], v[92:95]
v_and_b32 v31, 0xffff0000, v25
v_mfma_f32_16x16x32_bf16 v[92:95], a[124:127], a[204:207], v[92:95]
buffer_load_dwordx4 v16, s[12:15], s33 offen offset:2048 lds
v_mfma_f32_16x16x32_bf16 v[96:99], a[208:211], a[64:67], v[96:99]
s_add_u32 s33, s33, 458752
v_mfma_f32_16x16x32_bf16 v[96:99], a[212:215], a[96:99], v[96:99]
ds_read_b64_tr_b16 a[200:201], v21 offset:32
v_mfma_f32_16x16x32_bf16 v[100:103], a[208:211], a[68:71], v[100:103]
ds_read_b64_tr_b16 a[202:203], v21 offset:1824
v_mfma_f32_16x16x32_bf16 v[100:103], a[212:215], a[100:103], v[100:103]
ds_read_b64_tr_b16 a[204:205], v21 offset:7200
v_mfma_f32_16x16x32_bf16 v[104:107], a[208:211], a[72:75], v[104:107]
ds_read_b64_tr_b16 a[206:207], v21 offset:8992
v_mfma_f32_16x16x32_bf16 v[104:107], a[212:215], a[104:107], v[104:107]
s_add_u32 m0, s34, 36864
v_mfma_f32_16x16x32_bf16 v[108:111], a[208:211], a[76:79], v[108:111]
buffer_load_dwordx4 v6, s[8:11], s32 offen offset:0 lds
v_mfma_f32_16x16x32_bf16 v[108:111], a[212:215], a[108:111], v[108:111]
v_mul_f32_e64 v30, v30, v27
v_mfma_f32_16x16x32_bf16 v[112:115], a[208:211], a[80:83], v[112:115]
v_mul_f32_e64 v31, v31, v29
v_mfma_f32_16x16x32_bf16 v[112:115], a[212:215], a[112:115], v[112:115]
v_cvt_pk_bf16_f32 v25, v30, v31
v_mfma_f32_16x16x32_bf16 v[116:119], a[208:211], a[84:87], v[116:119]
buffer_load_dwordx4 v7, s[8:11], s32 offen offset:1024 lds
v_mfma_f32_16x16x32_bf16 v[116:119], a[212:215], a[116:119], v[116:119]
v_lshlrev_b32_e64 v30, 16, v25
v_mfma_f32_16x16x32_bf16 v[120:123], a[208:211], a[88:91], v[120:123]
v_and_b32 v31, 0xffff0000, v25
v_mfma_f32_16x16x32_bf16 v[120:123], a[212:215], a[120:123], v[120:123]
v_add_f32_e64 v28, v28, v30
v_mfma_f32_16x16x32_bf16 v[124:127], a[208:211], a[92:95], v[124:127]
buffer_load_dwordx4 v8, s[8:11], s32 offen offset:2048 lds
v_mfma_f32_16x16x32_bf16 v[124:127], a[212:215], a[124:127], v[124:127]
v_add_f32 v28, v28, v31
s_waitcnt lgkmcnt(0)
v_mfma_f32_16x16x32_bf16 v[128:131], a[192:195], a[64:67], v[128:131]
ds_read_b64_tr_b16 a[208:209], v21 offset:14384
v_mfma_f32_16x16x32_bf16 v[128:131], a[196:199], a[96:99], v[128:131]
ds_read_b64_tr_b16 a[210:211], v21 offset:16176
v_mfma_f32_16x16x32_bf16 v[132:135], a[192:195], a[68:71], v[132:135]
buffer_load_dwordx4 v9, s[8:11], s32 offen offset:3072 lds
v_mfma_f32_16x16x32_bf16 v[132:135], a[196:199], a[100:103], v[132:135]
s_add_u32 s32, s32, 128
v_mfma_f32_16x16x32_bf16 v[136:139], a[192:195], a[72:75], v[136:139]
ds_read_b64_tr_b16 a[212:213], v21 offset:21552
v_mfma_f32_16x16x32_bf16 v[136:139], a[196:199], a[104:107], v[136:139]
ds_read_b64_tr_b16 a[214:215], v21 offset:23344
v_mfma_f32_16x16x32_bf16 v[140:143], a[192:195], a[76:79], v[140:143]
v_accvgpr_read_b32 v1, a218
v_mfma_f32_16x16x32_bf16 v[140:143], a[196:199], a[108:111], v[140:143]
v_lshlrev_b32_e64 v27, 16, v1
v_mfma_f32_16x16x32_bf16 v[144:147], a[192:195], a[80:83], v[144:147]
v_and_b32 v29, 0xffff0000, v1
v_mfma_f32_16x16x32_bf16 v[144:147], a[196:199], a[112:115], v[144:147]
v_accvgpr_read_b32 v25, a226
v_mfma_f32_16x16x32_bf16 v[148:151], a[192:195], a[84:87], v[148:151]
v_lshlrev_b32_e64 v30, 16, v25
v_mfma_f32_16x16x32_bf16 v[148:151], a[196:199], a[116:119], v[148:151]
v_and_b32 v31, 0xffff0000, v25
v_mfma_f32_16x16x32_bf16 v[152:155], a[192:195], a[88:91], v[152:155]
v_mul_f32_e64 v30, v30, v27
v_mfma_f32_16x16x32_bf16 v[152:155], a[196:199], a[120:123], v[152:155]
v_mul_f32_e64 v31, v31, v29
v_mfma_f32_16x16x32_bf16 v[156:159], a[192:195], a[92:95], v[156:159]
v_cvt_pk_bf16_f32 v25, v30, v31
v_mfma_f32_16x16x32_bf16 v[156:159], a[196:199], a[124:127], v[156:159]
v_lshlrev_b32_e64 v30, 16, v25
v_mfma_f32_16x16x32_bf16 v[160:163], a[200:203], a[64:67], v[160:163]
ds_read_b64_tr_b16 a[192:193], v21 offset:64
v_mfma_f32_16x16x32_bf16 v[160:163], a[204:207], a[96:99], v[160:163]
ds_read_b64_tr_b16 a[194:195], v21 offset:1856
v_mfma_f32_16x16x32_bf16 v[164:167], a[200:203], a[68:71], v[164:167]
ds_read_b64_tr_b16 a[196:197], v21 offset:7232
v_mfma_f32_16x16x32_bf16 v[164:167], a[204:207], a[100:103], v[164:167]
ds_read_b64_tr_b16 a[198:199], v21 offset:9024
v_mfma_f32_16x16x32_bf16 v[168:171], a[200:203], a[72:75], v[168:171]
v_and_b32 v31, 0xffff0000, v25
v_mfma_f32_16x16x32_bf16 v[168:171], a[204:207], a[104:107], v[168:171]
v_add_f32_e64 v26, v26, v30
v_mfma_f32_16x16x32_bf16 v[172:175], a[200:203], a[76:79], v[172:175]
v_add_f32_e64 v26, v26, v31
v_mfma_f32_16x16x32_bf16 v[172:175], a[204:207], a[108:111], v[172:175]
v_accvgpr_read_b32 v25, a234
v_mfma_f32_16x16x32_bf16 v[176:179], a[200:203], a[80:83], v[176:179]
v_lshlrev_b32_e64 v30, 16, v25
v_mfma_f32_16x16x32_bf16 v[176:179], a[204:207], a[112:115], v[176:179]
v_and_b32 v31, 0xffff0000, v25
v_mfma_f32_16x16x32_bf16 v[180:183], a[200:203], a[84:87], v[180:183]
v_mul_f32_e64 v30, v30, v27
v_mfma_f32_16x16x32_bf16 v[180:183], a[204:207], a[116:119], v[180:183]
v_mul_f32_e64 v31, v31, v29
v_mfma_f32_16x16x32_bf16 v[184:187], a[200:203], a[88:91], v[184:187]
v_cvt_pk_bf16_f32 v25, v30, v31
v_mfma_f32_16x16x32_bf16 v[184:187], a[204:207], a[120:123], v[184:187]
v_lshlrev_b32_e64 v30, 16, v25
v_mfma_f32_16x16x32_bf16 v[188:191], a[200:203], a[92:95], v[188:191]
v_and_b32 v31, 0xffff0000, v25
v_mfma_f32_16x16x32_bf16 v[188:191], a[204:207], a[124:127], v[188:191]
v_add_f32 v28, v28, v30
s_waitcnt lgkmcnt(0)
v_mfma_f32_16x16x32_bf16 v[192:195], a[208:211], a[64:67], v[192:195]
ds_read_b64_tr_b16 a[200:201], v21 offset:14416
v_mfma_f32_16x16x32_bf16 v[192:195], a[212:215], a[96:99], v[192:195]
ds_read_b64_tr_b16 a[202:203], v21 offset:16208
v_mfma_f32_16x16x32_bf16 v[196:199], a[208:211], a[68:71], v[196:199]
ds_read_b64_tr_b16 a[204:205], v21 offset:21584
v_mfma_f32_16x16x32_bf16 v[196:199], a[212:215], a[100:103], v[196:199]
ds_read_b64_tr_b16 a[206:207], v21 offset:23376
v_mfma_f32_16x16x32_bf16 v[200:203], a[208:211], a[72:75], v[200:203]
v_add_f32_e64 v28, v28, v31
v_mfma_f32_16x16x32_bf16 v[200:203], a[212:215], a[104:107], v[200:203]
v_accvgpr_read_b32 v1, a219
v_mfma_f32_16x16x32_bf16 v[204:207], a[208:211], a[76:79], v[204:207]
v_lshlrev_b32_e64 v27, 16, v1
v_mfma_f32_16x16x32_bf16 v[204:207], a[212:215], a[108:111], v[204:207]
v_and_b32 v29, 0xffff0000, v1
v_mfma_f32_16x16x32_bf16 v[208:211], a[208:211], a[80:83], v[208:211]
v_accvgpr_read_b32 v25, a227
v_mfma_f32_16x16x32_bf16 v[208:211], a[212:215], a[112:115], v[208:211]
v_lshlrev_b32_e64 v30, 16, v25
v_mfma_f32_16x16x32_bf16 v[212:215], a[208:211], a[84:87], v[212:215]
v_and_b32 v31, 0xffff0000, v25
v_mfma_f32_16x16x32_bf16 v[212:215], a[212:215], a[116:119], v[212:215]
v_mul_f32_e64 v30, v30, v27
v_mfma_f32_16x16x32_bf16 v[216:219], a[208:211], a[88:91], v[216:219]
v_mul_f32_e64 v31, v31, v29
v_mfma_f32_16x16x32_bf16 v[216:219], a[212:215], a[120:123], v[216:219]
v_cvt_pk_bf16_f32 v25, v30, v31
v_mfma_f32_16x16x32_bf16 v[220:223], a[208:211], a[92:95], v[220:223]
v_lshlrev_b32_e64 v30, 16, v25
v_mfma_f32_16x16x32_bf16 v[220:223], a[212:215], a[124:127], v[220:223]
v_and_b32 v31, 0xffff0000, v25
v_mfma_f32_16x16x32_bf16 v[224:227], a[192:195], a[64:67], v[224:227]
ds_read_b64_tr_b16 a[208:209], v22 offset:0
v_mfma_f32_16x16x32_bf16 v[224:227], a[196:199], a[96:99], v[224:227]
ds_read_b64_tr_b16 a[210:211], v22 offset:1792
v_mfma_f32_16x16x32_bf16 v[228:231], a[192:195], a[68:71], v[228:231]
ds_read_b64_tr_b16 a[212:213], v22 offset:7168
v_mfma_f32_16x16x32_bf16 v[228:231], a[196:199], a[100:103], v[228:231]
ds_read_b64_tr_b16 a[214:215], v22 offset:8960
v_mfma_f32_16x16x32_bf16 v[232:235], a[192:195], a[72:75], v[232:235]
v_add_f32_e64 v26, v26, v30
v_mfma_f32_16x16x32_bf16 v[232:235], a[196:199], a[104:107], v[232:235]
v_add_f32_e64 v26, v26, v31
v_mfma_f32_16x16x32_bf16 v[236:239], a[192:195], a[76:79], v[236:239]
v_accvgpr_read_b32 v25, a235
v_mfma_f32_16x16x32_bf16 v[236:239], a[196:199], a[108:111], v[236:239]
v_lshlrev_b32_e64 v30, 16, v25
v_mfma_f32_16x16x32_bf16 v[240:243], a[192:195], a[80:83], v[240:243]
v_and_b32 v31, 0xffff0000, v25
v_mfma_f32_16x16x32_bf16 v[240:243], a[196:199], a[112:115], v[240:243]
v_mul_f32_e64 v30, v30, v27
v_mfma_f32_16x16x32_bf16 v[244:247], a[192:195], a[84:87], v[244:247]
v_mul_f32_e64 v31, v31, v29
v_mfma_f32_16x16x32_bf16 v[244:247], a[196:199], a[116:119], v[244:247]
v_cvt_pk_bf16_f32 v25, v30, v31
v_mfma_f32_16x16x32_bf16 v[248:251], a[192:195], a[88:91], v[248:251]
v_lshlrev_b32_e64 v30, 16, v25
v_mfma_f32_16x16x32_bf16 v[248:251], a[196:199], a[120:123], v[248:251]
v_and_b32 v31, 0xffff0000, v25
v_mfma_f32_16x16x32_bf16 v[252:255], a[192:195], a[92:95], v[252:255]
v_add_f32_e64 v28, v28, v30
v_mfma_f32_16x16x32_bf16 v[252:255], a[196:199], a[124:127], v[252:255]
v_add_f32 v28, v28, v31
s_waitcnt lgkmcnt(0) vmcnt(0)
s_barrier
v_mfma_f32_16x16x32_bf16 a[0:3], a[200:203], a[64:67], a[0:3]
ds_read_b128 a[128:131], v19 offset:32768
ds_read_b128 a[192:195], v23 offset:8192
v_mfma_f32_16x16x32_bf16 a[0:3], a[204:207], a[96:99], a[0:3]
ds_read_b128 a[196:199], v24 offset:8192
ds_read_b128 a[160:163], v20 offset:32768
v_mfma_f32_16x16x32_bf16 a[4:7], a[200:203], a[68:71], a[4:7]
ds_read_b128 a[132:135], v19 offset:34816
ds_read_b128 a[164:167], v20 offset:34816
v_mfma_f32_16x16x32_bf16 a[4:7], a[204:207], a[100:103], a[4:7]
ds_read_b128 a[136:139], v19 offset:36864
ds_read_b128 a[168:171], v20 offset:36864
v_mfma_f32_16x16x32_bf16 a[8:11], a[200:203], a[72:75], a[8:11]
ds_read_b128 a[140:143], v19 offset:38912
ds_read_b128 a[172:175], v20 offset:38912
v_mfma_f32_16x16x32_bf16 a[8:11], a[204:207], a[104:107], a[8:11]
ds_read_b128 a[144:147], v19 offset:40960
ds_read_b128 a[176:179], v20 offset:40960
v_mfma_f32_16x16x32_bf16 a[12:15], a[200:203], a[76:79], a[12:15]
ds_read_b128 a[148:151], v19 offset:43008
ds_read_b128 a[180:183], v20 offset:43008
v_mfma_f32_16x16x32_bf16 a[12:15], a[204:207], a[108:111], a[12:15]
ds_read_b128 a[152:155], v19 offset:45056
v_mfma_f32_16x16x32_bf16 a[16:19], a[200:203], a[80:83], a[16:19]
s_waitcnt lgkmcnt(13)
ds_read_b128 a[184:187], v20 offset:45056
v_mfma_f32_16x16x32_bf16 a[16:19], a[204:207], a[112:115], a[16:19]
ds_read_b128 a[156:159], v19 offset:47104
v_mfma_f32_16x16x32_bf16 a[20:23], a[200:203], a[84:87], a[20:23]
s_waitcnt lgkmcnt(11)
ds_read_b128 a[188:191], v20 offset:47104
v_mfma_f32_16x16x32_bf16 a[20:23], a[204:207], a[116:119], a[20:23]
v_accvgpr_read_b32 v3, a253
v_accvgpr_read_b32 v2, a252
v_mfma_f32_16x16x32_bf16 a[24:27], a[200:203], a[88:91], a[24:27]
v_cmp_eq_u32 vcc, 0, v3
s_nop 0
v_mfma_f32_16x16x32_bf16 a[24:27], a[204:207], a[120:123], a[24:27]
s_nop 0
s_cbranch_vccnz KF_tg_slow
KF_tg_ok:
v_mfma_f32_16x16x32_bf16 a[28:31], a[200:203], a[92:95], a[28:31]
v_readfirstlane_b32 s75, v2
v_accvgpr_read_b32 v1, a220
v_mfma_f32_16x16x32_bf16 a[28:31], a[204:207], a[124:127], a[28:31]
v_lshlrev_b32_e64 v27, 16, v1
v_and_b32 v29, 0xffff0000, v1
v_mfma_f32_16x16x32_bf16 a[32:35], a[208:211], a[64:67], a[32:35]
ds_read_b128 a[200:203], v23 offset:12288
v_mfma_f32_16x16x32_bf16 a[32:35], a[212:215], a[96:99], a[32:35]
ds_read_b128 a[204:207], v24 offset:12288
v_mfma_f32_16x16x32_bf16 a[36:39], a[208:211], a[68:71], a[36:39]
v_accvgpr_read_b32 v25, a228
v_lshlrev_b32_e64 v30, 16, v25
v_mfma_f32_16x16x32_bf16 a[36:39], a[212:215], a[100:103], a[36:39]
v_and_b32 v31, 0xffff0000, v25
v_mul_f32_e64 v30, v30, v27
v_mfma_f32_16x16x32_bf16 a[40:43], a[208:211], a[72:75], a[40:43]
v_mul_f32_e64 v31, v31, v29
v_cvt_pk_bf16_f32 v25, v30, v31
v_mfma_f32_16x16x32_bf16 a[40:43], a[212:215], a[104:107], a[40:43]
v_lshlrev_b32_e64 v30, 16, v25
v_and_b32 v31, 0xffff0000, v25
v_mfma_f32_16x16x32_bf16 a[44:47], a[208:211], a[76:79], a[44:47]
v_add_f32 v26, v26, v30
v_add_f32 v26, v26, v31
v_mfma_f32_16x16x32_bf16 a[44:47], a[212:215], a[108:111], a[44:47]
v_accvgpr_read_b32 v25, a236
v_lshlrev_b32_e64 v30, 16, v25
v_mfma_f32_16x16x32_bf16 a[48:51], a[208:211], a[80:83], a[48:51]
v_and_b32 v31, 0xffff0000, v25
v_mul_f32_e64 v30, v30, v27
v_mfma_f32_16x16x32_bf16 a[48:51], a[212:215], a[112:115], a[48:51]
v_mul_f32_e64 v31, v31, v29
v_cvt_pk_bf16_f32 v25, v30, v31
v_mfma_f32_16x16x32_bf16 a[52:55], a[208:211], a[84:87], a[52:55]
v_lshlrev_b32_e64 v30, 16, v25
v_and_b32 v31, 0xffff0000, v25
v_mfma_f32_16x16x32_bf16 a[52:55], a[212:215], a[116:119], a[52:55]
v_add_f32 v28, v28, v30
v_add_f32 v28, v28, v31
v_mfma_f32_16x16x32_bf16 a[56:59], a[208:211], a[88:91], a[56:59]
v_accvgpr_read_b32 v1, a221
v_lshlrev_b32_e64 v27, 16, v1
v_mfma_f32_16x16x32_bf16 a[56:59], a[212:215], a[120:123], a[56:59]
v_and_b32 v29, 0xffff0000, v1
v_accvgpr_read_b32 v25, a229
v_mfma_f32_16x16x32_bf16 a[60:63], a[208:211], a[92:95], a[60:63]
v_lshlrev_b32_e64 v30, 16, v25
v_and_b32 v31, 0xffff0000, v25
v_mfma_f32_16x16x32_bf16 a[60:63], a[212:215], a[124:127], a[60:63]
v_mul_f32 v30, v30, v27
v_mul_f32 v31, v31, v29
v_mfma_f32_16x16x32_bf16 v[32:35], a[128:131], a[192:195], v[32:35]
ds_read_b64_tr_b16 a[208:209], v21 offset:28688
v_mfma_f32_16x16x32_bf16 v[32:35], a[160:163], a[196:199], v[32:35]
s_waitcnt lgkmcnt(1)
ds_read_b64_tr_b16 a[210:211], v21 offset:30480
v_mfma_f32_16x16x32_bf16 v[36:39], a[132:135], a[192:195], v[36:39]
ds_read_b64_tr_b16 a[212:213], v21 offset:35856
ds_read_b64_tr_b16 a[214:215], v21 offset:37648
v_mfma_f32_16x16x32_bf16 v[36:39], a[164:167], a[196:199], v[36:39]
v_cvt_pk_bf16_f32 v25, v30, v31
v_lshlrev_b32 v30, 16, v25
v_mfma_f32_16x16x32_bf16 v[40:43], a[136:139], a[192:195], v[40:43]
v_and_b32 v31, 0xffff0000, v25
v_add_f32_e64 v26, v26, v30
v_mfma_f32_16x16x32_bf16 v[40:43], a[168:171], a[196:199], v[40:43]
v_add_f32_e64 v26, v26, v31
v_accvgpr_read_b32 v25, a237
v_mfma_f32_16x16x32_bf16 v[44:47], a[140:143], a[192:195], v[44:47]
v_lshlrev_b32_e64 v30, 16, v25
v_and_b32 v31, 0xffff0000, v25
v_mfma_f32_16x16x32_bf16 v[44:47], a[172:175], a[196:199], v[44:47]
v_mul_f32 v30, v30, v27
v_mul_f32 v31, v31, v29
v_mfma_f32_16x16x32_bf16 v[48:51], a[144:147], a[192:195], v[48:51]
v_cvt_pk_bf16_f32 v25, v30, v31
v_lshlrev_b32_e64 v30, 16, v25
v_mfma_f32_16x16x32_bf16 v[48:51], a[176:179], a[196:199], v[48:51]
v_and_b32 v31, 0xffff0000, v25
v_add_f32_e64 v28, v28, v30
v_mfma_f32_16x16x32_bf16 v[52:55], a[148:151], a[192:195], v[52:55]
v_add_f32_e64 v28, v28, v31
v_accvgpr_read_b32 v1, a222
v_mfma_f32_16x16x32_bf16 v[52:55], a[180:183], a[196:199], v[52:55]
v_lshlrev_b32_e64 v27, 16, v1
v_and_b32 v29, 0xffff0000, v1
v_mfma_f32_16x16x32_bf16 v[56:59], a[152:155], a[192:195], v[56:59]
v_accvgpr_read_b32 v25, a230
v_lshlrev_b32_e64 v30, 16, v25
v_mfma_f32_16x16x32_bf16 v[56:59], a[184:187], a[196:199], v[56:59]
v_and_b32 v31, 0xffff0000, v25
v_mul_f32_e64 v30, v30, v27
v_mfma_f32_16x16x32_bf16 v[60:63], a[156:159], a[192:195], v[60:63]
v_mul_f32_e64 v31, v31, v29
v_cvt_pk_bf16_f32 v25, v30, v31
v_mfma_f32_16x16x32_bf16 v[60:63], a[188:191], a[196:199], v[60:63]
v_lshlrev_b32_e64 v30, 16, v25
v_mfma_f32_16x16x32_bf16 v[64:67], a[128:131], a[200:203], v[64:67]
ds_read_b64_tr_b16 a[192:193], v21 offset:43040
ds_read_b64_tr_b16 a[194:195], v21 offset:44832
v_mfma_f32_16x16x32_bf16 v[64:67], a[160:163], a[204:207], v[64:67]
ds_read_b64_tr_b16 a[196:197], v21 offset:50208
ds_read_b64_tr_b16 a[198:199], v21 offset:52000
v_mfma_f32_16x16x32_bf16 v[68:71], a[132:135], a[200:203], v[68:71]
v_and_b32 v31, 0xffff0000, v25
v_add_f32_e64 v26, v26, v30
v_mfma_f32_16x16x32_bf16 v[68:71], a[164:167], a[204:207], v[68:71]
v_add_f32_e64 v26, v26, v31
v_accvgpr_read_b32 v25, a238
v_mfma_f32_16x16x32_bf16 v[72:75], a[136:139], a[200:203], v[72:75]
v_lshlrev_b32_e64 v30, 16, v25
v_and_b32 v31, 0xffff0000, v25
v_mfma_f32_16x16x32_bf16 v[72:75], a[168:171], a[204:207], v[72:75]
v_mul_f32 v30, v30, v27
v_mul_f32 v31, v31, v29
v_mfma_f32_16x16x32_bf16 v[76:79], a[140:143], a[200:203], v[76:79]
v_cvt_pk_bf16_f32 v25, v30, v31
v_lshlrev_b32_e64 v30, 16, v25
v_mfma_f32_16x16x32_bf16 v[76:79], a[172:175], a[204:207], v[76:79]
v_and_b32 v31, 0xffff0000, v25
v_add_f32_e64 v28, v28, v30
v_mfma_f32_16x16x32_bf16 v[80:83], a[144:147], a[200:203], v[80:83]
v_add_f32_e64 v28, v28, v31
v_accvgpr_read_b32 v1, a223
v_mfma_f32_16x16x32_bf16 v[80:83], a[176:179], a[204:207], v[80:83]
v_lshlrev_b32_e64 v27, 16, v1
v_and_b32 v29, 0xffff0000, v1
v_mfma_f32_16x16x32_bf16 v[84:87], a[148:151], a[200:203], v[84:87]
v_accvgpr_read_b32 v25, a231
v_lshlrev_b32_e64 v30, 16, v25
v_mfma_f32_16x16x32_bf16 v[84:87], a[180:183], a[204:207], v[84:87]
v_and_b32 v31, 0xffff0000, v25
v_mul_f32_e64 v30, v30, v27
v_mfma_f32_16x16x32_bf16 v[88:91], a[152:155], a[200:203], v[88:91]
v_mul_f32_e64 v31, v31, v29
v_cvt_pk_bf16_f32 v25, v30, v31
v_mfma_f32_16x16x32_bf16 v[88:91], a[184:187], a[204:207], v[88:91]
v_lshlrev_b32_e64 v30, 16, v25
v_and_b32 v31, 0xffff0000, v25
v_mfma_f32_16x16x32_bf16 v[92:95], a[156:159], a[200:203], v[92:95]
v_add_f32 v26, v26, v30
v_add_f32 v26, v26, v31
v_mfma_f32_16x16x32_bf16 v[92:95], a[188:191], a[204:207], v[92:95]
v_accvgpr_read_b32 v25, a239
s_waitcnt lgkmcnt(0)
v_mfma_f32_16x16x32_bf16 v[96:99], a[208:211], a[128:131], v[96:99]
ds_read_b64_tr_b16 a[200:201], v21 offset:28720
ds_read_b64_tr_b16 a[202:203], v21 offset:30512
v_mfma_f32_16x16x32_bf16 v[96:99], a[212:215], a[160:163], v[96:99]
ds_read_b64_tr_b16 a[204:205], v21 offset:35888
ds_read_b64_tr_b16 a[206:207], v21 offset:37680
v_mfma_f32_16x16x32_bf16 v[100:103], a[208:211], a[132:135], v[100:103]
v_lshlrev_b32 v30, 16, v25
v_and_b32 v31, 0xffff0000, v25
v_mfma_f32_16x16x32_bf16 v[100:103], a[212:215], a[164:167], v[100:103]
v_mul_f32 v30, v30, v27
v_mul_f32 v31, v31, v29
v_mfma_f32_16x16x32_bf16 v[104:107], a[208:211], a[136:139], v[104:107]
v_cvt_pk_bf16_f32 v25, v30, v31
v_lshlrev_b32_e64 v30, 16, v25
v_mfma_f32_16x16x32_bf16 v[104:107], a[212:215], a[168:171], v[104:107]
v_and_b32 v31, 0xffff0000, v25
v_add_f32_e64 v28, v28, v30
v_mfma_f32_16x16x32_bf16 v[108:111], a[208:211], a[140:143], v[108:111]
v_add_f32_e64 v28, v28, v31
v_add_f32_dpp v26, v26, v26 row_ror:8 row_mask:0xf bank_mask:0xf
v_mfma_f32_16x16x32_bf16 v[108:111], a[212:215], a[172:175], v[108:111]
v_add_f32_dpp v28, v28, v28 row_ror:8 row_mask:0xf bank_mask:0xf
v_add_f32_dpp v26, v26, v26 row_ror:4 row_mask:0xf bank_mask:0xf
v_mfma_f32_16x16x32_bf16 v[112:115], a[208:211], a[144:147], v[112:115]
v_add_f32_dpp v28, v28, v28 row_ror:4 row_mask:0xf bank_mask:0xf
v_add_f32_dpp v26, v26, v26 row_ror:2 row_mask:0xf bank_mask:0xf
v_mfma_f32_16x16x32_bf16 v[112:115], a[212:215], a[176:179], v[112:115]
v_add_f32_dpp v28, v28, v28 row_ror:2 row_mask:0xf bank_mask:0xf
v_add_f32_dpp v26, v26, v26 row_ror:1 row_mask:0xf bank_mask:0xf
v_mfma_f32_16x16x32_bf16 v[116:119], a[208:211], a[148:151], v[116:119]
v_add_f32_dpp v28, v28, v28 row_ror:1 row_mask:0xf bank_mask:0xf
v_mov_b32_e64 v27, v26
v_mfma_f32_16x16x32_bf16 v[116:119], a[212:215], a[180:183], v[116:119]
v_mov_b32_e64 v29, v28
v_mfma_f32_16x16x32_bf16 v[120:123], a[208:211], a[152:155], v[120:123]
v_permlane16_swap_b32_e64 v26, v27
v_mfma_f32_16x16x32_bf16 v[120:123], a[212:215], a[184:187], v[120:123]
v_permlane16_swap_b32_e64 v28, v29
v_mfma_f32_16x16x32_bf16 v[124:127], a[208:211], a[156:159], v[124:127]
v_add_f32 v26, v26, v27
v_add_f32 v28, v28, v29
v_mfma_f32_16x16x32_bf16 v[124:127], a[212:215], a[188:191], v[124:127]
v_mov_b32_e64 v27, v26
v_mfma_f32_16x16x32_bf16 v[128:131], a[192:195], a[128:131], v[128:131]
ds_read_b64_tr_b16 a[208:209], v21 offset:43072
ds_read_b64_tr_b16 a[210:211], v21 offset:44864
v_mfma_f32_16x16x32_bf16 v[128:131], a[196:199], a[160:163], v[128:131]
ds_read_b64_tr_b16 a[212:213], v21 offset:50240
ds_read_b64_tr_b16 a[214:215], v21 offset:52032
v_mfma_f32_16x16x32_bf16 v[132:135], a[192:195], a[132:135], v[132:135]
v_mov_b32_e64 v29, v28
v_mfma_f32_16x16x32_bf16 v[132:135], a[196:199], a[164:167], v[132:135]
v_permlane32_swap_b32_e64 v26, v27
v_mfma_f32_16x16x32_bf16 v[136:139], a[192:195], a[136:139], v[136:139]
v_permlane32_swap_b32_e64 v28, v29
v_mfma_f32_16x16x32_bf16 v[136:139], a[196:199], a[168:171], v[136:139]
v_add_f32 v26, v26, v27
v_add_f32 v28, v28, v29
v_mfma_f32_16x16x32_bf16 v[140:143], a[192:195], a[140:143], v[140:143]
v_cvt_pk_bf16_f32 v25, v26, v28
v_lshlrev_b32_e64 v26, 16, v25
v_mfma_f32_16x16x32_bf16 v[140:143], a[196:199], a[172:175], v[140:143]
v_and_b32 v28, 0xffff0000, v25
v_mul_f32 v26, 0xbfb8aa3b, v26
v_mfma_f32_16x16x32_bf16 v[144:147], a[192:195], a[144:147], v[144:147]
v_mul_f32 v28, 0xbfb8aa3b, v28
v_mfma_f32_16x16x32_bf16 v[144:147], a[196:199], a[176:179], v[144:147]
v_exp_f32_e64 v26, v26
v_mfma_f32_16x16x32_bf16 v[148:151], a[192:195], a[148:151], v[148:151]
v_exp_f32_e64 v28, v28
v_mfma_f32_16x16x32_bf16 v[148:151], a[196:199], a[180:183], v[148:151]
v_add_f32 v26, 1.0, v26
v_add_f32 v28, 1.0, v28
v_mfma_f32_16x16x32_bf16 v[152:155], a[192:195], a[152:155], v[152:155]
v_rcp_f32_e64 v26, v26
v_mfma_f32_16x16x32_bf16 v[152:155], a[196:199], a[184:187], v[152:155]
v_rcp_f32_e64 v28, v28
v_mfma_f32_16x16x32_bf16 v[156:159], a[192:195], a[156:159], v[156:159]
v_cvt_pk_bf16_f32 v25, v26, v28
v_lshlrev_b32_e64 v26, 16, v25
v_mfma_f32_16x16x32_bf16 v[156:159], a[196:199], a[188:191], v[156:159]
v_and_b32 v28, 0xffff0000, v25
s_waitcnt lgkmcnt(0)
v_mfma_f32_16x16x32_bf16 v[160:163], a[200:203], a[128:131], v[160:163]
ds_read_b64_tr_b16 a[192:193], v21 offset:28752
ds_read_b64_tr_b16 a[194:195], v21 offset:30544
v_mfma_f32_16x16x32_bf16 v[160:163], a[204:207], a[160:163], v[160:163]
ds_read_b64_tr_b16 a[196:197], v21 offset:35920
ds_read_b64_tr_b16 a[198:199], v21 offset:37712
v_mfma_f32_16x16x32_bf16 v[164:167], a[200:203], a[132:135], v[164:167]
v_sub_f32 v27, 1.0, v26
v_sub_f32_e64 v29, 1.0, v28
v_mfma_f32_16x16x32_bf16 v[164:167], a[204:207], a[164:167], v[164:167]
v_cvt_pk_bf16_f32 v25, v27, v29
v_lshlrev_b32_e64 v27, 16, v25
v_mfma_f32_16x16x32_bf16 v[168:171], a[200:203], a[136:139], v[168:171]
v_and_b32 v29, 0xffff0000, v25
v_lshrrev_b32_e64 v26, 16, v26
v_mfma_f32_16x16x32_bf16 v[168:171], a[204:207], a[168:171], v[168:171]
v_lshrrev_b32 v28, 16, v28
v_or_b32 v26, v26, v27
v_mfma_f32_16x16x32_bf16 v[172:175], a[200:203], a[140:143], v[172:175]
v_or_b32 v28, v28, v29
v_mov_b32 v27, s75
v_mfma_f32_16x16x32_bf16 v[172:175], a[204:207], a[172:175], v[172:175]
v_mov_b32_e64 v29, s75
buffer_store_dwordx4 v[26:29], off, s[20:23], s70 sc1
v_mfma_f32_16x16x32_bf16 v[176:179], a[200:203], a[144:147], v[176:179]
v_accvgpr_read_b32 v2, a240
v_accvgpr_read_b32 v3, a241
v_mfma_f32_16x16x32_bf16 v[176:179], a[204:207], a[176:179], v[176:179]
v_accvgpr_read_b32 v4, a242
v_lshlrev_b32_e64 v2, 16, v2
v_mfma_f32_16x16x32_bf16 v[180:183], a[200:203], a[148:151], v[180:183]
v_lshlrev_b32 v3, 16, v3
v_lshlrev_b32 v4, 16, v4
v_mfma_f32_16x16x32_bf16 v[180:183], a[204:207], a[180:183], v[180:183]
v_mul_f32 v4, 0x3fb8aa3b, v4
v_mfma_f32_16x16x32_bf16 v[184:187], a[200:203], a[152:155], v[184:187]
v_exp_f32_e64 v4, v4
v_mfma_f32_16x16x32_bf16 v[184:187], a[204:207], a[184:187], v[184:187]
v_cvt_pk_bf16_f32 v4, v4, v4
v_lshlrev_b32_e64 v4, 16, v4
v_mfma_f32_16x16x32_bf16 v[188:191], a[200:203], a[156:159], v[188:191]
v_mul_f32 v10, v4, v2
v_mul_f32 v11, v4, v3
v_mfma_f32_16x16x32_bf16 v[188:191], a[204:207], a[188:191], v[188:191]
v_mul_f32 v10, 0x3fb8aa3b, v10
v_mfma_f32_16x16x32_bf16 v[192:195], a[208:211], a[128:131], v[192:195]
ds_read_b64_tr_b16 a[200:201], v21 offset:43104
ds_read_b64_tr_b16 a[202:203], v21 offset:44896
v_mfma_f32_16x16x32_bf16 v[192:195], a[212:215], a[160:163], v[192:195]
ds_read_b64_tr_b16 a[204:205], v21 offset:50272
ds_read_b64_tr_b16 a[206:207], v21 offset:52064
v_mfma_f32_16x16x32_bf16 v[196:199], a[208:211], a[132:135], v[196:199]
v_mul_f32_e64 v11, 0.15915494309189535, v11
v_mfma_f32_16x16x32_bf16 v[196:199], a[212:215], a[164:167], v[196:199]
v_exp_f32_e64 v10, v10
v_mfma_f32_16x16x32_bf16 v[200:203], a[208:211], a[136:139], v[200:203]
v_rndne_f32 v12, v11
v_sub_f32 v11, v11, v12
v_mfma_f32_16x16x32_bf16 v[200:203], a[212:215], a[168:171], v[200:203]
v_cos_f32_e64 v12, v11
v_mfma_f32_16x16x32_bf16 v[204:207], a[208:211], a[140:143], v[204:207]
v_sin_f32_e64 v13, v11
v_mfma_f32_16x16x32_bf16 v[204:207], a[212:215], a[172:175], v[204:207]
v_mul_f32 v6, v10, v12
v_mul_f32 v7, v10, v13
v_mfma_f32_16x16x32_bf16 v[208:211], a[208:211], a[144:147], v[208:211]
v_accvgpr_write_b32 a216, v6
v_accvgpr_write_b32 a217, v7
v_mfma_f32_16x16x32_bf16 v[208:211], a[212:215], a[176:179], v[208:211]
v_add_f32 v10, -1.0, v6
v_mul_f32 v11, v2, v2
v_mfma_f32_16x16x32_bf16 v[212:215], a[208:211], a[148:151], v[212:215]
v_fma_f32 v11, v3, v3, v11
v_mfma_f32_16x16x32_bf16 v[212:215], a[212:215], a[180:183], v[212:215]
v_rcp_f32_e64 v11, v11
v_mfma_f32_16x16x32_bf16 v[216:219], a[208:211], a[152:155], v[216:219]
v_mul_f32 v12, v10, v2
v_mul_f32 v13, v7, v2
v_mfma_f32_16x16x32_bf16 v[216:219], a[212:215], a[184:187], v[216:219]
v_fma_f32 v12, v7, v3, v12
v_fma_f32 v13, -v10, v3, v13
v_mfma_f32_16x16x32_bf16 v[220:223], a[208:211], a[156:159], v[220:223]
v_add_f32 v11, v11, v11
v_mul_f32 v12, v12, v11
v_mfma_f32_16x16x32_bf16 v[220:223], a[212:215], a[188:191], v[220:223]
v_mul_f32 v13, v13, v11
s_waitcnt lgkmcnt(0)
v_mfma_f32_16x16x32_bf16 v[224:227], a[192:195], a[128:131], v[224:227]
ds_read_b64_tr_b16 a[208:209], v22 offset:28688
ds_read_b64_tr_b16 a[210:211], v22 offset:30480
v_mfma_f32_16x16x32_bf16 v[224:227], a[196:199], a[160:163], v[224:227]
ds_read_b64_tr_b16 a[212:213], v22 offset:35856
ds_read_b64_tr_b16 a[214:215], v22 offset:37648
v_mfma_f32_16x16x32_bf16 v[228:231], a[192:195], a[132:135], v[228:231]
v_accvgpr_write_b32 a218, v12
v_accvgpr_write_b32 a219, v13
v_mfma_f32_16x16x32_bf16 v[228:231], a[196:199], a[164:167], v[228:231]
v_mul_f32 v8, v6, v6
v_mul_f32 v9, v6, v7
v_mfma_f32_16x16x32_bf16 v[232:235], a[192:195], a[136:139], v[232:235]
v_fma_f32 v8, -v7, v7, v8
v_add_f32_e64 v9, v9, v9
v_mfma_f32_16x16x32_bf16 v[232:235], a[196:199], a[168:171], v[232:235]
v_mul_f32 v6, v8, v8
v_mul_f32 v7, v8, v9
v_mfma_f32_16x16x32_bf16 v[236:239], a[192:195], a[140:143], v[236:239]
v_fma_f32 v6, -v9, v9, v6
v_add_f32_e64 v7, v7, v7
v_mfma_f32_16x16x32_bf16 v[236:239], a[196:199], a[172:175], v[236:239]
v_mul_f32 v8, v6, v6
v_mul_f32 v9, v6, v7
v_mfma_f32_16x16x32_bf16 v[240:243], a[192:195], a[144:147], v[240:243]
v_fma_f32 v8, -v7, v7, v8
v_add_f32_e64 v9, v9, v9
v_mfma_f32_16x16x32_bf16 v[240:243], a[196:199], a[176:179], v[240:243]
v_mul_f32 v6, v8, v8
v_mul_f32 v7, v8, v9
v_mfma_f32_16x16x32_bf16 v[244:247], a[192:195], a[148:151], v[244:247]
v_fma_f32 v6, -v9, v9, v6
v_add_f32_e64 v7, v7, v7
v_mfma_f32_16x16x32_bf16 v[244:247], a[196:199], a[180:183], v[244:247]
v_accvgpr_write_b32 a220, v6
v_accvgpr_write_b32 a221, v7
v_mfma_f32_16x16x32_bf16 v[248:251], a[192:195], a[152:155], v[248:251]
v_mul_f32 v8, v6, v6
v_mul_f32 v9, v6, v7
v_mfma_f32_16x16x32_bf16 v[248:251], a[196:199], a[184:187], v[248:251]
v_fma_f32 v8, -v7, v7, v8
v_add_f32_e64 v9, v9, v9
v_mfma_f32_16x16x32_bf16 v[252:255], a[192:195], a[156:159], v[252:255]
v_accvgpr_write_b32 a222, v8
v_accvgpr_write_b32 a223, v9
v_mfma_f32_16x16x32_bf16 v[252:255], a[196:199], a[188:191], v[252:255]
v_mul_f32_e64 v6, v8, v8
v_mfma_f32_16x16x32_bf16 a[0:3], a[200:203], a[128:131], a[0:3]
v_mul_f32_e64 v7, v8, v9
v_fma_f32 v6, -v9, v9, v6
v_mfma_f32_16x16x32_bf16 a[0:3], a[204:207], a[160:163], a[0:3]
v_add_f32 v7, v7, v7
v_mul_f32 v8, v6, v6
v_mfma_f32_16x16x32_bf16 a[4:7], a[200:203], a[132:135], a[4:7]
v_mul_f32_e64 v9, v6, v7
v_fma_f32 v8, -v7, v7, v8
v_mfma_f32_16x16x32_bf16 a[4:7], a[204:207], a[164:167], a[4:7]
v_add_f32 v9, v9, v9
v_mul_f32 v6, v8, v8
v_mfma_f32_16x16x32_bf16 a[8:11], a[200:203], a[136:139], a[8:11]
v_mul_f32_e64 v7, v8, v9
v_fma_f32 v6, -v9, v9, v6
v_mfma_f32_16x16x32_bf16 a[8:11], a[204:207], a[168:171], a[8:11]
v_add_f32_e64 v7, v7, v7
v_accvgpr_write_b32 a224, v6
v_mfma_f32_16x16x32_bf16 a[12:15], a[200:203], a[140:143], a[12:15]
v_accvgpr_write_b32 a225, v7
v_accvgpr_read_b32 v2, a243
v_mfma_f32_16x16x32_bf16 a[12:15], a[204:207], a[172:175], a[12:15]
v_accvgpr_read_b32 v3, a244
v_accvgpr_read_b32 v4, a245
v_mfma_f32_16x16x32_bf16 a[16:19], a[200:203], a[144:147], a[16:19]
v_lshlrev_b32 v2, 16, v2
v_lshlrev_b32 v3, 16, v3
v_mfma_f32_16x16x32_bf16 a[16:19], a[204:207], a[176:179], a[16:19]
v_lshlrev_b32_e64 v4, 16, v4
v_mul_f32 v4, 0x3fb8aa3b, v4
v_mfma_f32_16x16x32_bf16 a[20:23], a[200:203], a[148:151], a[20:23]
v_exp_f32_e64 v4, v4
v_mfma_f32_16x16x32_bf16 a[20:23], a[204:207], a[180:183], a[20:23]
v_cvt_pk_bf16_f32 v4, v4, v4
v_lshlrev_b32_e64 v4, 16, v4
v_mfma_f32_16x16x32_bf16 a[24:27], a[200:203], a[152:155], a[24:27]
v_mul_f32 v10, v4, v2
v_mul_f32 v11, v4, v3
v_mfma_f32_16x16x32_bf16 a[24:27], a[204:207], a[184:187], a[24:27]
v_mul_f32 v10, 0x3fb8aa3b, v10
v_mul_f32_e64 v11, 0.15915494309189535, v11
v_mfma_f32_16x16x32_bf16 a[28:31], a[200:203], a[156:159], a[28:31]
v_exp_f32_e64 v10, v10
v_mfma_f32_16x16x32_bf16 a[28:31], a[204:207], a[188:191], a[28:31]
v_rndne_f32 v12, v11
s_waitcnt lgkmcnt(0)
v_mfma_f32_16x16x32_bf16 a[32:35], a[208:211], a[128:131], a[32:35]
v_sub_f32_e64 v11, v11, v12
v_mfma_f32_16x16x32_bf16 a[32:35], a[212:215], a[160:163], a[32:35]
v_cos_f32_e64 v12, v11
v_mfma_f32_16x16x32_bf16 a[36:39], a[208:211], a[132:135], a[36:39]
v_sin_f32_e64 v13, v11
v_mfma_f32_16x16x32_bf16 a[36:39], a[212:215], a[164:167], a[36:39]
v_mul_f32 v6, v10, v12
v_mul_f32 v7, v10, v13
v_mfma_f32_16x16x32_bf16 a[40:43], a[208:211], a[136:139], a[40:43]
v_mul_f32 v8, v6, v6
v_mul_f32 v9, v6, v7
v_mfma_f32_16x16x32_bf16 a[40:43], a[212:215], a[168:171], a[40:43]
v_fma_f32 v8, -v7, v7, v8
v_add_f32_e64 v9, v9, v9
v_mfma_f32_16x16x32_bf16 a[44:47], a[208:211], a[140:143], a[44:47]
v_mul_f32 v6, v8, v8
v_mul_f32 v7, v8, v9
v_mfma_f32_16x16x32_bf16 a[44:47], a[212:215], a[172:175], a[44:47]
v_fma_f32 v6, -v9, v9, v6
v_add_f32_e64 v7, v7, v7
v_mfma_f32_16x16x32_bf16 a[48:51], a[208:211], a[144:147], a[48:51]
v_mul_f32 v8, v6, v6
v_mul_f32 v9, v6, v7
v_mfma_f32_16x16x32_bf16 a[48:51], a[212:215], a[176:179], a[48:51]
v_fma_f32 v8, -v7, v7, v8
v_add_f32_e64 v9, v9, v9
v_mfma_f32_16x16x32_bf16 a[52:55], a[208:211], a[148:151], a[52:55]
v_mul_f32 v6, v8, v8
v_mul_f32 v7, v8, v9
v_mfma_f32_16x16x32_bf16 a[52:55], a[212:215], a[180:183], a[52:55]
v_fma_f32 v6, -v9, v9, v6
v_add_f32_e64 v7, v7, v7
v_mfma_f32_16x16x32_bf16 a[56:59], a[208:211], a[152:155], a[56:59]
v_mul_f32 v8, v6, v6
v_mul_f32 v9, v6, v7
v_mfma_f32_16x16x32_bf16 a[56:59], a[212:215], a[184:187], a[56:59]
v_fma_f32 v8, -v7, v7, v8
v_add_f32_e64 v9, v9, v9
v_mfma_f32_16x16x32_bf16 a[60:63], a[208:211], a[156:159], a[60:63]
v_accvgpr_write_b32 a226, v8
v_mfma_f32_16x16x32_bf16 a[60:63], a[212:215], a[188:191], a[60:63]
v_accvgpr_write_b32 a227, v9
s_waitcnt lgkmcnt(0)
v_accvgpr_read_b32 v2, a216
v_accvgpr_read_b32 v3, a217
v_accvgpr_read_b32 v4, a220
v_accvgpr_read_b32 v5, a221
v_and_b32 v25, 15, v0
v_lshrrev_b32_e64 v26, 4, v0
v_pk_fma_f32 v[6:7], v[32:33], v[2:3], v[34:35] op_sel:[0,0,0] op_sel_hi:[1,0,1]
v_pk_fma_f32 v[8:9], v[64:65], v[2:3], v[66:67] op_sel:[0,0,0] op_sel_hi:[1,0,1]
v_pk_fma_f32 v[6:7], v[64:65], v[2:3], v[6:7] op_sel:[0,1,0] op_sel_hi:[1,1,1] neg_lo:[0,1,0] neg_hi:[0,1,0]
v_pk_fma_f32 v[8:9], v[32:33], v[2:3], v[8:9] op_sel:[0,1,0] op_sel_hi:[1,1,1]
v_pk_fma_f32 v[12:13], v[6:7], v[2:3], v[36:37] op_sel:[0,0,0] op_sel_hi:[1,0,1]
v_pk_fma_f32 v[14:15], v[8:9], v[2:3], v[68:69] op_sel:[0,0,0] op_sel_hi:[1,0,1]
v_pk_fma_f32 v[12:13], v[8:9], v[2:3], v[12:13] op_sel:[0,1,0] op_sel_hi:[1,1,1] neg_lo:[0,1,0] neg_hi:[0,1,0]
v_pk_fma_f32 v[14:15], v[6:7], v[2:3], v[14:15] op_sel:[0,1,0] op_sel_hi:[1,1,1]
v_pk_fma_f32 v[6:7], v[12:13], v[2:3], v[38:39] op_sel:[0,0,0] op_sel_hi:[1,0,1]
v_pk_fma_f32 v[8:9], v[14:15], v[2:3], v[70:71] op_sel:[0,0,0] op_sel_hi:[1,0,1]
v_pk_fma_f32 v[6:7], v[14:15], v[2:3], v[6:7] op_sel:[0,1,0] op_sel_hi:[1,1,1] neg_lo:[0,1,0] neg_hi:[0,1,0]
v_pk_fma_f32 v[8:9], v[12:13], v[2:3], v[8:9] op_sel:[0,1,0] op_sel_hi:[1,1,1]
v_pk_fma_f32 v[12:13], v[6:7], v[2:3], v[40:41] op_sel:[0,0,0] op_sel_hi:[1,0,1]
v_pk_fma_f32 v[14:15], v[8:9], v[2:3], v[72:73] op_sel:[0,0,0] op_sel_hi:[1,0,1]
v_pk_fma_f32 v[12:13], v[8:9], v[2:3], v[12:13] op_sel:[0,1,0] op_sel_hi:[1,1,1] neg_lo:[0,1,0] neg_hi:[0,1,0]
v_pk_fma_f32 v[14:15], v[6:7], v[2:3], v[14:15] op_sel:[0,1,0] op_sel_hi:[1,1,1]
v_pk_fma_f32 v[6:7], v[12:13], v[2:3], v[42:43] op_sel:[0,0,0] op_sel_hi:[1,0,1]
v_pk_fma_f32 v[8:9], v[14:15], v[2:3], v[74:75] op_sel:[0,0,0] op_sel_hi:[1,0,1]
v_pk_fma_f32 v[6:7], v[14:15], v[2:3], v[6:7] op_sel:[0,1,0] op_sel_hi:[1,1,1] neg_lo:[0,1,0] neg_hi:[0,1,0]
v_pk_fma_f32 v[8:9], v[12:13], v[2:3], v[8:9] op_sel:[0,1,0] op_sel_hi:[1,1,1]
v_pk_fma_f32 v[12:13], v[6:7], v[2:3], v[44:45] op_sel:[0,0,0] op_sel_hi:[1,0,1]
v_pk_fma_f32 v[14:15], v[8:9], v[2:3], v[76:77] op_sel:[0,0,0] op_sel_hi:[1,0,1]
v_pk_fma_f32 v[12:13], v[8:9], v[2:3], v[12:13] op_sel:[0,1,0] op_sel_hi:[1,1,1] neg_lo:[0,1,0] neg_hi:[0,1,0]
v_pk_fma_f32 v[14:15], v[6:7], v[2:3], v[14:15] op_sel:[0,1,0] op_sel_hi:[1,1,1]
v_pk_fma_f32 v[6:7], v[12:13], v[2:3], v[46:47] op_sel:[0,0,0] op_sel_hi:[1,0,1]
v_pk_fma_f32 v[8:9], v[14:15], v[2:3], v[78:79] op_sel:[0,0,0] op_sel_hi:[1,0,1]
v_pk_fma_f32 v[6:7], v[14:15], v[2:3], v[6:7] op_sel:[0,1,0] op_sel_hi:[1,1,1] neg_lo:[0,1,0] neg_hi:[0,1,0]
v_pk_fma_f32 v[8:9], v[12:13], v[2:3], v[8:9] op_sel:[0,1,0] op_sel_hi:[1,1,1]
v_pk_fma_f32 v[12:13], v[6:7], v[2:3], v[48:49] op_sel:[0,0,0] op_sel_hi:[1,0,1]
v_pk_fma_f32 v[14:15], v[8:9], v[2:3], v[80:81] op_sel:[0,0,0] op_sel_hi:[1,0,1]
v_pk_fma_f32 v[12:13], v[8:9], v[2:3], v[12:13] op_sel:[0,1,0] op_sel_hi:[1,1,1] neg_lo:[0,1,0] neg_hi:[0,1,0]
v_pk_fma_f32 v[14:15], v[6:7], v[2:3], v[14:15] op_sel:[0,1,0] op_sel_hi:[1,1,1]
v_pk_fma_f32 v[6:7], v[12:13], v[2:3], v[50:51] op_sel:[0,0,0] op_sel_hi:[1,0,1]
v_pk_fma_f32 v[8:9], v[14:15], v[2:3], v[82:83] op_sel:[0,0,0] op_sel_hi:[1,0,1]
v_pk_fma_f32 v[6:7], v[14:15], v[2:3], v[6:7] op_sel:[0,1,0] op_sel_hi:[1,1,1] neg_lo:[0,1,0] neg_hi:[0,1,0]
v_pk_fma_f32 v[8:9], v[12:13], v[2:3], v[8:9] op_sel:[0,1,0] op_sel_hi:[1,1,1]
v_pk_fma_f32 v[12:13], v[6:7], v[2:3], v[52:53] op_sel:[0,0,0] op_sel_hi:[1,0,1]
v_pk_fma_f32 v[14:15], v[8:9], v[2:3], v[84:85] op_sel:[0,0,0] op_sel_hi:[1,0,1]
v_pk_fma_f32 v[12:13], v[8:9], v[2:3], v[12:13] op_sel:[0,1,0] op_sel_hi:[1,1,1] neg_lo:[0,1,0] neg_hi:[0,1,0]
v_pk_fma_f32 v[14:15], v[6:7], v[2:3], v[14:15] op_sel:[0,1,0] op_sel_hi:[1,1,1]
v_pk_fma_f32 v[6:7], v[12:13], v[2:3], v[54:55] op_sel:[0,0,0] op_sel_hi:[1,0,1]
v_pk_fma_f32 v[8:9], v[14:15], v[2:3], v[86:87] op_sel:[0,0,0] op_sel_hi:[1,0,1]
v_pk_fma_f32 v[6:7], v[14:15], v[2:3], v[6:7] op_sel:[0,1,0] op_sel_hi:[1,1,1] neg_lo:[0,1,0] neg_hi:[0,1,0]
v_pk_fma_f32 v[8:9], v[12:13], v[2:3], v[8:9] op_sel:[0,1,0] op_sel_hi:[1,1,1]
v_pk_fma_f32 v[12:13], v[6:7], v[2:3], v[56:57] op_sel:[0,0,0] op_sel_hi:[1,0,1]
v_pk_fma_f32 v[14:15], v[8:9], v[2:3], v[88:89] op_sel:[0,0,0] op_sel_hi:[1,0,1]
v_pk_fma_f32 v[12:13], v[8:9], v[2:3], v[12:13] op_sel:[0,1,0] op_sel_hi:[1,1,1] neg_lo:[0,1,0] neg_hi:[0,1,0]
v_pk_fma_f32 v[14:15], v[6:7], v[2:3], v[14:15] op_sel:[0,1,0] op_sel_hi:[1,1,1]
v_pk_fma_f32 v[6:7], v[12:13], v[2:3], v[58:59] op_sel:[0,0,0] op_sel_hi:[1,0,1]
v_pk_fma_f32 v[8:9], v[14:15], v[2:3], v[90:91] op_sel:[0,0,0] op_sel_hi:[1,0,1]
v_pk_fma_f32 v[6:7], v[14:15], v[2:3], v[6:7] op_sel:[0,1,0] op_sel_hi:[1,1,1] neg_lo:[0,1,0] neg_hi:[0,1,0]
v_pk_fma_f32 v[8:9], v[12:13], v[2:3], v[8:9] op_sel:[0,1,0] op_sel_hi:[1,1,1]
v_pk_fma_f32 v[12:13], v[6:7], v[2:3], v[60:61] op_sel:[0,0,0] op_sel_hi:[1,0,1]
v_pk_fma_f32 v[14:15], v[8:9], v[2:3], v[92:93] op_sel:[0,0,0] op_sel_hi:[1,0,1]
v_pk_fma_f32 v[12:13], v[8:9], v[2:3], v[12:13] op_sel:[0,1,0] op_sel_hi:[1,1,1] neg_lo:[0,1,0] neg_hi:[0,1,0]
v_pk_fma_f32 v[14:15], v[6:7], v[2:3], v[14:15] op_sel:[0,1,0] op_sel_hi:[1,1,1]
v_pk_fma_f32 v[6:7], v[12:13], v[2:3], v[62:63] op_sel:[0,0,0] op_sel_hi:[1,0,1]
v_pk_fma_f32 v[8:9], v[14:15], v[2:3], v[94:95] op_sel:[0,0,0] op_sel_hi:[1,0,1]
v_pk_fma_f32 v[6:7], v[14:15], v[2:3], v[6:7] op_sel:[0,1,0] op_sel_hi:[1,1,1] neg_lo:[0,1,0] neg_hi:[0,1,0]
v_pk_fma_f32 v[8:9], v[12:13], v[2:3], v[8:9] op_sel:[0,1,0] op_sel_hi:[1,1,1]
v_mov_b32 v10, v6
v_mov_b32 v11, v8
v_fma_f32 v12, v4, v6, v7
v_fma_f32 v13, v4, v8, v9
v_fma_f32 v12, -v5, v8, v12
v_fma_f32 v13, v5, v6, v13
s_lshl_b32 s66, s6, 10
s_lshl_b32 s67, s7, 7
s_add_u32 s66, s66, s67
s_add_u32 s66, s66, 149504
v_lshlrev_b32 v27, 8, v26
v_lshl_add_u32 v27, v25, 3, v27
v_add_u32_e64 v27, s66, v27
ds_write_b64 v27, v[12:13]
s_lshl_b32 s66, s4, 12
s_lshl_b32 s67, s6, 11
s_add_u32 s70, s66, s67
s_add_u32 s70, s70, 4096
s_mul_i32 s66, s5, 14
s_mul_i32 s67, s7, 7
s_add_u32 s66, s66, s67
s_add_u32 s66, s66, 256
s_lshl_b32 s66, s66, 15
s_add_u32 s71, s70, s66
v_lshrrev_b32 v28, 1, v26
v_and_b32 v29, 1, v26
v_lshlrev_b32_e64 v1, 15, v28
v_lshl_add_u32 v1, v29, 8, v1
v_lshl_add_u32 v1, v25, 4, v1
v_add_u32_e64 v16, s71, v1
v_lshl_add_u32 v1, v29, 1, v28
v_lshlrev_b32_e64 v1, 8, v1
v_lshl_add_u32 v1, v25, 4, v1
v_add_u32_e64 v1, s71, v1
v_add_u32 v17, 196608, v1
s_lshl_b32 s66, s5, 2
s_lshl_b32 s67, s7, 1
s_add_u32 s66, s66, s67
s_lshl_b32 s66, s66, 15
s_add_u32 s72, s70, s66
v_lshl_add_u32 v1, v28, 7, v29
v_lshlrev_b32 v1, 15, v1
v_lshl_add_u32 v1, v25, 4, v1
v_add_u32_e64 v18, s72, v1
v_mov_b32 v30, 0xc0135761
v_mov_b32 v31, 0xbdd2d3e8
v_mov_b32 v19, s75
s_lshl_b32 s66, s99, 4
s_lshl_b32 s67, s3, 2
s_add_u32 s66, s66, s67
v_and_b32 v27, 7, v0
v_lshlrev_b32 v27, 9, v27
v_add_u32 v24, s66, v27
s_waitcnt lgkmcnt(0)
s_barrier
s_cmp_eq_u32 s4, 7
s_cselect_b32 s73, 1, s3
s_cmp_lg_u32 s73, 0
s_cbranch_scc1 KF_nopub
v_and_b32 v1, 31, v0
v_lshlrev_b32_e64 v1, 3, v1
v_add_u32 v27, 149504, v1
ds_read_b64 v[6:7], v27
ds_read_b64 v[12:13], v27 offset:256
ds_read_b64 v[14:15], v27 offset:512
ds_read_b64 v[20:21], v27 offset:768
ds_read_b64 v[22:23], v27 offset:1024
v_accvgpr_read_b32 v28, a226
v_accvgpr_read_b32 v29, a227
s_waitcnt lgkmcnt(3)
v_fma_f32 v8, v28, v6, v12
v_fma_f32 v9, v28, v7, v13
v_fma_f32 v8, -v29, v7, v8
v_fma_f32 v9, v29, v6, v9
ds_read_b64 v[12:13], v27 offset:1280
s_waitcnt lgkmcnt(3)
v_fma_f32 v6, v28, v8, v14
v_fma_f32 v7, v28, v9, v15
v_fma_f32 v6, -v29, v9, v6
v_fma_f32 v7, v29, v8, v7
ds_read_b64 v[14:15], v27 offset:1536
s_waitcnt lgkmcnt(3)
v_fma_f32 v8, v28, v6, v20
v_fma_f32 v9, v28, v7, v21
v_fma_f32 v8, -v29, v7, v8
v_fma_f32 v9, v29, v6, v9
ds_read_b64 v[20:21], v27 offset:1792
s_waitcnt lgkmcnt(3)
v_fma_f32 v6, v28, v8, v22
v_fma_f32 v7, v28, v9, v23
v_fma_f32 v6, -v29, v9, v6
v_fma_f32 v7, v29, v8, v7
s_waitcnt lgkmcnt(2)
v_fma_f32 v8, v28, v6, v12
v_fma_f32 v9, v28, v7, v13
v_fma_f32 v8, -v29, v7, v8
v_fma_f32 v9, v29, v6, v9
s_waitcnt lgkmcnt(1)
v_fma_f32 v6, v28, v8, v14
v_fma_f32 v7, v28, v9, v15
v_fma_f32 v6, -v29, v9, v6
v_fma_f32 v7, v29, v8, v7
s_waitcnt lgkmcnt(0)
v_fma_f32 v8, v28, v6, v20
v_fma_f32 v9, v28, v7, v21
v_fma_f32 v8, -v29, v7, v8
v_fma_f32 v9, v29, v6, v9
s_lshl_b32 s66, s4, 14
s_lshl_b32 s67, s5, 9
s_add_u32 s66, s66, s67
v_mov_b32 v12, v8
v_mov_b32 v13, s75
v_mov_b32 v14, v9
v_mov_b32 v15, s75
v_lshlrev_b32_e64 v1, 1, v1
buffer_store_dwordx4 v[12:15], v1, s[28:31], s66 offen sc1
s_nop 1
KF_nopub:
s_mov_b32 s74, 0
v_pk_mul_f32 v[6:7], v[96:97], v[96:97]
v_pk_mul_f32 v[8:9], v[98:99], v[98:99]
v_pk_mul_f32 v[12:13], v[100:101], v[100:101]
v_pk_mul_f32 v[14:15], v[102:103], v[102:103]
v_pk_fma_f32 v[6:7], v[6:7], v[30:31], v[30:31] op_sel:[0,1,0] op_sel_hi:[1,1,0]
v_pk_fma_f32 v[8:9], v[8:9], v[30:31], v[30:31] op_sel:[0,1,0] op_sel_hi:[1,1,0]
v_pk_fma_f32 v[12:13], v[12:13], v[30:31], v[30:31] op_sel:[0,1,0] op_sel_hi:[1,1,0]
v_pk_fma_f32 v[14:15], v[14:15], v[30:31], v[30:31] op_sel:[0,1,0] op_sel_hi:[1,1,0]
v_pk_mul_f32 v[6:7], v[6:7], v[96:97]
v_pk_mul_f32 v[8:9], v[8:9], v[98:99]
v_pk_mul_f32 v[12:13], v[12:13], v[100:101]
v_pk_mul_f32 v[14:15], v[14:15], v[102:103]
v_exp_f32_e64 v6, v6
v_exp_f32_e64 v7, v7
v_exp_f32_e64 v8, v8
v_exp_f32_e64 v9, v9
v_exp_f32_e64 v12, v12
v_exp_f32_e64 v13, v13
v_exp_f32_e64 v14, v14
v_exp_f32_e64 v15, v15
v_pk_add_f32 v[6:7], v[6:7], 1.0 op_sel_hi:[1,0]
v_pk_add_f32 v[8:9], v[8:9], 1.0 op_sel_hi:[1,0]
v_pk_add_f32 v[12:13], v[12:13], 1.0 op_sel_hi:[1,0]
v_pk_add_f32 v[14:15], v[14:15], 1.0 op_sel_hi:[1,0]
v_rcp_f32_e64 v6, v6
v_rcp_f32_e64 v7, v7
v_rcp_f32_e64 v8, v8
v_rcp_f32_e64 v9, v9
v_rcp_f32_e64 v12, v12
v_rcp_f32_e64 v13, v13
v_rcp_f32_e64 v14, v14
v_rcp_f32_e64 v15, v15
v_pk_mul_f32 v[128:129], v[128:129], v[96:97]
v_pk_mul_f32 v[130:131], v[130:131], v[98:99]
v_pk_mul_f32 v[132:133], v[132:133], v[100:101]
v_pk_mul_f32 v[134:135], v[134:135], v[102:103]
v_pk_mul_f32 v[128:129], v[128:129], v[6:7]
v_pk_mul_f32 v[130:131], v[130:131], v[8:9]
v_pk_mul_f32 v[132:133], v[132:133], v[12:13]
v_pk_mul_f32 v[134:135], v[134:135], v[14:15]
v_cvt_pk_bf16_f32 v96, v128, v129
v_cvt_pk_bf16_f32 v97, v130, v131
v_cvt_pk_bf16_f32 v98, v132, v133
v_cvt_pk_bf16_f32 v99, v134, v135
s_nop 1
v_permlane16_swap_b32 v96, v98
v_permlane16_swap_b32_e64 v97, v99
buffer_store_dwordx4 v[96:99], v16, s[20:23], s74 offen offset:0 sc1
v_pk_mul_f32 v[6:7], v[104:105], v[104:105]
v_pk_mul_f32 v[8:9], v[106:107], v[106:107]
v_pk_mul_f32 v[12:13], v[108:109], v[108:109]
v_pk_mul_f32 v[14:15], v[110:111], v[110:111]
v_pk_fma_f32 v[6:7], v[6:7], v[30:31], v[30:31] op_sel:[0,1,0] op_sel_hi:[1,1,0]
v_pk_fma_f32 v[8:9], v[8:9], v[30:31], v[30:31] op_sel:[0,1,0] op_sel_hi:[1,1,0]
v_pk_fma_f32 v[12:13], v[12:13], v[30:31], v[30:31] op_sel:[0,1,0] op_sel_hi:[1,1,0]
v_pk_fma_f32 v[14:15], v[14:15], v[30:31], v[30:31] op_sel:[0,1,0] op_sel_hi:[1,1,0]
v_pk_mul_f32 v[6:7], v[6:7], v[104:105]
v_pk_mul_f32 v[8:9], v[8:9], v[106:107]
v_pk_mul_f32 v[12:13], v[12:13], v[108:109]
v_pk_mul_f32 v[14:15], v[14:15], v[110:111]
v_exp_f32_e64 v6, v6
v_exp_f32_e64 v7, v7
v_exp_f32_e64 v8, v8
v_exp_f32_e64 v9, v9
v_exp_f32_e64 v12, v12
v_exp_f32_e64 v13, v13
v_exp_f32_e64 v14, v14
v_exp_f32_e64 v15, v15
v_pk_add_f32 v[6:7], v[6:7], 1.0 op_sel_hi:[1,0]
v_pk_add_f32 v[8:9], v[8:9], 1.0 op_sel_hi:[1,0]
v_pk_add_f32 v[12:13], v[12:13], 1.0 op_sel_hi:[1,0]
v_pk_add_f32 v[14:15], v[14:15], 1.0 op_sel_hi:[1,0]
v_rcp_f32_e64 v6, v6
v_rcp_f32_e64 v7, v7
v_rcp_f32_e64 v8, v8
v_rcp_f32_e64 v9, v9
v_rcp_f32_e64 v12, v12
v_rcp_f32_e64 v13, v13
v_rcp_f32_e64 v14, v14
v_rcp_f32_e64 v15, v15
v_pk_mul_f32 v[136:137], v[136:137], v[104:105]
v_pk_mul_f32 v[138:139], v[138:139], v[106:107]
v_pk_mul_f32 v[140:141], v[140:141], v[108:109]
v_pk_mul_f32 v[142:143], v[142:143], v[110:111]
v_pk_mul_f32 v[136:137], v[136:137], v[6:7]
v_pk_mul_f32 v[138:139], v[138:139], v[8:9]
v_pk_mul_f32 v[140:141], v[140:141], v[12:13]
v_pk_mul_f32 v[142:143], v[142:143], v[14:15]
v_cvt_pk_bf16_f32 v104, v136, v137
v_cvt_pk_bf16_f32 v105, v138, v139
v_cvt_pk_bf16_f32 v106, v140, v141
v_cvt_pk_bf16_f32 v107, v142, v143
s_nop 1
v_permlane16_swap_b32 v104, v106
v_permlane16_swap_b32_e64 v105, v107
buffer_store_dwordx4 v[104:107], v16, s[20:23], s74 offen offset:512 sc1
v_pk_mul_f32 v[6:7], v[112:113], v[112:113]
v_pk_mul_f32 v[8:9], v[114:115], v[114:115]
v_pk_mul_f32 v[12:13], v[116:117], v[116:117]
v_pk_mul_f32 v[14:15], v[118:119], v[118:119]
v_pk_fma_f32 v[6:7], v[6:7], v[30:31], v[30:31] op_sel:[0,1,0] op_sel_hi:[1,1,0]
v_pk_fma_f32 v[8:9], v[8:9], v[30:31], v[30:31] op_sel:[0,1,0] op_sel_hi:[1,1,0]
v_pk_fma_f32 v[12:13], v[12:13], v[30:31], v[30:31] op_sel:[0,1,0] op_sel_hi:[1,1,0]
v_pk_fma_f32 v[14:15], v[14:15], v[30:31], v[30:31] op_sel:[0,1,0] op_sel_hi:[1,1,0]
v_pk_mul_f32 v[6:7], v[6:7], v[112:113]
v_pk_mul_f32 v[8:9], v[8:9], v[114:115]
v_pk_mul_f32 v[12:13], v[12:13], v[116:117]
v_pk_mul_f32 v[14:15], v[14:15], v[118:119]
v_exp_f32_e64 v6, v6
v_exp_f32_e64 v7, v7
v_exp_f32_e64 v8, v8
v_exp_f32_e64 v9, v9
v_exp_f32_e64 v12, v12
v_exp_f32_e64 v13, v13
v_exp_f32_e64 v14, v14
v_exp_f32_e64 v15, v15
v_pk_add_f32 v[6:7], v[6:7], 1.0 op_sel_hi:[1,0]
v_pk_add_f32 v[8:9], v[8:9], 1.0 op_sel_hi:[1,0]
v_pk_add_f32 v[12:13], v[12:13], 1.0 op_sel_hi:[1,0]
v_pk_add_f32 v[14:15], v[14:15], 1.0 op_sel_hi:[1,0]
v_rcp_f32_e64 v6, v6
v_rcp_f32_e64 v7, v7
v_rcp_f32_e64 v8, v8
v_rcp_f32_e64 v9, v9
v_rcp_f32_e64 v12, v12
v_rcp_f32_e64 v13, v13
v_rcp_f32_e64 v14, v14
v_rcp_f32_e64 v15, v15
v_pk_mul_f32 v[144:145], v[144:145], v[112:113]
v_pk_mul_f32 v[146:147], v[146:147], v[114:115]
v_pk_mul_f32 v[148:149], v[148:149], v[116:117]
v_pk_mul_f32 v[150:151], v[150:151], v[118:119]
v_pk_mul_f32 v[144:145], v[144:145], v[6:7]
v_pk_mul_f32 v[146:147], v[146:147], v[8:9]
v_pk_mul_f32 v[148:149], v[148:149], v[12:13]
v_pk_mul_f32 v[150:151], v[150:151], v[14:15]
v_cvt_pk_bf16_f32 v112, v144, v145
v_cvt_pk_bf16_f32 v113, v146, v147
v_cvt_pk_bf16_f32 v114, v148, v149
v_cvt_pk_bf16_f32 v115, v150, v151
s_nop 1
v_permlane16_swap_b32 v112, v114
v_permlane16_swap_b32_e64 v113, v115
buffer_store_dwordx4 v[112:115], v16, s[20:23], s74 offen offset:1024 sc1
v_pk_mul_f32 v[6:7], v[120:121], v[120:121]
v_pk_mul_f32 v[8:9], v[122:123], v[122:123]
v_pk_mul_f32 v[12:13], v[124:125], v[124:125]
v_pk_mul_f32 v[14:15], v[126:127], v[126:127]
v_pk_fma_f32 v[6:7], v[6:7], v[30:31], v[30:31] op_sel:[0,1,0] op_sel_hi:[1,1,0]
v_pk_fma_f32 v[8:9], v[8:9], v[30:31], v[30:31] op_sel:[0,1,0] op_sel_hi:[1,1,0]
v_pk_fma_f32 v[12:13], v[12:13], v[30:31], v[30:31] op_sel:[0,1,0] op_sel_hi:[1,1,0]
v_pk_fma_f32 v[14:15], v[14:15], v[30:31], v[30:31] op_sel:[0,1,0] op_sel_hi:[1,1,0]
v_pk_mul_f32 v[6:7], v[6:7], v[120:121]
v_pk_mul_f32 v[8:9], v[8:9], v[122:123]
v_pk_mul_f32 v[12:13], v[12:13], v[124:125]
v_pk_mul_f32 v[14:15], v[14:15], v[126:127]
v_exp_f32_e64 v6, v6
v_exp_f32_e64 v7, v7
v_exp_f32_e64 v8, v8
v_exp_f32_e64 v9, v9
v_exp_f32_e64 v12, v12
v_exp_f32_e64 v13, v13
v_exp_f32_e64 v14, v14
v_exp_f32_e64 v15, v15
v_pk_add_f32 v[6:7], v[6:7], 1.0 op_sel_hi:[1,0]
v_pk_add_f32 v[8:9], v[8:9], 1.0 op_sel_hi:[1,0]
v_pk_add_f32 v[12:13], v[12:13], 1.0 op_sel_hi:[1,0]
v_pk_add_f32 v[14:15], v[14:15], 1.0 op_sel_hi:[1,0]
v_rcp_f32_e64 v6, v6
v_rcp_f32_e64 v7, v7
v_rcp_f32_e64 v8, v8
v_rcp_f32_e64 v9, v9
v_rcp_f32_e64 v12, v12
v_rcp_f32_e64 v13, v13
v_rcp_f32_e64 v14, v14
v_rcp_f32_e64 v15, v15
v_pk_mul_f32 v[152:153], v[152:153], v[120:121]
v_pk_mul_f32 v[154:155], v[154:155], v[122:123]
v_pk_mul_f32 v[156:157], v[156:157], v[124:125]
v_pk_mul_f32 v[158:159], v[158:159], v[126:127]
v_pk_mul_f32 v[152:153], v[152:153], v[6:7]
v_pk_mul_f32 v[154:155], v[154:155], v[8:9]
v_pk_mul_f32 v[156:157], v[156:157], v[12:13]
v_pk_mul_f32 v[158:159], v[158:159], v[14:15]
v_cvt_pk_bf16_f32 v120, v152, v153
v_cvt_pk_bf16_f32 v121, v154, v155
v_cvt_pk_bf16_f32 v122, v156, v157
v_cvt_pk_bf16_f32 v123, v158, v159
s_nop 1
v_permlane16_swap_b32 v120, v122
v_permlane16_swap_b32_e64 v121, v123
buffer_store_dwordx4 v[120:123], v16, s[20:23], s74 offen offset:1536 sc1
s_mov_b32 s12, s56
s_and_b32 s13, s57, 0xffff
s_mov_b32 s14, 7340032
s_mov_b32 s15, 0x20000
s_mov_b32 s16, s46
s_and_b32 s17, s47, 0xffff
s_mov_b32 s18, 2097152
s_mov_b32 s19, 0x20000
s_mov_b32 s24, s48
s_and_b32 s25, s49, 0xffff
s_mov_b32 s26, 2097152
s_mov_b32 s27, 0x20000
s_lshl_b32 s38, s98, 20
s_mul_i32 s39, s98, 3670016
s_add_u32 s39, s39, 8388608
s_lshl_b32 s40, s98, 9
s_mul_i32 s41, s98, 1835008
s_lshl_b32 s42, s3, 13
s_lshl_b32 s43, s3, 12
s_add_u32 s43, s43, 98304
s_sub_u32 s53, s101, 12288
s_mul_i32 s67, s98, 49152
s_sub_u32 s66, s53, s67
s_xor_b32 s67, s100, 0
s_mul_i32 s67, s67, 49152
s_add_u32 s67, s67, 8192
s_add_u32 s50, s66, s67
s_xor_b32 s67, s100, 1
s_mul_i32 s67, s67, 49152
s_add_u32 s67, s67, 4096
s_add_u32 s51, s66, s67
s_xor_b32 s67, s100, 2
s_mul_i32 s67, s67, 49152
s_add_u32 s67, s67, 0
s_add_u32 s52, s66, s67
s_lshl_b32 s66, s4, 2
s_add_u32 s66, s66, s98
s_lshl_b32 s66, s66, 12
s_add_u32 s55, s66, 24268800
s_lshl_b32 s66, s99, 9
s_add_u32 s54, s55, s66
v_and_b32 v1, 3, v0
v_min_u32 v1, 2, v1
v_add_u32 v28, 1, v1
v_xor_b32 v28, s98, v28
v_subrev_u32 v28, s98, v28
v_lshlrev_b32 v28, 12, v28
v_lshl_add_u32 v28, v1, 4, v28
s_lshl_b32 s67, s3, 2
s_add_u32 s66, s66, s67
s_add_u32 s66, s66, 384
v_add_u32 v28, s66, v28
v_and_b32 v1, 8, v0
v_cmp_eq_u32 vcc, 0, v1
v_and_b32 v143, 31, v0
v_lshlrev_b32 v143, 2, v143
v_cndmask_b32 v28, v28, v24, vcc
v_add_u32 v29, s55, v28
s_lshl_b32 s58, s4, 11
s_lshl_b32 s67, s7, 10
s_add_u32 s58, s58, s67
s_add_u32 s58, s58, 24117248
s_add_u32 s59, s67, 147456
s_lshl_b32 s66, s100, 1
s_and_b32 s67, s66, 2
s_and_b32 s68, s66, 4
v_xor_b32 v1, s67, v26
v_lshlrev_b32_e64 v1, 8, v1
v_lshl_add_u32 v1, v25, 4, v1
s_mul_i32 s66, s3, 229376
s_lshl_b32 s67, s4, 12
s_add_u32 s66, s66, s67
s_add_u32 s66, s66, 4096
s_lshl_b32 s68, s68, 8
s_add_u32 s67, s66, s68
s_sub_u32 s69, s66, s68
v_add_u32 v128, s67, v1
v_add_u32_e64 v129, s69, v1
v_add_u32 v130, 0x8000, v128
v_add_u32 v131, 0x8000, v129
v_lshlrev_b32 v1, 1, v26
v_xor_b32 v1, v1, v25
v_lshlrev_b32 v1, 4, v1
s_mul_i32 s66, s3, 56
v_add_u32 v28, s66, v26
v_lshlrev_b32 v28, 11, v28
s_lshl_b32 s66, s99, 8
v_add_u32 v28, s66, v28
v_add_u32_e64 v132, v28, v1
v_add_u32 v133, 7168, v132
v_xor_b32 v1, 128, v1
v_add_u32_e64 v134, v28, v1
v_add_u32 v134, 14336, v134
v_add_u32 v135, 7168, v134
s_getpc_b64 s[76:77]
KF_ct1:
s_add_u32 s76, s76, KF_k2-KF_ct1
s_addc_u32 s77, s77, 0
s_lshl_b32 s78, s3, 4
v_and_b32 v1, 15, v0
v_add_lshl_u32 v1, v1, s78, 7
v_min_u32 v1, KF_last-(KF_k2), v1
global_load_dword a255, v1, s[76:77]
s_mov_b32 s74, 65536
v_pk_mul_f32 v[6:7], v[160:161], v[160:161]
v_pk_mul_f32 v[8:9], v[162:163], v[162:163]
v_pk_mul_f32 v[12:13], v[164:165], v[164:165]
v_pk_mul_f32 v[14:15], v[166:167], v[166:167]
v_pk_fma_f32 v[6:7], v[6:7], v[30:31], v[30:31] op_sel:[0,1,0] op_sel_hi:[1,1,0]
v_pk_fma_f32 v[8:9], v[8:9], v[30:31], v[30:31] op_sel:[0,1,0] op_sel_hi:[1,1,0]
v_pk_fma_f32 v[12:13], v[12:13], v[30:31], v[30:31] op_sel:[0,1,0] op_sel_hi:[1,1,0]
v_pk_fma_f32 v[14:15], v[14:15], v[30:31], v[30:31] op_sel:[0,1,0] op_sel_hi:[1,1,0]
v_pk_mul_f32 v[6:7], v[6:7], v[160:161]
v_pk_mul_f32 v[8:9], v[8:9], v[162:163]
v_pk_mul_f32 v[12:13], v[12:13], v[164:165]
v_pk_mul_f32 v[14:15], v[14:15], v[166:167]
s_add_u32 s45, s41, 0
s_add_u32 m0, s43, 0
s_nop 0
s_nop 0
buffer_load_dwordx4 v132, s[12:15], s45 offen offset:0 lds
v_exp_f32_e64 v6, v6
v_exp_f32_e64 v7, v7
v_exp_f32_e64 v8, v8
v_exp_f32_e64 v9, v9
v_exp_f32_e64 v12, v12
v_exp_f32_e64 v13, v13
v_exp_f32_e64 v14, v14
v_exp_f32_e64 v15, v15
v_pk_add_f32 v[6:7], v[6:7], 1.0 op_sel_hi:[1,0]
v_pk_add_f32 v[8:9], v[8:9], 1.0 op_sel_hi:[1,0]
v_pk_add_f32 v[12:13], v[12:13], 1.0 op_sel_hi:[1,0]
v_pk_add_f32 v[14:15], v[14:15], 1.0 op_sel_hi:[1,0]
v_rcp_f32_e64 v6, v6
v_rcp_f32_e64 v7, v7
v_rcp_f32_e64 v8, v8
v_rcp_f32_e64 v9, v9
buffer_load_dwordx4 v133, s[12:15], s45 offen offset:1024 lds
v_rcp_f32_e64 v12, v12
v_rcp_f32_e64 v13, v13
v_rcp_f32_e64 v14, v14
v_rcp_f32_e64 v15, v15
v_pk_mul_f32 v[192:193], v[192:193], v[160:161]
v_pk_mul_f32 v[194:195], v[194:195], v[162:163]
v_pk_mul_f32 v[196:197], v[196:197], v[164:165]
v_pk_mul_f32 v[198:199], v[198:199], v[166:167]
v_pk_mul_f32 v[192:193], v[192:193], v[6:7]
v_pk_mul_f32 v[194:195], v[194:195], v[8:9]
v_pk_mul_f32 v[196:197], v[196:197], v[12:13]
v_pk_mul_f32 v[198:199], v[198:199], v[14:15]
v_cvt_pk_bf16_f32 v160, v192, v193
v_cvt_pk_bf16_f32 v161, v194, v195
v_cvt_pk_bf16_f32 v162, v196, v197
v_cvt_pk_bf16_f32 v163, v198, v199
s_nop 1
v_permlane16_swap_b32 v160, v162
v_permlane16_swap_b32_e64 v161, v163
buffer_store_dwordx4 v[160:163], v16, s[20:23], s74 offen offset:0 sc1
v_pk_mul_f32 v[6:7], v[168:169], v[168:169]
v_pk_mul_f32 v[8:9], v[170:171], v[170:171]
v_pk_mul_f32 v[12:13], v[172:173], v[172:173]
v_pk_mul_f32 v[14:15], v[174:175], v[174:175]
v_pk_fma_f32 v[6:7], v[6:7], v[30:31], v[30:31] op_sel:[0,1,0] op_sel_hi:[1,1,0]
v_pk_fma_f32 v[8:9], v[8:9], v[30:31], v[30:31] op_sel:[0,1,0] op_sel_hi:[1,1,0]
v_pk_fma_f32 v[12:13], v[12:13], v[30:31], v[30:31] op_sel:[0,1,0] op_sel_hi:[1,1,0]
v_pk_fma_f32 v[14:15], v[14:15], v[30:31], v[30:31] op_sel:[0,1,0] op_sel_hi:[1,1,0]
v_pk_mul_f32 v[6:7], v[6:7], v[168:169]
v_pk_mul_f32 v[8:9], v[8:9], v[170:171]
v_pk_mul_f32 v[12:13], v[12:13], v[172:173]
v_pk_mul_f32 v[14:15], v[14:15], v[174:175]
buffer_load_dwordx4 v134, s[12:15], s45 offen offset:2048 lds
v_exp_f32_e64 v6, v6
v_exp_f32_e64 v7, v7
v_exp_f32_e64 v8, v8
v_exp_f32_e64 v9, v9
v_exp_f32_e64 v12, v12
v_exp_f32_e64 v13, v13
v_exp_f32_e64 v14, v14
v_exp_f32_e64 v15, v15
v_pk_add_f32 v[6:7], v[6:7], 1.0 op_sel_hi:[1,0]
v_pk_add_f32 v[8:9], v[8:9], 1.0 op_sel_hi:[1,0]
v_pk_add_f32 v[12:13], v[12:13], 1.0 op_sel_hi:[1,0]
v_pk_add_f32 v[14:15], v[14:15], 1.0 op_sel_hi:[1,0]
v_rcp_f32_e64 v6, v6
v_rcp_f32_e64 v7, v7
v_rcp_f32_e64 v8, v8
v_rcp_f32_e64 v9, v9
buffer_load_dwordx4 v135, s[12:15], s45 offen offset:3072 lds
v_rcp_f32_e64 v12, v12
v_rcp_f32_e64 v13, v13
v_rcp_f32_e64 v14, v14
v_rcp_f32_e64 v15, v15
v_pk_mul_f32 v[200:201], v[200:201], v[168:169]
v_pk_mul_f32 v[202:203], v[202:203], v[170:171]
v_pk_mul_f32 v[204:205], v[204:205], v[172:173]
v_pk_mul_f32 v[206:207], v[206:207], v[174:175]
v_pk_mul_f32 v[200:201], v[200:201], v[6:7]
v_pk_mul_f32 v[202:203], v[202:203], v[8:9]
v_pk_mul_f32 v[204:205], v[204:205], v[12:13]
v_pk_mul_f32 v[206:207], v[206:207], v[14:15]
v_cvt_pk_bf16_f32 v168, v200, v201
v_cvt_pk_bf16_f32 v169, v202, v203
v_cvt_pk_bf16_f32 v170, v204, v205
v_cvt_pk_bf16_f32 v171, v206, v207
s_nop 1
v_permlane16_swap_b32 v168, v170
v_permlane16_swap_b32 v169, v171
s_waitcnt vmcnt(6)
buffer_store_dword v19, v29, s[20:23], 0 offen sc1
buffer_store_dwordx4 v[168:171], v16, s[20:23], s74 offen offset:512 sc1
v_pk_mul_f32 v[6:7], v[176:177], v[176:177]
v_pk_mul_f32 v[8:9], v[178:179], v[178:179]
v_pk_mul_f32 v[12:13], v[180:181], v[180:181]
v_pk_mul_f32 v[14:15], v[182:183], v[182:183]
v_pk_fma_f32 v[6:7], v[6:7], v[30:31], v[30:31] op_sel:[0,1,0] op_sel_hi:[1,1,0]
v_pk_fma_f32 v[8:9], v[8:9], v[30:31], v[30:31] op_sel:[0,1,0] op_sel_hi:[1,1,0]
v_pk_fma_f32 v[12:13], v[12:13], v[30:31], v[30:31] op_sel:[0,1,0] op_sel_hi:[1,1,0]
v_pk_fma_f32 v[14:15], v[14:15], v[30:31], v[30:31] op_sel:[0,1,0] op_sel_hi:[1,1,0]
v_pk_mul_f32 v[6:7], v[6:7], v[176:177]
v_pk_mul_f32 v[8:9], v[8:9], v[178:179]
v_pk_mul_f32 v[12:13], v[12:13], v[180:181]
v_pk_mul_f32 v[14:15], v[14:15], v[182:183]
s_add_u32 s45, s41, 458752
s_add_u32 m0, s43, 16384
s_nop 0
s_nop 0
buffer_load_dwordx4 v132, s[12:15], s45 offen offset:0 lds
v_exp_f32_e64 v6, v6
v_exp_f32_e64 v7, v7
v_exp_f32_e64 v8, v8
v_exp_f32_e64 v9, v9
v_exp_f32_e64 v12, v12
v_exp_f32_e64 v13, v13
v_exp_f32_e64 v14, v14
v_exp_f32_e64 v15, v15
v_pk_add_f32 v[6:7], v[6:7], 1.0 op_sel_hi:[1,0]
v_pk_add_f32 v[8:9], v[8:9], 1.0 op_sel_hi:[1,0]
v_pk_add_f32 v[12:13], v[12:13], 1.0 op_sel_hi:[1,0]
v_pk_add_f32 v[14:15], v[14:15], 1.0 op_sel_hi:[1,0]
v_rcp_f32_e64 v6, v6
v_rcp_f32_e64 v7, v7
v_rcp_f32_e64 v8, v8
v_rcp_f32_e64 v9, v9
buffer_load_dwordx4 v133, s[12:15], s45 offen offset:1024 lds
v_rcp_f32_e64 v12, v12
v_rcp_f32_e64 v13, v13
v_rcp_f32_e64 v14, v14
v_rcp_f32_e64 v15, v15
v_pk_mul_f32 v[208:209], v[208:209], v[176:177]
v_pk_mul_f32 v[210:211], v[210:211], v[178:179]
v_pk_mul_f32 v[212:213], v[212:213], v[180:181]
v_pk_mul_f32 v[214:215], v[214:215], v[182:183]
v_pk_mul_f32 v[208:209], v[208:209], v[6:7]
v_pk_mul_f32 v[210:211], v[210:211], v[8:9]
v_pk_mul_f32 v[212:213], v[212:213], v[12:13]
v_pk_mul_f32 v[214:215], v[214:215], v[14:15]
v_cvt_pk_bf16_f32 v176, v208, v209
v_cvt_pk_bf16_f32 v177, v210, v211
v_cvt_pk_bf16_f32 v178, v212, v213
v_cvt_pk_bf16_f32 v179, v214, v215
s_nop 1
v_permlane16_swap_b32 v176, v178
v_permlane16_swap_b32_e64 v177, v179
buffer_store_dwordx4 v[176:179], v16, s[20:23], s74 offen offset:1024 sc1
v_pk_mul_f32 v[6:7], v[184:185], v[184:185]
v_pk_mul_f32 v[8:9], v[186:187], v[186:187]
v_pk_mul_f32 v[12:13], v[188:189], v[188:189]
v_pk_mul_f32 v[14:15], v[190:191], v[190:191]
v_pk_fma_f32 v[6:7], v[6:7], v[30:31], v[30:31] op_sel:[0,1,0] op_sel_hi:[1,1,0]
v_pk_fma_f32 v[8:9], v[8:9], v[30:31], v[30:31] op_sel:[0,1,0] op_sel_hi:[1,1,0]
v_pk_fma_f32 v[12:13], v[12:13], v[30:31], v[30:31] op_sel:[0,1,0] op_sel_hi:[1,1,0]
v_pk_fma_f32 v[14:15], v[14:15], v[30:31], v[30:31] op_sel:[0,1,0] op_sel_hi:[1,1,0]
v_pk_mul_f32 v[6:7], v[6:7], v[184:185]
v_pk_mul_f32 v[8:9], v[8:9], v[186:187]
v_pk_mul_f32 v[12:13], v[12:13], v[188:189]
v_pk_mul_f32 v[14:15], v[14:15], v[190:191]
buffer_load_dwordx4 v134, s[12:15], s45 offen offset:2048 lds
v_exp_f32_e64 v6, v6
v_exp_f32_e64 v7, v7
v_exp_f32_e64 v8, v8
v_exp_f32_e64 v9, v9
v_exp_f32_e64 v12, v12
v_exp_f32_e64 v13, v13
v_exp_f32_e64 v14, v14
v_exp_f32_e64 v15, v15
v_pk_add_f32 v[6:7], v[6:7], 1.0 op_sel_hi:[1,0]
v_pk_add_f32 v[8:9], v[8:9], 1.0 op_sel_hi:[1,0]
v_pk_add_f32 v[12:13], v[12:13], 1.0 op_sel_hi:[1,0]
v_pk_add_f32 v[14:15], v[14:15], 1.0 op_sel_hi:[1,0]
v_rcp_f32_e64 v6, v6
v_rcp_f32_e64 v7, v7
v_rcp_f32_e64 v8, v8
v_rcp_f32_e64 v9, v9
buffer_load_dwordx4 v135, s[12:15], s45 offen offset:3072 lds
v_rcp_f32_e64 v12, v12
v_rcp_f32_e64 v13, v13
v_rcp_f32_e64 v14, v14
v_rcp_f32_e64 v15, v15
v_pk_mul_f32 v[216:217], v[216:217], v[184:185]
v_pk_mul_f32 v[218:219], v[218:219], v[186:187]
v_pk_mul_f32 v[220:221], v[220:221], v[188:189]
v_pk_mul_f32 v[222:223], v[222:223], v[190:191]
v_pk_mul_f32 v[216:217], v[216:217], v[6:7]
v_pk_mul_f32 v[218:219], v[218:219], v[8:9]
v_pk_mul_f32 v[220:221], v[220:221], v[12:13]
v_pk_mul_f32 v[222:223], v[222:223], v[14:15]
v_cvt_pk_bf16_f32 v184, v216, v217
v_cvt_pk_bf16_f32 v185, v218, v219
v_cvt_pk_bf16_f32 v186, v220, v221
v_cvt_pk_bf16_f32 v187, v222, v223
s_nop 1
v_permlane16_swap_b32 v184, v186
v_permlane16_swap_b32_e64 v185, v187
buffer_store_dwordx4 v[184:187], v16, s[20:23], s74 offen offset:1536 sc1
v_accvgpr_read_b32 v96, a0
v_accvgpr_read_b32 v97, a1
v_accvgpr_read_b32 v98, a2
v_accvgpr_read_b32 v99, a3
v_accvgpr_read_b32 v100, a4
v_accvgpr_read_b32 v101, a5
v_accvgpr_read_b32 v102, a6
v_accvgpr_read_b32 v103, a7
v_accvgpr_read_b32 v104, a8
v_accvgpr_read_b32 v105, a9
v_accvgpr_read_b32 v106, a10
v_accvgpr_read_b32 v107, a11
v_accvgpr_read_b32 v108, a12
v_accvgpr_read_b32 v109, a13
v_accvgpr_read_b32 v110, a14
v_accvgpr_read_b32 v111, a15
v_accvgpr_read_b32 v112, a16
v_accvgpr_read_b32 v113, a17
v_accvgpr_read_b32 v114, a18
v_accvgpr_read_b32 v115, a19
v_accvgpr_read_b32 v116, a20
v_accvgpr_read_b32 v117, a21
v_accvgpr_read_b32 v118, a22
v_accvgpr_read_b32 v119, a23
v_accvgpr_read_b32 v120, a24
v_accvgpr_read_b32 v121, a25
v_accvgpr_read_b32 v122, a26
v_accvgpr_read_b32 v123, a27
v_accvgpr_read_b32 v124, a28
v_accvgpr_read_b32 v125, a29
v_accvgpr_read_b32 v126, a30
v_accvgpr_read_b32 v127, a31
s_mov_b32 s74, 131072
v_pk_mul_f32 v[6:7], v[224:225], v[224:225]
v_pk_mul_f32 v[8:9], v[226:227], v[226:227]
v_pk_mul_f32 v[12:13], v[228:229], v[228:229]
v_pk_mul_f32 v[14:15], v[230:231], v[230:231]
v_pk_fma_f32 v[6:7], v[6:7], v[30:31], v[30:31] op_sel:[0,1,0] op_sel_hi:[1,1,0]
v_pk_fma_f32 v[8:9], v[8:9], v[30:31], v[30:31] op_sel:[0,1,0] op_sel_hi:[1,1,0]
v_pk_fma_f32 v[12:13], v[12:13], v[30:31], v[30:31] op_sel:[0,1,0] op_sel_hi:[1,1,0]
v_pk_fma_f32 v[14:15], v[14:15], v[30:31], v[30:31] op_sel:[0,1,0] op_sel_hi:[1,1,0]
v_pk_mul_f32 v[6:7], v[6:7], v[224:225]
v_pk_mul_f32 v[8:9], v[8:9], v[226:227]
v_pk_mul_f32 v[12:13], v[12:13], v[228:229]
v_pk_mul_f32 v[14:15], v[14:15], v[230:231]
s_add_u32 s45, s41, 917504
s_add_u32 m0, s43, 32768
s_nop 0
s_nop 0
buffer_load_dwordx4 v132, s[12:15], s45 offen offset:0 lds
v_exp_f32_e64 v6, v6
v_exp_f32_e64 v7, v7
v_exp_f32_e64 v8, v8
v_exp_f32_e64 v9, v9
v_exp_f32_e64 v12, v12
v_exp_f32_e64 v13, v13
v_exp_f32_e64 v14, v14
v_exp_f32_e64 v15, v15
v_pk_add_f32 v[6:7], v[6:7], 1.0 op_sel_hi:[1,0]
v_pk_add_f32 v[8:9], v[8:9], 1.0 op_sel_hi:[1,0]
v_pk_add_f32 v[12:13], v[12:13], 1.0 op_sel_hi:[1,0]
v_pk_add_f32 v[14:15], v[14:15], 1.0 op_sel_hi:[1,0]
v_rcp_f32_e64 v6, v6
v_rcp_f32_e64 v7, v7
v_rcp_f32_e64 v8, v8
v_rcp_f32_e64 v9, v9
buffer_load_dwordx4 v133, s[12:15], s45 offen offset:1024 lds
v_rcp_f32_e64 v12, v12
v_rcp_f32_e64 v13, v13
v_rcp_f32_e64 v14, v14
v_rcp_f32_e64 v15, v15
v_pk_mul_f32 v[96:97], v[96:97], v[224:225]
v_pk_mul_f32 v[98:99], v[98:99], v[226:227]
v_pk_mul_f32 v[100:101], v[100:101], v[228:229]
v_pk_mul_f32 v[102:103], v[102:103], v[230:231]
v_pk_mul_f32 v[96:97], v[96:97], v[6:7]
v_pk_mul_f32 v[98:99], v[98:99], v[8:9]
v_pk_mul_f32 v[100:101], v[100:101], v[12:13]
v_pk_mul_f32 v[102:103], v[102:103], v[14:15]
v_cvt_pk_bf16_f32 v224, v96, v97
v_cvt_pk_bf16_f32 v225, v98, v99
v_cvt_pk_bf16_f32 v226, v100, v101
v_cvt_pk_bf16_f32 v227, v102, v103
s_nop 1
v_permlane16_swap_b32 v224, v226
v_permlane16_swap_b32_e64 v225, v227
buffer_store_dwordx4 v[224:227], v16, s[20:23], s74 offen offset:0 sc1
v_pk_mul_f32 v[6:7], v[232:233], v[232:233]
v_pk_mul_f32 v[8:9], v[234:235], v[234:235]
v_pk_mul_f32 v[12:13], v[236:237], v[236:237]
v_pk_mul_f32 v[14:15], v[238:239], v[238:239]
v_pk_fma_f32 v[6:7], v[6:7], v[30:31], v[30:31] op_sel:[0,1,0] op_sel_hi:[1,1,0]
v_pk_fma_f32 v[8:9], v[8:9], v[30:31], v[30:31] op_sel:[0,1,0] op_sel_hi:[1,1,0]
v_pk_fma_f32 v[12:13], v[12:13], v[30:31], v[30:31] op_sel:[0,1,0] op_sel_hi:[1,1,0]
v_pk_fma_f32 v[14:15], v[14:15], v[30:31], v[30:31] op_sel:[0,1,0] op_sel_hi:[1,1,0]
v_pk_mul_f32 v[6:7], v[6:7], v[232:233]
v_pk_mul_f32 v[8:9], v[8:9], v[234:235]
v_pk_mul_f32 v[12:13], v[12:13], v[236:237]
v_pk_mul_f32 v[14:15], v[14:15], v[238:239]
buffer_load_dwordx4 v134, s[12:15], s45 offen offset:2048 lds
v_exp_f32_e64 v6, v6
v_exp_f32_e64 v7, v7
v_exp_f32_e64 v8, v8
v_exp_f32_e64 v9, v9
v_exp_f32_e64 v12, v12
v_exp_f32_e64 v13, v13
v_exp_f32_e64 v14, v14
v_exp_f32_e64 v15, v15
v_pk_add_f32 v[6:7], v[6:7], 1.0 op_sel_hi:[1,0]
v_pk_add_f32 v[8:9], v[8:9], 1.0 op_sel_hi:[1,0]
v_pk_add_f32 v[12:13], v[12:13], 1.0 op_sel_hi:[1,0]
v_pk_add_f32 v[14:15], v[14:15], 1.0 op_sel_hi:[1,0]
v_rcp_f32_e64 v6, v6
v_rcp_f32_e64 v7, v7
v_rcp_f32_e64 v8, v8
v_rcp_f32_e64 v9, v9
buffer_load_dwordx4 v135, s[12:15], s45 offen offset:3072 lds
v_rcp_f32_e64 v12, v12
v_rcp_f32_e64 v13, v13
v_rcp_f32_e64 v14, v14
v_rcp_f32_e64 v15, v15
v_pk_mul_f32 v[104:105], v[104:105], v[232:233]
v_pk_mul_f32 v[106:107], v[106:107], v[234:235]
v_pk_mul_f32 v[108:109], v[108:109], v[236:237]
v_pk_mul_f32 v[110:111], v[110:111], v[238:239]
v_pk_mul_f32 v[104:105], v[104:105], v[6:7]
v_pk_mul_f32 v[106:107], v[106:107], v[8:9]
v_pk_mul_f32 v[108:109], v[108:109], v[12:13]
v_pk_mul_f32 v[110:111], v[110:111], v[14:15]
v_cvt_pk_bf16_f32 v232, v104, v105
v_cvt_pk_bf16_f32 v233, v106, v107
v_cvt_pk_bf16_f32 v234, v108, v109
v_cvt_pk_bf16_f32 v235, v110, v111
s_nop 1
v_permlane16_swap_b32 v232, v234
v_permlane16_swap_b32_e64 v233, v235
buffer_store_dwordx4 v[232:235], v16, s[20:23], s74 offen offset:512 sc1
v_pk_mul_f32 v[6:7], v[240:241], v[240:241]
v_pk_mul_f32 v[8:9], v[242:243], v[242:243]
v_pk_mul_f32 v[12:13], v[244:245], v[244:245]
v_pk_mul_f32 v[14:15], v[246:247], v[246:247]
v_pk_fma_f32 v[6:7], v[6:7], v[30:31], v[30:31] op_sel:[0,1,0] op_sel_hi:[1,1,0]
v_pk_fma_f32 v[8:9], v[8:9], v[30:31], v[30:31] op_sel:[0,1,0] op_sel_hi:[1,1,0]
v_pk_fma_f32 v[12:13], v[12:13], v[30:31], v[30:31] op_sel:[0,1,0] op_sel_hi:[1,1,0]
v_pk_fma_f32 v[14:15], v[14:15], v[30:31], v[30:31] op_sel:[0,1,0] op_sel_hi:[1,1,0]
v_pk_mul_f32 v[6:7], v[6:7], v[240:241]
v_pk_mul_f32 v[8:9], v[8:9], v[242:243]
v_pk_mul_f32 v[12:13], v[12:13], v[244:245]
v_pk_mul_f32 v[14:15], v[14:15], v[246:247]
v_exp_f32_e64 v6, v6
v_exp_f32_e64 v7, v7
v_exp_f32_e64 v8, v8
v_exp_f32_e64 v9, v9
v_exp_f32_e64 v12, v12
v_exp_f32_e64 v13, v13
v_exp_f32_e64 v14, v14
v_exp_f32_e64 v15, v15
v_pk_add_f32 v[6:7], v[6:7], 1.0 op_sel_hi:[1,0]
v_pk_add_f32 v[8:9], v[8:9], 1.0 op_sel_hi:[1,0]
v_pk_add_f32 v[12:13], v[12:13], 1.0 op_sel_hi:[1,0]
v_pk_add_f32 v[14:15], v[14:15], 1.0 op_sel_hi:[1,0]
v_rcp_f32_e64 v6, v6
v_rcp_f32_e64 v7, v7
v_rcp_f32_e64 v8, v8
v_rcp_f32_e64 v9, v9
v_rcp_f32_e64 v12, v12
v_rcp_f32_e64 v13, v13
v_rcp_f32_e64 v14, v14
v_rcp_f32_e64 v15, v15
v_pk_mul_f32 v[112:113], v[112:113], v[240:241]
v_pk_mul_f32 v[114:115], v[114:115], v[242:243]
v_pk_mul_f32 v[116:117], v[116:117], v[244:245]
v_pk_mul_f32 v[118:119], v[118:119], v[246:247]
v_pk_mul_f32 v[112:113], v[112:113], v[6:7]
v_pk_mul_f32 v[114:115], v[114:115], v[8:9]
v_pk_mul_f32 v[116:117], v[116:117], v[12:13]
v_pk_mul_f32 v[118:119], v[118:119], v[14:15]
v_cvt_pk_bf16_f32 v240, v112, v113
v_cvt_pk_bf16_f32 v241, v114, v115
v_cvt_pk_bf16_f32 v242, v116, v117
v_cvt_pk_bf16_f32 v243, v118, v119
s_nop 1
v_permlane16_swap_b32 v240, v242
v_permlane16_swap_b32_e64 v241, v243
buffer_store_dwordx4 v[240:243], v16, s[20:23], s74 offen offset:1024 sc1
v_pk_mul_f32 v[6:7], v[248:249], v[248:249]
v_pk_mul_f32 v[8:9], v[250:251], v[250:251]
v_pk_mul_f32 v[12:13], v[252:253], v[252:253]
v_pk_mul_f32 v[14:15], v[254:255], v[254:255]
v_pk_fma_f32 v[6:7], v[6:7], v[30:31], v[30:31] op_sel:[0,1,0] op_sel_hi:[1,1,0]
v_pk_fma_f32 v[8:9], v[8:9], v[30:31], v[30:31] op_sel:[0,1,0] op_sel_hi:[1,1,0]
v_pk_fma_f32 v[12:13], v[12:13], v[30:31], v[30:31] op_sel:[0,1,0] op_sel_hi:[1,1,0]
v_pk_fma_f32 v[14:15], v[14:15], v[30:31], v[30:31] op_sel:[0,1,0] op_sel_hi:[1,1,0]
v_pk_mul_f32 v[6:7], v[6:7], v[248:249]
v_pk_mul_f32 v[8:9], v[8:9], v[250:251]
v_pk_mul_f32 v[12:13], v[12:13], v[252:253]
v_pk_mul_f32 v[14:15], v[14:15], v[254:255]
v_exp_f32_e64 v6, v6
v_exp_f32_e64 v7, v7
v_exp_f32_e64 v8, v8
v_exp_f32_e64 v9, v9
v_exp_f32_e64 v12, v12
v_exp_f32_e64 v13, v13
v_exp_f32_e64 v14, v14
v_exp_f32_e64 v15, v15
v_pk_add_f32 v[6:7], v[6:7], 1.0 op_sel_hi:[1,0]
v_pk_add_f32 v[8:9], v[8:9], 1.0 op_sel_hi:[1,0]
v_pk_add_f32 v[12:13], v[12:13], 1.0 op_sel_hi:[1,0]
v_pk_add_f32 v[14:15], v[14:15], 1.0 op_sel_hi:[1,0]
v_rcp_f32_e64 v6, v6
v_rcp_f32_e64 v7, v7
v_rcp_f32_e64 v8, v8
v_rcp_f32_e64 v9, v9
v_rcp_f32_e64 v12, v12
v_rcp_f32_e64 v13, v13
v_rcp_f32_e64 v14, v14
v_rcp_f32_e64 v15, v15
v_pk_mul_f32 v[120:121], v[120:121], v[248:249]
v_pk_mul_f32 v[122:123], v[122:123], v[250:251]
v_pk_mul_f32 v[124:125], v[124:125], v[252:253]
v_pk_mul_f32 v[126:127], v[126:127], v[254:255]
v_pk_mul_f32 v[120:121], v[120:121], v[6:7]
v_pk_mul_f32 v[122:123], v[122:123], v[8:9]
v_pk_mul_f32 v[124:125], v[124:125], v[12:13]
v_pk_mul_f32 v[126:127], v[126:127], v[14:15]
v_cvt_pk_bf16_f32 v248, v120, v121
v_cvt_pk_bf16_f32 v249, v122, v123
v_cvt_pk_bf16_f32 v250, v124, v125
v_cvt_pk_bf16_f32 v251, v126, v127
s_nop 1
v_permlane16_swap_b32 v248, v250
v_permlane16_swap_b32_e64 v249, v251
buffer_store_dwordx4 v[248:251], v16, s[20:23], s74 offen offset:1536 sc1
s_sub_u32 s66, s4, 7
s_lshl_b32 s66, s66, 14
s_lshl_b32 s67, s5, 9
s_add_u32 s66, s66, s67
s_lshl_b32 s67, s7, 8
s_add_u32 s66, s66, s67
v_lshlrev_b32 v136, 4, v25
v_add_u32 v136, s66, v136
v_add_u32 v137, 16384, v136
v_add_u32 v138, 32768, v136
v_add_u32 v139, 49152, v136
v_add_u32 v140, 65536, v136
v_add_u32 v141, 81920, v136
v_add_u32 v142, 98304, v136
buffer_load_dword v27, v143, s[20:23], s54 offen offset:0 sc1
v_accvgpr_read_b32 v96, a32
v_accvgpr_read_b32 v97, a33
v_accvgpr_read_b32 v98, a34
v_accvgpr_read_b32 v99, a35
buffer_load_dwordx4 v[192:195], v136, s[28:31], 0 offen sc1
v_accvgpr_read_b32 v100, a36
v_accvgpr_read_b32 v101, a37
v_accvgpr_read_b32 v102, a38
v_accvgpr_read_b32 v103, a39
buffer_load_dwordx4 v[196:199], v137, s[28:31], 0 offen sc1
v_accvgpr_read_b32 v104, a40
v_accvgpr_read_b32 v105, a41
v_accvgpr_read_b32 v106, a42
v_accvgpr_read_b32 v107, a43
buffer_load_dwordx4 v[200:203], v138, s[28:31], 0 offen sc1
v_accvgpr_read_b32 v108, a44
v_accvgpr_read_b32 v109, a45
v_accvgpr_read_b32 v110, a46
v_accvgpr_read_b32 v111, a47
buffer_load_dwordx4 v[204:207], v139, s[28:31], 0 offen sc1
v_accvgpr_read_b32 v112, a48
v_accvgpr_read_b32 v113, a49
v_accvgpr_read_b32 v114, a50
v_accvgpr_read_b32 v115, a51
buffer_load_dwordx4 v[208:211], v140, s[28:31], 0 offen sc1
v_accvgpr_read_b32 v116, a52
v_accvgpr_read_b32 v117, a53
v_accvgpr_read_b32 v118, a54
v_accvgpr_read_b32 v119, a55
buffer_load_dwordx4 v[212:215], v141, s[28:31], 0 offen sc1
v_accvgpr_read_b32 v120, a56
v_accvgpr_read_b32 v121, a57
v_accvgpr_read_b32 v122, a58
v_accvgpr_read_b32 v123, a59
buffer_load_dwordx4 v[216:219], v142, s[28:31], 0 offen sc1
v_accvgpr_read_b32 v124, a60
v_accvgpr_read_b32 v125, a61
v_accvgpr_read_b32 v126, a62
v_accvgpr_read_b32 v127, a63
v_permlane32_swap_b32 v96, v100
v_permlane32_swap_b32 v97, v101
v_permlane32_swap_b32 v98, v102
v_permlane32_swap_b32 v99, v103
v_permlane32_swap_b32 v104, v108
v_permlane32_swap_b32 v105, v109
v_permlane32_swap_b32 v106, v110
v_permlane32_swap_b32 v107, v111
v_permlane32_swap_b32 v112, v116
v_permlane32_swap_b32 v113, v117
v_permlane32_swap_b32 v114, v118
v_permlane32_swap_b32 v115, v119
v_permlane32_swap_b32 v120, v124
v_permlane32_swap_b32 v121, v125
v_permlane32_swap_b32 v122, v126
v_permlane32_swap_b32 v123, v127
v_pk_mul_f32 v[6:7], v[96:97], v[96:97]
v_pk_mul_f32 v[8:9], v[98:99], v[98:99]
v_pk_mul_f32 v[12:13], v[104:105], v[104:105]
v_pk_mul_f32 v[14:15], v[106:107], v[106:107]
v_pk_fma_f32 v[6:7], v[6:7], v[30:31], v[30:31] op_sel:[0,1,0] op_sel_hi:[1,1,0]
v_pk_fma_f32 v[8:9], v[8:9], v[30:31], v[30:31] op_sel:[0,1,0] op_sel_hi:[1,1,0]
v_pk_fma_f32 v[12:13], v[12:13], v[30:31], v[30:31] op_sel:[0,1,0] op_sel_hi:[1,1,0]
v_pk_fma_f32 v[14:15], v[14:15], v[30:31], v[30:31] op_sel:[0,1,0] op_sel_hi:[1,1,0]
v_pk_mul_f32 v[6:7], v[6:7], v[96:97]
v_pk_mul_f32 v[8:9], v[8:9], v[98:99]
v_pk_mul_f32 v[12:13], v[12:13], v[104:105]
v_pk_mul_f32 v[14:15], v[14:15], v[106:107]
v_exp_f32_e64 v6, v6
v_exp_f32_e64 v7, v7
v_exp_f32_e64 v8, v8
v_exp_f32_e64 v9, v9
v_exp_f32_e64 v12, v12
v_exp_f32_e64 v13, v13
v_exp_f32_e64 v14, v14
v_exp_f32_e64 v15, v15
v_pk_add_f32 v[6:7], v[6:7], 1.0 op_sel_hi:[1,0]
v_pk_add_f32 v[8:9], v[8:9], 1.0 op_sel_hi:[1,0]
v_pk_add_f32 v[12:13], v[12:13], 1.0 op_sel_hi:[1,0]
v_pk_add_f32 v[14:15], v[14:15], 1.0 op_sel_hi:[1,0]
v_rcp_f32_e64 v6, v6
v_rcp_f32_e64 v7, v7
v_rcp_f32_e64 v8, v8
v_rcp_f32_e64 v9, v9
v_rcp_f32_e64 v12, v12
v_rcp_f32_e64 v13, v13
v_rcp_f32_e64 v14, v14
v_rcp_f32_e64 v15, v15
v_pk_mul_f32 v[100:101], v[100:101], v[96:97]
v_pk_mul_f32 v[102:103], v[102:103], v[98:99]
v_pk_mul_f32 v[108:109], v[108:109], v[104:105]
v_pk_mul_f32 v[110:111], v[110:111], v[106:107]
v_pk_mul_f32 v[100:101], v[100:101], v[6:7]
v_pk_mul_f32 v[102:103], v[102:103], v[8:9]
v_pk_mul_f32 v[108:109], v[108:109], v[12:13]
v_pk_mul_f32 v[110:111], v[110:111], v[14:15]
v_cvt_pk_bf16_f32 v96, v100, v101
v_cvt_pk_bf16_f32 v97, v102, v103
v_cvt_pk_bf16_f32 v98, v108, v109
v_cvt_pk_bf16_f32 v99, v110, v111
s_nop 1
v_permlane16_swap_b32 v96, v98
v_permlane16_swap_b32_e64 v97, v99
buffer_store_dwordx4 v[96:99], v17, s[20:23], 0 offen offset:0 sc1
v_pk_mul_f32 v[6:7], v[112:113], v[112:113]
v_pk_mul_f32 v[8:9], v[114:115], v[114:115]
v_pk_mul_f32 v[12:13], v[120:121], v[120:121]
v_pk_mul_f32 v[14:15], v[122:123], v[122:123]
v_pk_fma_f32 v[6:7], v[6:7], v[30:31], v[30:31] op_sel:[0,1,0] op_sel_hi:[1,1,0]
v_pk_fma_f32 v[8:9], v[8:9], v[30:31], v[30:31] op_sel:[0,1,0] op_sel_hi:[1,1,0]
v_pk_fma_f32 v[12:13], v[12:13], v[30:31], v[30:31] op_sel:[0,1,0] op_sel_hi:[1,1,0]
v_pk_fma_f32 v[14:15], v[14:15], v[30:31], v[30:31] op_sel:[0,1,0] op_sel_hi:[1,1,0]
v_pk_mul_f32 v[6:7], v[6:7], v[112:113]
v_pk_mul_f32 v[8:9], v[8:9], v[114:115]
v_pk_mul_f32 v[12:13], v[12:13], v[120:121]
v_pk_mul_f32 v[14:15], v[14:15], v[122:123]
v_exp_f32_e64 v6, v6
v_exp_f32_e64 v7, v7
v_exp_f32_e64 v8, v8
v_exp_f32_e64 v9, v9
v_exp_f32_e64 v12, v12
v_exp_f32_e64 v13, v13
v_exp_f32_e64 v14, v14
v_exp_f32_e64 v15, v15
v_pk_add_f32 v[6:7], v[6:7], 1.0 op_sel_hi:[1,0]
v_pk_add_f32 v[8:9], v[8:9], 1.0 op_sel_hi:[1,0]
v_pk_add_f32 v[12:13], v[12:13], 1.0 op_sel_hi:[1,0]
v_pk_add_f32 v[14:15], v[14:15], 1.0 op_sel_hi:[1,0]
v_rcp_f32_e64 v6, v6
v_rcp_f32_e64 v7, v7
v_rcp_f32_e64 v8, v8
v_rcp_f32_e64 v9, v9
v_rcp_f32_e64 v12, v12
v_rcp_f32_e64 v13, v13
v_rcp_f32_e64 v14, v14
v_rcp_f32_e64 v15, v15
v_pk_mul_f32 v[116:117], v[116:117], v[112:113]
v_pk_mul_f32 v[118:119], v[118:119], v[114:115]
v_pk_mul_f32 v[124:125], v[124:125], v[120:121]
v_pk_mul_f32 v[126:127], v[126:127], v[122:123]
v_pk_mul_f32 v[116:117], v[116:117], v[6:7]
v_pk_mul_f32 v[118:119], v[118:119], v[8:9]
v_pk_mul_f32 v[124:125], v[124:125], v[12:13]
v_pk_mul_f32 v[126:127], v[126:127], v[14:15]
v_cvt_pk_bf16_f32 v112, v116, v117
v_cvt_pk_bf16_f32 v113, v118, v119
v_cvt_pk_bf16_f32 v114, v124, v125
v_cvt_pk_bf16_f32 v115, v126, v127
s_nop 1
v_permlane16_swap_b32 v112, v114
v_permlane16_swap_b32_e64 v113, v115
buffer_store_dwordx4 v[112:115], v17, s[20:23], 0 offen offset:1024 sc1
s_waitcnt vmcnt(9)
v_cmp_ne_u32 vcc, s75, v27
s_lshl_b32 s67, s7, 7
s_add_u32 s67, s67, 149504
v_lshlrev_b32 v1, 3, v25
v_add_u32_e64 v1, s67, v1
ds_read_b64 v[144:145], v1 offset:0
ds_read_b64 v[146:147], v1 offset:256
ds_read_b64 v[148:149], v1 offset:512
ds_read_b64 v[150:151], v1 offset:768
ds_read_b64 v[152:153], v1 offset:1024
ds_read_b64 v[154:155], v1 offset:1280
ds_read_b64 v[156:157], v1 offset:1536
s_cbranch_vccnz KF_f1_slow
KF_f1_ok:
s_add_u32 s44, s39, 0
s_add_u32 m0, s42, 0
s_nop 0
buffer_load_dwordx4 v128, s[20:23], s44 offen offset:0 lds
v_accvgpr_read_b32 v20, a224
v_accvgpr_read_b32 v21, a225
v_accvgpr_read_b32 v22, a222
v_accvgpr_read_b32 v23, a223
s_lshl_b32 s67, s6, 2
v_add_u32 v28, s67, v26
s_mul_i32 s67, s3, 3072
s_add_u32 s67, s67, 151552
v_lshlrev_b32_e64 v27, 7, v26
buffer_load_dwordx4 v129, s[20:23], s44 offen offset:1024 lds
v_lshl_add_u32 v27, v25, 3, v27
v_add_u32 v14, s67, v27
v_lshrrev_b32 v27, 5, v0
v_lshlrev_b32 v27, 9, v27
v_and_b32 v29, 3, v0
v_lshl_add_u32 v27, v29, 7, v27
v_and_b32_e64 v29, 1, v26
v_lshl_add_u32 v27, v29, 6, v27
v_bfe_u32 v29, v0, 2, 2
buffer_load_dwordx4 v128, s[20:23], s44 offen offset:2048 lds
v_lshl_add_u32 v27, v29, 3, v27
v_add_u32 v15, s67, v27
s_waitcnt vmcnt(5)
v_mov_b32 v164, 0
s_cmp_gt_u32 s4, 6
s_cselect_b32 s69, -1, 0
v_xor_b32 v165, s75, v193
v_xor_b32 v166, s75, v195
v_or_b32 v165, v165, v166
v_and_or_b32 v164, v165, s69, v164
buffer_load_dwordx4 v129, s[20:23], s44 offen offset:3072 lds
s_cmp_gt_u32 s4, 5
s_cselect_b32 s69, -1, 0
v_xor_b32 v165, s75, v197
v_xor_b32 v166, s75, v199
v_or_b32_e64 v165, v165, v166
v_and_or_b32 v164, v165, s69, v164
s_cmp_gt_u32 s4, 4
s_cselect_b32 s69, -1, 0
v_xor_b32 v165, s75, v201
v_xor_b32 v166, s75, v203
v_or_b32_e64 v165, v165, v166
s_add_u32 m0, s42, 4096
s_nop 0
buffer_load_dwordx4 v130, s[20:23], s44 offen offset:0 lds
v_and_or_b32 v164, v165, s69, v164
s_cmp_gt_u32 s4, 3
s_cselect_b32 s69, -1, 0
v_xor_b32 v165, s75, v205
v_xor_b32 v166, s75, v207
v_or_b32 v165, v165, v166
v_and_or_b32 v164, v165, s69, v164
s_cmp_gt_u32 s4, 2
s_cselect_b32 s69, -1, 0
v_xor_b32 v165, s75, v209
v_xor_b32 v166, s75, v211
buffer_load_dwordx4 v131, s[20:23], s44 offen offset:1024 lds
v_or_b32_e64 v165, v165, v166
v_and_or_b32 v164, v165, s69, v164
s_cmp_gt_u32 s4, 1
s_cselect_b32 s69, -1, 0
v_xor_b32 v165, s75, v213
v_xor_b32 v166, s75, v215
v_or_b32_e64 v165, v165, v166
v_and_or_b32 v164, v165, s69, v164
s_cmp_gt_u32 s4, 0
s_cselect_b32 s69, -1, 0
v_xor_b32_e64 v165, s75, v217
buffer_load_dwordx4 v130, s[20:23], s44 offen offset:2048 lds
v_xor_b32 v166, s75, v219
v_or_b32 v165, v165, v166
v_and_or_b32 v164, v165, s69, v164
v_cmp_ne_u32 vcc, 0, v164
s_nop 3
s_cbranch_vccnz KF_ag_slow
KF_ag_ok:
s_waitcnt lgkmcnt(0)
s_mov_b32 s28, s96
s_and_b32 s29, s97, 0xffff
buffer_load_dwordx4 v131, s[20:23], s44 offen offset:3072 lds
s_mov_b32 s30, 8388608
s_mov_b32 s31, 0x20000
v_mov_b32 v8, v192
v_mov_b32_e64 v9, v194
v_fma_f32 v6, v20, v8, v196
v_fma_f32 v7, v20, v9, v198
v_fma_f32 v6, -v21, v9, v6
v_fma_f32 v7, v21, v8, v7
v_fma_f32 v8, v20, v6, v200
s_add_u32 s44, s39, 917504
s_add_u32 m0, s42, 32768
s_nop 0
s_nop 0
buffer_load_dwordx4 v128, s[20:23], s44 offen offset:0 lds
v_fma_f32 v9, v20, v7, v202
v_fma_f32 v8, -v21, v7, v8
v_fma_f32 v9, v21, v6, v9
v_fma_f32 v6, v20, v8, v204
v_fma_f32 v7, v20, v9, v206
v_fma_f32 v6, -v21, v9, v6
v_fma_f32 v7, v21, v8, v7
v_fma_f32 v8, v20, v6, v208
v_fma_f32 v9, v20, v7, v210
buffer_load_dwordx4 v129, s[20:23], s44 offen offset:1024 lds
v_fma_f32 v8, -v21, v7, v8
v_fma_f32 v9, v21, v6, v9
v_fma_f32 v6, v20, v8, v212
v_fma_f32 v7, v20, v9, v214
v_fma_f32 v6, -v21, v9, v6
v_fma_f32 v7, v21, v8, v7
v_fma_f32 v8, v20, v6, v216
v_fma_f32 v9, v20, v7, v218
v_fma_f32 v8, -v21, v7, v8
buffer_load_dwordx4 v128, s[20:23], s44 offen offset:2048 lds
v_fma_f32 v9, v21, v6, v9
v_mov_b32 v160, v8
v_mov_b32 v162, v9
v_cmp_lt_u32_e64 vcc, 0, v28
v_fma_f32 v6, v22, v8, v144
v_fma_f32 v7, v22, v9, v145
v_fma_f32 v6, -v23, v9, v6
v_fma_f32 v7, v23, v8, v7
v_cndmask_b32_e64 v160, v160, v6, vcc
buffer_load_dwordx4 v129, s[20:23], s44 offen offset:3072 lds
v_cndmask_b32 v162, v162, v7, vcc
v_cmp_lt_u32 vcc, 1, v28
v_fma_f32 v8, v22, v6, v146
v_fma_f32 v9, v22, v7, v147
v_fma_f32 v8, -v23, v7, v8
v_fma_f32 v9, v23, v6, v9
v_cndmask_b32 v160, v160, v8, vcc
v_cndmask_b32 v162, v162, v9, vcc
v_cmp_lt_u32_e64 vcc, 2, v28
s_add_u32 m0, s42, 36864
s_nop 0
buffer_load_dwordx4 v130, s[20:23], s44 offen offset:0 lds
v_fma_f32 v6, v22, v8, v148
v_fma_f32 v7, v22, v9, v149
v_fma_f32 v6, -v23, v9, v6
v_fma_f32 v7, v23, v8, v7
v_cndmask_b32 v160, v160, v6, vcc
v_cndmask_b32 v162, v162, v7, vcc
v_cmp_lt_u32 vcc, 3, v28
v_fma_f32 v8, v22, v6, v150
v_fma_f32 v9, v22, v7, v151
buffer_load_dwordx4 v131, s[20:23], s44 offen offset:1024 lds
v_fma_f32 v8, -v23, v7, v8
v_fma_f32 v9, v23, v6, v9
v_cndmask_b32 v160, v160, v8, vcc
v_cndmask_b32 v162, v162, v9, vcc
v_cmp_lt_u32_e64 vcc, 4, v28
v_fma_f32 v6, v22, v8, v152
v_fma_f32 v7, v22, v9, v153
v_fma_f32 v6, -v23, v9, v6
v_fma_f32 v7, v23, v8, v7
buffer_load_dwordx4 v130, s[20:23], s44 offen offset:2048 lds
v_cndmask_b32 v160, v160, v6, vcc
v_cndmask_b32 v162, v162, v7, vcc
v_cmp_lt_u32_e64 vcc, 5, v28
v_fma_f32 v8, v22, v6, v154
v_fma_f32 v9, v22, v7, v155
v_fma_f32 v8, -v23, v7, v8
v_fma_f32 v9, v23, v6, v9
v_cndmask_b32 v160, v160, v8, vcc
v_cndmask_b32 v162, v162, v9, vcc
buffer_load_dwordx4 v131, s[20:23], s44 offen offset:3072 lds
v_cmp_lt_u32_e64 vcc, 6, v28
v_fma_f32 v6, v22, v8, v156
v_fma_f32 v7, v22, v9, v157
v_fma_f32 v6, -v23, v9, v6
v_fma_f32 v7, v23, v8, v7
v_cndmask_b32 v160, v160, v6, vcc
v_cndmask_b32 v162, v162, v7, vcc
v_fma_f32 v161, v4, v160, v10
v_fma_f32 v163, v4, v162, v11
s_add_u32 s44, s39, 1835008
s_add_u32 m0, s42, 65536
s_nop 0
buffer_load_dwordx4 v128, s[20:23], s44 offen offset:0 lds
v_fma_f32 v161, -v5, v162, v161
v_fma_f32 v163, v5, v160, v163
v_accvgpr_read_b32 v20, a218
v_accvgpr_read_b32 v21, a219
s_waitcnt vmcnt(17)
buffer_store_dword v19, v24, s[20:23], s55 offen offset:128 sc1
v_pk_fma_f32 v[32:33], v[160:161], v[2:3], v[32:33] op_sel:[0,0,0] op_sel_hi:[1,0,1]
v_pk_fma_f32 v[64:65], v[162:163], v[2:3], v[64:65] op_sel:[0,0,0] op_sel_hi:[1,0,1]
v_pk_fma_f32 v[32:33], v[162:163], v[2:3], v[32:33] op_sel:[0,1,0] op_sel_hi:[1,1,1] neg_lo:[0,1,0] neg_hi:[0,1,0]
v_pk_fma_f32 v[64:65], v[160:161], v[2:3], v[64:65] op_sel:[0,1,0] op_sel_hi:[1,1,1]
buffer_load_dwordx4 v129, s[20:23], s44 offen offset:1024 lds
v_pk_fma_f32 v[34:35], v[32:33], v[2:3], v[34:35] op_sel:[0,0,0] op_sel_hi:[1,0,1]
v_pk_fma_f32 v[66:67], v[64:65], v[2:3], v[66:67] op_sel:[0,0,0] op_sel_hi:[1,0,1]
v_pk_fma_f32 v[34:35], v[64:65], v[2:3], v[34:35] op_sel:[0,1,0] op_sel_hi:[1,1,1] neg_lo:[0,1,0] neg_hi:[0,1,0]
v_pk_fma_f32 v[66:67], v[32:33], v[2:3], v[66:67] op_sel:[0,1,0] op_sel_hi:[1,1,1]
v_pk_fma_f32 v[36:37], v[34:35], v[2:3], v[36:37] op_sel:[0,0,0] op_sel_hi:[1,0,1]
v_pk_fma_f32 v[68:69], v[66:67], v[2:3], v[68:69] op_sel:[0,0,0] op_sel_hi:[1,0,1]
v_pk_fma_f32 v[36:37], v[66:67], v[2:3], v[36:37] op_sel:[0,1,0] op_sel_hi:[1,1,1] neg_lo:[0,1,0] neg_hi:[0,1,0]
v_pk_fma_f32 v[68:69], v[34:35], v[2:3], v[68:69] op_sel:[0,1,0] op_sel_hi:[1,1,1]
v_pk_fma_f32 v[38:39], v[36:37], v[2:3], v[38:39] op_sel:[0,0,0] op_sel_hi:[1,0,1]
buffer_load_dwordx4 v128, s[20:23], s44 offen offset:2048 lds
v_pk_fma_f32 v[70:71], v[68:69], v[2:3], v[70:71] op_sel:[0,0,0] op_sel_hi:[1,0,1]
v_pk_fma_f32 v[38:39], v[68:69], v[2:3], v[38:39] op_sel:[0,1,0] op_sel_hi:[1,1,1] neg_lo:[0,1,0] neg_hi:[0,1,0]
v_pk_fma_f32 v[70:71], v[36:37], v[2:3], v[70:71] op_sel:[0,1,0] op_sel_hi:[1,1,1]
v_pk_fma_f32 v[40:41], v[38:39], v[2:3], v[40:41] op_sel:[0,0,0] op_sel_hi:[1,0,1]
v_pk_fma_f32 v[72:73], v[70:71], v[2:3], v[72:73] op_sel:[0,0,0] op_sel_hi:[1,0,1]
v_pk_fma_f32 v[40:41], v[70:71], v[2:3], v[40:41] op_sel:[0,1,0] op_sel_hi:[1,1,1] neg_lo:[0,1,0] neg_hi:[0,1,0]
v_pk_fma_f32 v[72:73], v[38:39], v[2:3], v[72:73] op_sel:[0,1,0] op_sel_hi:[1,1,1]
v_pk_fma_f32 v[42:43], v[40:41], v[2:3], v[42:43] op_sel:[0,0,0] op_sel_hi:[1,0,1]
v_pk_fma_f32 v[74:75], v[72:73], v[2:3], v[74:75] op_sel:[0,0,0] op_sel_hi:[1,0,1]
buffer_load_dwordx4 v129, s[20:23], s44 offen offset:3072 lds
v_pk_fma_f32 v[42:43], v[72:73], v[2:3], v[42:43] op_sel:[0,1,0] op_sel_hi:[1,1,1] neg_lo:[0,1,0] neg_hi:[0,1,0]
v_pk_fma_f32 v[74:75], v[40:41], v[2:3], v[74:75] op_sel:[0,1,0] op_sel_hi:[1,1,1]
v_pk_fma_f32 v[44:45], v[42:43], v[2:3], v[44:45] op_sel:[0,0,0] op_sel_hi:[1,0,1]
v_pk_fma_f32 v[76:77], v[74:75], v[2:3], v[76:77] op_sel:[0,0,0] op_sel_hi:[1,0,1]
v_pk_fma_f32 v[44:45], v[74:75], v[2:3], v[44:45] op_sel:[0,1,0] op_sel_hi:[1,1,1] neg_lo:[0,1,0] neg_hi:[0,1,0]
v_pk_fma_f32 v[76:77], v[42:43], v[2:3], v[76:77] op_sel:[0,1,0] op_sel_hi:[1,1,1]
v_pk_fma_f32 v[46:47], v[44:45], v[2:3], v[46:47] op_sel:[0,0,0] op_sel_hi:[1,0,1]
v_pk_fma_f32 v[78:79], v[76:77], v[2:3], v[78:79] op_sel:[0,0,0] op_sel_hi:[1,0,1]
v_pk_fma_f32 v[46:47], v[76:77], v[2:3], v[46:47] op_sel:[0,1,0] op_sel_hi:[1,1,1] neg_lo:[0,1,0] neg_hi:[0,1,0]
s_add_u32 m0, s42, 69632
s_nop 0
s_nop 0
buffer_load_dwordx4 v130, s[20:23], s44 offen offset:0 lds
v_pk_fma_f32 v[78:79], v[44:45], v[2:3], v[78:79] op_sel:[0,1,0] op_sel_hi:[1,1,1]
v_pk_fma_f32 v[48:49], v[46:47], v[2:3], v[48:49] op_sel:[0,0,0] op_sel_hi:[1,0,1]
v_pk_fma_f32 v[80:81], v[78:79], v[2:3], v[80:81] op_sel:[0,0,0] op_sel_hi:[1,0,1]
v_pk_fma_f32 v[48:49], v[78:79], v[2:3], v[48:49] op_sel:[0,1,0] op_sel_hi:[1,1,1] neg_lo:[0,1,0] neg_hi:[0,1,0]
v_pk_fma_f32 v[80:81], v[46:47], v[2:3], v[80:81] op_sel:[0,1,0] op_sel_hi:[1,1,1]
v_pk_fma_f32 v[50:51], v[48:49], v[2:3], v[50:51] op_sel:[0,0,0] op_sel_hi:[1,0,1]
v_pk_fma_f32 v[82:83], v[80:81], v[2:3], v[82:83] op_sel:[0,0,0] op_sel_hi:[1,0,1]
v_pk_fma_f32 v[50:51], v[80:81], v[2:3], v[50:51] op_sel:[0,1,0] op_sel_hi:[1,1,1] neg_lo:[0,1,0] neg_hi:[0,1,0]
v_pk_fma_f32 v[82:83], v[48:49], v[2:3], v[82:83] op_sel:[0,1,0] op_sel_hi:[1,1,1]
buffer_load_dwordx4 v131, s[20:23], s44 offen offset:1024 lds
v_pk_fma_f32 v[52:53], v[50:51], v[2:3], v[52:53] op_sel:[0,0,0] op_sel_hi:[1,0,1]
v_pk_fma_f32 v[84:85], v[82:83], v[2:3], v[84:85] op_sel:[0,0,0] op_sel_hi:[1,0,1]
v_pk_fma_f32 v[52:53], v[82:83], v[2:3], v[52:53] op_sel:[0,1,0] op_sel_hi:[1,1,1] neg_lo:[0,1,0] neg_hi:[0,1,0]
v_pk_fma_f32 v[84:85], v[50:51], v[2:3], v[84:85] op_sel:[0,1,0] op_sel_hi:[1,1,1]
v_pk_fma_f32 v[54:55], v[52:53], v[2:3], v[54:55] op_sel:[0,0,0] op_sel_hi:[1,0,1]
v_pk_fma_f32 v[86:87], v[84:85], v[2:3], v[86:87] op_sel:[0,0,0] op_sel_hi:[1,0,1]
v_pk_fma_f32 v[54:55], v[84:85], v[2:3], v[54:55] op_sel:[0,1,0] op_sel_hi:[1,1,1] neg_lo:[0,1,0] neg_hi:[0,1,0]
v_pk_fma_f32 v[86:87], v[52:53], v[2:3], v[86:87] op_sel:[0,1,0] op_sel_hi:[1,1,1]
v_pk_fma_f32 v[56:57], v[54:55], v[2:3], v[56:57] op_sel:[0,0,0] op_sel_hi:[1,0,1]
buffer_load_dwordx4 v130, s[20:23], s44 offen offset:2048 lds
v_pk_fma_f32 v[88:89], v[86:87], v[2:3], v[88:89] op_sel:[0,0,0] op_sel_hi:[1,0,1]
v_pk_fma_f32 v[56:57], v[86:87], v[2:3], v[56:57] op_sel:[0,1,0] op_sel_hi:[1,1,1] neg_lo:[0,1,0] neg_hi:[0,1,0]
v_pk_fma_f32 v[88:89], v[54:55], v[2:3], v[88:89] op_sel:[0,1,0] op_sel_hi:[1,1,1]
v_pk_fma_f32 v[58:59], v[56:57], v[2:3], v[58:59] op_sel:[0,0,0] op_sel_hi:[1,0,1]
v_pk_fma_f32 v[90:91], v[88:89], v[2:3], v[90:91] op_sel:[0,0,0] op_sel_hi:[1,0,1]
v_pk_fma_f32 v[58:59], v[88:89], v[2:3], v[58:59] op_sel:[0,1,0] op_sel_hi:[1,1,1] neg_lo:[0,1,0] neg_hi:[0,1,0]
v_pk_fma_f32 v[90:91], v[56:57], v[2:3], v[90:91] op_sel:[0,1,0] op_sel_hi:[1,1,1]
v_pk_fma_f32 v[60:61], v[58:59], v[2:3], v[60:61] op_sel:[0,0,0] op_sel_hi:[1,0,1]
v_pk_fma_f32 v[92:93], v[90:91], v[2:3], v[92:93] op_sel:[0,0,0] op_sel_hi:[1,0,1]
buffer_load_dwordx4 v131, s[20:23], s44 offen offset:3072 lds
v_pk_fma_f32 v[60:61], v[90:91], v[2:3], v[60:61] op_sel:[0,1,0] op_sel_hi:[1,1,1] neg_lo:[0,1,0] neg_hi:[0,1,0]
v_pk_fma_f32 v[92:93], v[58:59], v[2:3], v[92:93] op_sel:[0,1,0] op_sel_hi:[1,1,1]
v_pk_fma_f32 v[62:63], v[60:61], v[2:3], v[62:63] op_sel:[0,0,0] op_sel_hi:[1,0,1]
v_pk_fma_f32 v[94:95], v[92:93], v[2:3], v[94:95] op_sel:[0,0,0] op_sel_hi:[1,0,1]
v_pk_fma_f32 v[62:63], v[92:93], v[2:3], v[62:63] op_sel:[0,1,0] op_sel_hi:[1,1,1] neg_lo:[0,1,0] neg_hi:[0,1,0]
v_pk_fma_f32 v[94:95], v[60:61], v[2:3], v[94:95] op_sel:[0,1,0] op_sel_hi:[1,1,1]
v_pk_mul_f32 v[96:97], v[32:33], v[20:21] op_sel:[0,0] op_sel_hi:[1,0]
v_pk_mul_f32 v[98:99], v[64:65], v[20:21] op_sel:[0,0] op_sel_hi:[1,0] neg_lo:[0,1] neg_hi:[0,1]
v_pk_fma_f32 v[96:97], v[64:65], v[20:21], v[96:97] op_sel:[0,1,0] op_sel_hi:[1,1,1] neg_lo:[0,1,0] neg_hi:[0,1,0]
v_pk_fma_f32 v[98:99], v[32:33], v[20:21], v[98:99] op_sel:[0,1,0] op_sel_hi:[1,1,1] neg_lo:[0,1,0] neg_hi:[0,1,0]
v_pk_mul_f32 v[100:101], v[34:35], v[20:21] op_sel:[0,0] op_sel_hi:[1,0]
v_pk_mul_f32 v[102:103], v[66:67], v[20:21] op_sel:[0,0] op_sel_hi:[1,0] neg_lo:[0,1] neg_hi:[0,1]
v_pk_fma_f32 v[100:101], v[66:67], v[20:21], v[100:101] op_sel:[0,1,0] op_sel_hi:[1,1,1] neg_lo:[0,1,0] neg_hi:[0,1,0]
v_pk_fma_f32 v[102:103], v[34:35], v[20:21], v[102:103] op_sel:[0,1,0] op_sel_hi:[1,1,1] neg_lo:[0,1,0] neg_hi:[0,1,0]
v_cvt_pk_bf16_f32 v224, v96, v97
v_cvt_pk_bf16_f32 v226, v98, v99
v_cvt_pk_bf16_f32 v225, v100, v101
v_cvt_pk_bf16_f32 v227, v102, v103
ds_write_b64 v14, v[224:225] offset:0
ds_write_b64 v14, v[226:227] offset:512
ds_read_b64_tr_b16 v[192:193], v15 offset:0
ds_read_b64_tr_b16 v[194:195], v15 offset:32
v_pk_mul_f32 v[104:105], v[36:37], v[20:21] op_sel:[0,0] op_sel_hi:[1,0]
v_pk_mul_f32 v[106:107], v[68:69], v[20:21] op_sel:[0,0] op_sel_hi:[1,0] neg_lo:[0,1] neg_hi:[0,1]
v_pk_fma_f32 v[104:105], v[68:69], v[20:21], v[104:105] op_sel:[0,1,0] op_sel_hi:[1,1,1] neg_lo:[0,1,0] neg_hi:[0,1,0]
v_pk_fma_f32 v[106:107], v[36:37], v[20:21], v[106:107] op_sel:[0,1,0] op_sel_hi:[1,1,1] neg_lo:[0,1,0] neg_hi:[0,1,0]
v_pk_mul_f32 v[108:109], v[38:39], v[20:21] op_sel:[0,0] op_sel_hi:[1,0]
v_pk_mul_f32 v[110:111], v[70:71], v[20:21] op_sel:[0,0] op_sel_hi:[1,0] neg_lo:[0,1] neg_hi:[0,1]
v_pk_fma_f32 v[108:109], v[70:71], v[20:21], v[108:109] op_sel:[0,1,0] op_sel_hi:[1,1,1] neg_lo:[0,1,0] neg_hi:[0,1,0]
v_pk_fma_f32 v[110:111], v[38:39], v[20:21], v[110:111] op_sel:[0,1,0] op_sel_hi:[1,1,1] neg_lo:[0,1,0] neg_hi:[0,1,0]
v_cvt_pk_bf16_f32 v228, v104, v105
v_cvt_pk_bf16_f32 v230, v106, v107
v_cvt_pk_bf16_f32 v229, v108, v109
v_cvt_pk_bf16_f32 v231, v110, v111
ds_write_b64 v14, v[228:229] offset:1024
ds_write_b64 v14, v[230:231] offset:1536
ds_read_b64_tr_b16 v[196:197], v15 offset:1024
ds_read_b64_tr_b16 v[198:199], v15 offset:1056
v_pk_mul_f32 v[96:97], v[40:41], v[20:21] op_sel:[0,0] op_sel_hi:[1,0]
v_pk_mul_f32 v[98:99], v[72:73], v[20:21] op_sel:[0,0] op_sel_hi:[1,0] neg_lo:[0,1] neg_hi:[0,1]
v_pk_fma_f32 v[96:97], v[72:73], v[20:21], v[96:97] op_sel:[0,1,0] op_sel_hi:[1,1,1] neg_lo:[0,1,0] neg_hi:[0,1,0]
v_pk_fma_f32 v[98:99], v[40:41], v[20:21], v[98:99] op_sel:[0,1,0] op_sel_hi:[1,1,1] neg_lo:[0,1,0] neg_hi:[0,1,0]
v_pk_mul_f32 v[100:101], v[42:43], v[20:21] op_sel:[0,0] op_sel_hi:[1,0]
v_pk_mul_f32 v[102:103], v[74:75], v[20:21] op_sel:[0,0] op_sel_hi:[1,0] neg_lo:[0,1] neg_hi:[0,1]
v_pk_fma_f32 v[100:101], v[74:75], v[20:21], v[100:101] op_sel:[0,1,0] op_sel_hi:[1,1,1] neg_lo:[0,1,0] neg_hi:[0,1,0]
v_pk_fma_f32 v[102:103], v[42:43], v[20:21], v[102:103] op_sel:[0,1,0] op_sel_hi:[1,1,1] neg_lo:[0,1,0] neg_hi:[0,1,0]
v_cvt_pk_bf16_f32 v232, v96, v97
v_cvt_pk_bf16_f32 v234, v98, v99
v_cvt_pk_bf16_f32 v233, v100, v101
v_cvt_pk_bf16_f32 v235, v102, v103
s_waitcnt lgkmcnt(4)
s_nop 0
buffer_store_dwordx4 v[192:195], v18, s[20:23], 0 offen offset:0 sc1
ds_write_b64 v14, v[232:233] offset:2048
ds_write_b64 v14, v[234:235] offset:2560
ds_read_b64_tr_b16 v[200:201], v15 offset:2048
ds_read_b64_tr_b16 v[202:203], v15 offset:2080
v_pk_mul_f32 v[104:105], v[44:45], v[20:21] op_sel:[0,0] op_sel_hi:[1,0]
v_pk_mul_f32 v[106:107], v[76:77], v[20:21] op_sel:[0,0] op_sel_hi:[1,0] neg_lo:[0,1] neg_hi:[0,1]
v_pk_fma_f32 v[104:105], v[76:77], v[20:21], v[104:105] op_sel:[0,1,0] op_sel_hi:[1,1,1] neg_lo:[0,1,0] neg_hi:[0,1,0]
v_pk_fma_f32 v[106:107], v[44:45], v[20:21], v[106:107] op_sel:[0,1,0] op_sel_hi:[1,1,1] neg_lo:[0,1,0] neg_hi:[0,1,0]
v_pk_mul_f32 v[108:109], v[46:47], v[20:21] op_sel:[0,0] op_sel_hi:[1,0]
v_pk_mul_f32 v[110:111], v[78:79], v[20:21] op_sel:[0,0] op_sel_hi:[1,0] neg_lo:[0,1] neg_hi:[0,1]
v_pk_fma_f32 v[108:109], v[78:79], v[20:21], v[108:109] op_sel:[0,1,0] op_sel_hi:[1,1,1] neg_lo:[0,1,0] neg_hi:[0,1,0]
v_pk_fma_f32 v[110:111], v[46:47], v[20:21], v[110:111] op_sel:[0,1,0] op_sel_hi:[1,1,1] neg_lo:[0,1,0] neg_hi:[0,1,0]
v_cvt_pk_bf16_f32 v236, v104, v105
v_cvt_pk_bf16_f32 v238, v106, v107
v_cvt_pk_bf16_f32 v237, v108, v109
v_cvt_pk_bf16_f32 v239, v110, v111
s_waitcnt lgkmcnt(4)
s_nop 0
buffer_store_dwordx4 v[196:199], v18, s[20:23], 0 offen offset:256 sc1
ds_write_b64 v14, v[236:237] offset:0
ds_write_b64 v14, v[238:239] offset:512
ds_read_b64_tr_b16 v[204:205], v15 offset:0
ds_read_b64_tr_b16 v[206:207], v15 offset:32
v_pk_mul_f32 v[96:97], v[48:49], v[20:21] op_sel:[0,0] op_sel_hi:[1,0]
v_pk_mul_f32 v[98:99], v[80:81], v[20:21] op_sel:[0,0] op_sel_hi:[1,0] neg_lo:[0,1] neg_hi:[0,1]
v_pk_fma_f32 v[96:97], v[80:81], v[20:21], v[96:97] op_sel:[0,1,0] op_sel_hi:[1,1,1] neg_lo:[0,1,0] neg_hi:[0,1,0]
v_pk_fma_f32 v[98:99], v[48:49], v[20:21], v[98:99] op_sel:[0,1,0] op_sel_hi:[1,1,1] neg_lo:[0,1,0] neg_hi:[0,1,0]
v_pk_mul_f32 v[100:101], v[50:51], v[20:21] op_sel:[0,0] op_sel_hi:[1,0]
v_pk_mul_f32 v[102:103], v[82:83], v[20:21] op_sel:[0,0] op_sel_hi:[1,0] neg_lo:[0,1] neg_hi:[0,1]
v_pk_fma_f32 v[100:101], v[82:83], v[20:21], v[100:101] op_sel:[0,1,0] op_sel_hi:[1,1,1] neg_lo:[0,1,0] neg_hi:[0,1,0]
v_pk_fma_f32 v[102:103], v[50:51], v[20:21], v[102:103] op_sel:[0,1,0] op_sel_hi:[1,1,1] neg_lo:[0,1,0] neg_hi:[0,1,0]
v_cvt_pk_bf16_f32 v240, v96, v97
v_cvt_pk_bf16_f32 v242, v98, v99
v_cvt_pk_bf16_f32 v241, v100, v101
v_cvt_pk_bf16_f32 v243, v102, v103
s_waitcnt lgkmcnt(4)
s_nop 0
buffer_store_dwordx4 v[200:203], v18, s[20:23], 0 offen offset:512 sc1
ds_write_b64 v14, v[240:241] offset:1024
ds_write_b64 v14, v[242:243] offset:1536
ds_read_b64_tr_b16 v[208:209], v15 offset:1024
ds_read_b64_tr_b16 v[210:211], v15 offset:1056
v_pk_mul_f32 v[104:105], v[52:53], v[20:21] op_sel:[0,0] op_sel_hi:[1,0]
v_pk_mul_f32 v[106:107], v[84:85], v[20:21] op_sel:[0,0] op_sel_hi:[1,0] neg_lo:[0,1] neg_hi:[0,1]
v_pk_fma_f32 v[104:105], v[84:85], v[20:21], v[104:105] op_sel:[0,1,0] op_sel_hi:[1,1,1] neg_lo:[0,1,0] neg_hi:[0,1,0]
v_pk_fma_f32 v[106:107], v[52:53], v[20:21], v[106:107] op_sel:[0,1,0] op_sel_hi:[1,1,1] neg_lo:[0,1,0] neg_hi:[0,1,0]
v_pk_mul_f32 v[108:109], v[54:55], v[20:21] op_sel:[0,0] op_sel_hi:[1,0]
v_pk_mul_f32 v[110:111], v[86:87], v[20:21] op_sel:[0,0] op_sel_hi:[1,0] neg_lo:[0,1] neg_hi:[0,1]
v_pk_fma_f32 v[108:109], v[86:87], v[20:21], v[108:109] op_sel:[0,1,0] op_sel_hi:[1,1,1] neg_lo:[0,1,0] neg_hi:[0,1,0]
v_pk_fma_f32 v[110:111], v[54:55], v[20:21], v[110:111] op_sel:[0,1,0] op_sel_hi:[1,1,1] neg_lo:[0,1,0] neg_hi:[0,1,0]
v_cvt_pk_bf16_f32 v244, v104, v105
v_cvt_pk_bf16_f32 v246, v106, v107
v_cvt_pk_bf16_f32 v245, v108, v109
v_cvt_pk_bf16_f32 v247, v110, v111
s_waitcnt lgkmcnt(4)
s_nop 0
buffer_store_dwordx4 v[204:207], v18, s[20:23], 0 offen offset:768 sc1
ds_write_b64 v14, v[244:245] offset:2048
ds_write_b64 v14, v[246:247] offset:2560
ds_read_b64_tr_b16 v[212:213], v15 offset:2048
ds_read_b64_tr_b16 v[214:215], v15 offset:2080
v_pk_mul_f32 v[96:97], v[56:57], v[20:21] op_sel:[0,0] op_sel_hi:[1,0]
v_pk_mul_f32 v[98:99], v[88:89], v[20:21] op_sel:[0,0] op_sel_hi:[1,0] neg_lo:[0,1] neg_hi:[0,1]
v_pk_fma_f32 v[96:97], v[88:89], v[20:21], v[96:97] op_sel:[0,1,0] op_sel_hi:[1,1,1] neg_lo:[0,1,0] neg_hi:[0,1,0]
v_pk_fma_f32 v[98:99], v[56:57], v[20:21], v[98:99] op_sel:[0,1,0] op_sel_hi:[1,1,1] neg_lo:[0,1,0] neg_hi:[0,1,0]
v_pk_mul_f32 v[100:101], v[58:59], v[20:21] op_sel:[0,0] op_sel_hi:[1,0]
v_pk_mul_f32 v[102:103], v[90:91], v[20:21] op_sel:[0,0] op_sel_hi:[1,0] neg_lo:[0,1] neg_hi:[0,1]
v_pk_fma_f32 v[100:101], v[90:91], v[20:21], v[100:101] op_sel:[0,1,0] op_sel_hi:[1,1,1] neg_lo:[0,1,0] neg_hi:[0,1,0]
v_pk_fma_f32 v[102:103], v[58:59], v[20:21], v[102:103] op_sel:[0,1,0] op_sel_hi:[1,1,1] neg_lo:[0,1,0] neg_hi:[0,1,0]
v_cvt_pk_bf16_f32 v248, v96, v97
v_cvt_pk_bf16_f32 v250, v98, v99
v_cvt_pk_bf16_f32 v249, v100, v101
v_cvt_pk_bf16_f32 v251, v102, v103
s_waitcnt lgkmcnt(4)
s_nop 0
buffer_store_dwordx4 v[208:211], v18, s[20:23], 0 offen offset:1024 sc1
ds_write_b64 v14, v[248:249] offset:0
ds_write_b64 v14, v[250:251] offset:512
ds_read_b64_tr_b16 v[216:217], v15 offset:0
ds_read_b64_tr_b16 v[218:219], v15 offset:32
v_pk_mul_f32 v[104:105], v[60:61], v[20:21] op_sel:[0,0] op_sel_hi:[1,0]
v_pk_mul_f32 v[106:107], v[92:93], v[20:21] op_sel:[0,0] op_sel_hi:[1,0] neg_lo:[0,1] neg_hi:[0,1]
v_pk_fma_f32 v[104:105], v[92:93], v[20:21], v[104:105] op_sel:[0,1,0] op_sel_hi:[1,1,1] neg_lo:[0,1,0] neg_hi:[0,1,0]
v_pk_fma_f32 v[106:107], v[60:61], v[20:21], v[106:107] op_sel:[0,1,0] op_sel_hi:[1,1,1] neg_lo:[0,1,0] neg_hi:[0,1,0]
v_pk_mul_f32 v[108:109], v[62:63], v[20:21] op_sel:[0,0] op_sel_hi:[1,0]
v_pk_mul_f32 v[110:111], v[94:95], v[20:21] op_sel:[0,0] op_sel_hi:[1,0] neg_lo:[0,1] neg_hi:[0,1]
v_pk_fma_f32 v[108:109], v[94:95], v[20:21], v[108:109] op_sel:[0,1,0] op_sel_hi:[1,1,1] neg_lo:[0,1,0] neg_hi:[0,1,0]
v_pk_fma_f32 v[110:111], v[62:63], v[20:21], v[110:111] op_sel:[0,1,0] op_sel_hi:[1,1,1] neg_lo:[0,1,0] neg_hi:[0,1,0]
v_cvt_pk_bf16_f32 v252, v104, v105
v_cvt_pk_bf16_f32 v254, v106, v107
v_cvt_pk_bf16_f32 v253, v108, v109
v_cvt_pk_bf16_f32 v255, v110, v111
s_waitcnt lgkmcnt(4)
buffer_store_dwordx4 v[212:215], v18, s[20:23], 0 offen offset:1280 sc1
ds_write_b64 v14, v[252:253] offset:1024
ds_write_b64 v14, v[254:255] offset:1536
ds_read_b64_tr_b16 v[220:221], v15 offset:1024
ds_read_b64_tr_b16 v[222:223], v15 offset:1056
v_mov_b32 v136, v18
v_mov_b32 v137, v19
v_mov_b32 v138, v24
v_mov_b32 v2, v128
v_mov_b32 v10, v132
v_mov_b32 v3, v129
v_mov_b32 v11, v133
v_mov_b32 v4, v130
v_mov_b32 v12, v134
v_mov_b32 v5, v131
v_mov_b32 v13, v135
v_mov_b32 v30, v26
v_mov_b32 v31, v25
v_mov_b32 v27, v143
v_lshlrev_b32 v22, 4, v0
s_lshl_b32 s66, s6, 11
v_lshlrev_b32 v1, 12, v30
v_lshl_add_u32 v1, v31, 4, v1
v_add_u32_e64 v14, s66, v1
v_add_u32 v15, 0x10000, v14
v_bfe_u32 v1, v0, 2, 2
v_lshl_add_u32 v28, v30, 3, v1
v_lshlrev_b32 v28, 8, v28
v_and_b32 v29, 1, v0
v_lshl_add_u32 v28, v29, 3, v28
v_add_u32 v28, 98304, v28
v_and_b32_e64 v29, 1, v30
v_lshl_add_u32 v1, v29, 2, v1
v_lshlrev_b32_e64 v1, 1, v1
v_bfe_u32 v29, v0, 1, 1
s_lshl_b32 s66, s7, 3
v_add_u32 v29, s66, v29
v_xor_b32 v1, v1, v29
v_xor_b32 v29, 0, v1
v_lshl_add_u32 v18, v29, 4, v28
v_xor_b32_e64 v29, 2, v1
v_lshl_add_u32 v19, v29, 4, v28
v_xor_b32_e64 v29, 4, v1
v_lshl_add_u32 v20, v29, 4, v28
v_xor_b32_e64 v29, 6, v1
v_lshl_add_u32 v21, v29, 4, v28
s_waitcnt lgkmcnt(4)
buffer_store_dwordx4 v[216:219], v136, s[20:23], 0 offen offset:1536 sc1
s_waitcnt lgkmcnt(0)
buffer_store_dwordx4 v[220:223], v136, s[20:23], 0 offen offset:1792 sc1
s_waitcnt vmcnt(25)
s_barrier
KF_k2:
ds_read_b128 a[96:99], v14 offset:0
ds_read_b128 a[100:103], v14 offset:16384
ds_read_b64_tr_b16 a[32:33], v18 offset:0
ds_read_b64_tr_b16 a[34:35], v18 offset:1024
ds_read_b64_tr_b16 a[36:37], v18 offset:8192
ds_read_b64_tr_b16 a[38:39], v18 offset:9216
ds_read_b64_tr_b16 a[40:41], v19 offset:0
ds_read_b64_tr_b16 a[42:43], v19 offset:1024
ds_read_b64_tr_b16 a[44:45], v19 offset:8192
ds_read_b64_tr_b16 a[46:47], v19 offset:9216
ds_read_b128 a[104:107], v14 offset:256
ds_read_b128 a[108:111], v14 offset:16640
ds_read_b64_tr_b16 a[48:49], v20 offset:0
ds_read_b64_tr_b16 a[50:51], v20 offset:1024
ds_read_b64_tr_b16 a[52:53], v20 offset:8192
s_waitcnt lgkmcnt(14)
ds_read_b64_tr_b16 a[54:55], v20 offset:9216
s_waitcnt lgkmcnt(14)
ds_read_b64_tr_b16 a[56:57], v21 offset:0
s_waitcnt lgkmcnt(14)
ds_read_b64_tr_b16 a[58:59], v21 offset:1024
s_waitcnt lgkmcnt(14)
ds_read_b64_tr_b16 a[60:61], v21 offset:8192
s_waitcnt lgkmcnt(14)
ds_read_b64_tr_b16 a[62:63], v21 offset:9216
s_waitcnt lgkmcnt(14)
ds_read_b128 a[112:115], v14 offset:512
s_waitcnt lgkmcnt(14)
ds_read_b128 a[116:119], v14 offset:16896
v_mfma_f32_16x16x32_bf16 v[160:163], a[32:35], a[96:99], 0
v_mfma_f32_16x16x32_bf16 v[160:163], a[36:39], a[100:103], v[160:163]
s_waitcnt lgkmcnt(14)
v_mfma_f32_16x16x32_bf16 v[164:167], a[40:43], a[96:99], 0
s_waitcnt lgkmcnt(12)
v_mfma_f32_16x16x32_bf16 v[164:167], a[44:47], a[100:103], v[164:167]
s_waitcnt lgkmcnt(8)
v_mfma_f32_16x16x32_bf16 v[168:171], a[48:51], a[96:99], 0
s_waitcnt lgkmcnt(6)
v_mfma_f32_16x16x32_bf16 v[168:171], a[52:55], a[100:103], v[168:171]
s_waitcnt lgkmcnt(0)
v_mfma_f32_16x16x32_bf16 v[172:175], a[56:59], a[96:99], 0
ds_read_b128 a[120:123], v14 offset:768
v_mfma_f32_16x16x32_bf16 v[172:175], a[60:63], a[100:103], v[172:175]
ds_read_b128 a[124:127], v14 offset:17152
v_mfma_f32_16x16x32_bf16 v[176:179], a[32:35], a[104:107], 0
ds_read_b128 a[96:99], v14 offset:1024
v_mfma_f32_16x16x32_bf16 v[176:179], a[36:39], a[108:111], v[176:179]
ds_read_b128 a[100:103], v14 offset:17408
v_mfma_f32_16x16x32_bf16 v[180:183], a[40:43], a[104:107], 0
v_mfma_f32_16x16x32_bf16 v[180:183], a[44:47], a[108:111], v[180:183]
v_mfma_f32_16x16x32_bf16 v[184:187], a[48:51], a[104:107], 0
v_mfma_f32_16x16x32_bf16 v[184:187], a[52:55], a[108:111], v[184:187]
v_mfma_f32_16x16x32_bf16 v[188:191], a[56:59], a[104:107], 0
v_mfma_f32_16x16x32_bf16 v[188:191], a[60:63], a[108:111], v[188:191]
v_mfma_f32_16x16x32_bf16 v[192:195], a[32:35], a[112:115], 0
ds_read_b128 a[104:107], v14 offset:1280
v_mfma_f32_16x16x32_bf16 v[192:195], a[36:39], a[116:119], v[192:195]
ds_read_b128 a[108:111], v14 offset:17664
v_mfma_f32_16x16x32_bf16 v[196:199], a[40:43], a[112:115], 0
v_mfma_f32_16x16x32_bf16 v[196:199], a[44:47], a[116:119], v[196:199]
v_mfma_f32_16x16x32_bf16 v[200:203], a[48:51], a[112:115], 0
v_mfma_f32_16x16x32_bf16 v[200:203], a[52:55], a[116:119], v[200:203]
v_mfma_f32_16x16x32_bf16 v[204:207], a[56:59], a[112:115], 0
v_mfma_f32_16x16x32_bf16 v[204:207], a[60:63], a[116:119], v[204:207]
s_waitcnt lgkmcnt(0)
v_mfma_f32_16x16x32_bf16 v[208:211], a[32:35], a[120:123], 0
buffer_load_dword v29, v27, s[20:23], s54 offen offset:128 sc1
v_mfma_f32_16x16x32_bf16 v[208:211], a[36:39], a[124:127], v[208:211]
ds_read_b128 a[112:115], v14 offset:1536
v_mfma_f32_16x16x32_bf16 v[212:215], a[40:43], a[120:123], 0
ds_read_b128 a[116:119], v14 offset:17920
v_mfma_f32_16x16x32_bf16 v[212:215], a[44:47], a[124:127], v[212:215]
v_mfma_f32_16x16x32_bf16 v[216:219], a[48:51], a[120:123], 0
v_mfma_f32_16x16x32_bf16 v[216:219], a[52:55], a[124:127], v[216:219]
v_mfma_f32_16x16x32_bf16 v[220:223], a[56:59], a[120:123], 0
v_mfma_f32_16x16x32_bf16 v[220:223], a[60:63], a[124:127], v[220:223]
v_mfma_f32_16x16x32_bf16 v[224:227], a[32:35], a[96:99], 0
ds_read_b128 a[120:123], v14 offset:1792
v_mfma_f32_16x16x32_bf16 v[224:227], a[36:39], a[100:103], v[224:227]
ds_read_b128 a[124:127], v14 offset:18176
v_mfma_f32_16x16x32_bf16 v[228:231], a[40:43], a[96:99], 0
v_mfma_f32_16x16x32_bf16 v[228:231], a[44:47], a[100:103], v[228:231]
v_mfma_f32_16x16x32_bf16 v[232:235], a[48:51], a[96:99], 0
v_mfma_f32_16x16x32_bf16 v[232:235], a[52:55], a[100:103], v[232:235]
v_mfma_f32_16x16x32_bf16 v[236:239], a[56:59], a[96:99], 0
v_mfma_f32_16x16x32_bf16 v[236:239], a[60:63], a[100:103], v[236:239]
s_waitcnt lgkmcnt(0) vmcnt(18)
s_barrier
v_mfma_f32_16x16x32_bf16 v[240:243], a[32:35], a[104:107], 0
ds_read_b64_tr_b16 a[64:65], v18 offset:16384
v_mfma_f32_16x16x32_bf16 v[240:243], a[36:39], a[108:111], v[240:243]
ds_read_b64_tr_b16 a[66:67], v18 offset:17408
v_mfma_f32_16x16x32_bf16 v[244:247], a[40:43], a[104:107], 0
ds_read_b64_tr_b16 a[68:69], v18 offset:24576
v_mfma_f32_16x16x32_bf16 v[244:247], a[44:47], a[108:111], v[244:247]
ds_read_b64_tr_b16 a[70:71], v18 offset:25600
v_mfma_f32_16x16x32_bf16 v[248:251], a[48:51], a[104:107], 0
ds_read_b128 a[96:99], v14 offset:32768
v_mfma_f32_16x16x32_bf16 v[248:251], a[52:55], a[108:111], v[248:251]
ds_read_b128 a[100:103], v14 offset:49152
v_mfma_f32_16x16x32_bf16 v[252:255], a[56:59], a[104:107], 0
s_add_u32 s45, s41, 1376256
v_mfma_f32_16x16x32_bf16 v[252:255], a[60:63], a[108:111], v[252:255]
s_add_u32 m0, s43, 0
v_mfma_f32_16x16x32_bf16 a[0:3], a[32:35], a[112:115], 0
ds_read_b64_tr_b16 a[72:73], v19 offset:16384
v_mfma_f32_16x16x32_bf16 a[0:3], a[36:39], a[116:119], a[0:3]
ds_read_b64_tr_b16 a[74:75], v19 offset:17408
v_mfma_f32_16x16x32_bf16 a[4:7], a[40:43], a[112:115], 0
ds_read_b64_tr_b16 a[76:77], v19 offset:24576
v_mfma_f32_16x16x32_bf16 a[4:7], a[44:47], a[116:119], a[4:7]
ds_read_b64_tr_b16 a[78:79], v19 offset:25600
v_mfma_f32_16x16x32_bf16 a[8:11], a[48:51], a[112:115], 0
buffer_load_dwordx4 v10, s[12:15], s45 offen offset:0 lds
v_mfma_f32_16x16x32_bf16 a[8:11], a[52:55], a[116:119], a[8:11]
ds_read_b64_tr_b16 a[80:81], v20 offset:16384
v_mfma_f32_16x16x32_bf16 a[12:15], a[56:59], a[112:115], 0
ds_read_b64_tr_b16 a[82:83], v20 offset:17408
v_mfma_f32_16x16x32_bf16 a[12:15], a[60:63], a[116:119], a[12:15]
ds_read_b64_tr_b16 a[84:85], v20 offset:24576
v_mfma_f32_16x16x32_bf16 a[16:19], a[32:35], a[120:123], 0
ds_read_b64_tr_b16 a[86:87], v20 offset:25600
v_mfma_f32_16x16x32_bf16 a[16:19], a[36:39], a[124:127], a[16:19]
ds_read_b64_tr_b16 a[88:89], v21 offset:16384
v_mfma_f32_16x16x32_bf16 a[20:23], a[40:43], a[120:123], 0
v_mfma_f32_16x16x32_bf16 a[20:23], a[44:47], a[124:127], a[20:23]
v_mfma_f32_16x16x32_bf16 a[24:27], a[48:51], a[120:123], 0
s_waitcnt lgkmcnt(3)
ds_read_b64_tr_b16 a[90:91], v21 offset:17408
v_mfma_f32_16x16x32_bf16 a[24:27], a[52:55], a[124:127], a[24:27]
ds_read_b64_tr_b16 a[92:93], v21 offset:24576
v_mfma_f32_16x16x32_bf16 a[28:31], a[56:59], a[120:123], 0
ds_read_b64_tr_b16 a[94:95], v21 offset:25600
v_mfma_f32_16x16x32_bf16 a[28:31], a[60:63], a[124:127], a[28:31]
buffer_load_dwordx4 v11, s[12:15], s45 offen offset:1024 lds
v_mfma_f32_16x16x32_bf16 v[160:163], a[64:67], a[96:99], v[160:163]
ds_read_b128 a[104:107], v14 offset:33024
v_mfma_f32_16x16x32_bf16 v[160:163], a[68:71], a[100:103], v[160:163]
ds_read_b128 a[108:111], v14 offset:49408
v_mfma_f32_16x16x32_bf16 v[164:167], a[72:75], a[96:99], v[164:167]
ds_read_b128 a[112:115], v14 offset:33280
v_mfma_f32_16x16x32_bf16 v[164:167], a[76:79], a[100:103], v[164:167]
buffer_load_dwordx4 v12, s[12:15], s45 offen offset:2048 lds
v_mfma_f32_16x16x32_bf16 v[168:171], a[80:83], a[96:99], v[168:171]
s_waitcnt lgkmcnt(3)
v_mfma_f32_16x16x32_bf16 v[168:171], a[84:87], a[100:103], v[168:171]
ds_read_b128 a[116:119], v14 offset:49664
v_mfma_f32_16x16x32_bf16 v[172:175], a[88:91], a[96:99], v[172:175]
ds_read_b128 a[120:123], v14 offset:33536
v_mfma_f32_16x16x32_bf16 v[172:175], a[92:95], a[100:103], v[172:175]
buffer_load_dwordx4 v13, s[12:15], s45 offen offset:3072 lds
s_waitcnt lgkmcnt(3)
v_mfma_f32_16x16x32_bf16 v[176:179], a[64:67], a[104:107], v[176:179]
s_add_u32 s44, s39, 2752512
v_mfma_f32_16x16x32_bf16 v[176:179], a[68:71], a[108:111], v[176:179]
s_add_u32 m0, s42, 0
v_mfma_f32_16x16x32_bf16 v[180:183], a[72:75], a[104:107], v[180:183]
buffer_load_dwordx4 v2, s[20:23], s44 offen offset:0 lds
v_mfma_f32_16x16x32_bf16 v[180:183], a[76:79], a[108:111], v[180:183]
ds_read_b128 a[124:127], v14 offset:49920
v_mfma_f32_16x16x32_bf16 v[184:187], a[80:83], a[104:107], v[184:187]
ds_read_b128 a[96:99], v14 offset:33792
v_mfma_f32_16x16x32_bf16 v[184:187], a[84:87], a[108:111], v[184:187]
ds_read_b128 a[100:103], v14 offset:50176
v_mfma_f32_16x16x32_bf16 v[188:191], a[88:91], a[104:107], v[188:191]
buffer_load_dwordx4 v3, s[20:23], s44 offen offset:1024 lds
v_mfma_f32_16x16x32_bf16 v[188:191], a[92:95], a[108:111], v[188:191]
s_waitcnt lgkmcnt(3)
v_mfma_f32_16x16x32_bf16 v[192:195], a[64:67], a[112:115], v[192:195]
v_mfma_f32_16x16x32_bf16 v[192:195], a[68:71], a[116:119], v[192:195]
ds_read_b128 a[104:107], v14 offset:34048
v_mfma_f32_16x16x32_bf16 v[196:199], a[72:75], a[112:115], v[196:199]
buffer_load_dwordx4 v2, s[20:23], s44 offen offset:2048 lds
v_mfma_f32_16x16x32_bf16 v[196:199], a[76:79], a[116:119], v[196:199]
ds_read_b128 a[108:111], v14 offset:50432
v_mfma_f32_16x16x32_bf16 v[200:203], a[80:83], a[112:115], v[200:203]
v_mfma_f32_16x16x32_bf16 v[200:203], a[84:87], a[116:119], v[200:203]
v_mfma_f32_16x16x32_bf16 v[204:207], a[88:91], a[112:115], v[204:207]
buffer_load_dwordx4 v3, s[20:23], s44 offen offset:3072 lds
v_mfma_f32_16x16x32_bf16 v[204:207], a[92:95], a[116:119], v[204:207]
s_add_u32 m0, s42, 4096
v_mfma_f32_16x16x32_bf16 v[208:211], a[64:67], a[120:123], v[208:211]
buffer_load_dwordx4 v4, s[20:23], s44 offen offset:0 lds
s_waitcnt lgkmcnt(1)
v_mfma_f32_16x16x32_bf16 v[208:211], a[68:71], a[124:127], v[208:211]
ds_read_b128 a[112:115], v14 offset:34304
v_mfma_f32_16x16x32_bf16 v[212:215], a[72:75], a[120:123], v[212:215]
ds_read_b128 a[116:119], v14 offset:50688
v_mfma_f32_16x16x32_bf16 v[212:215], a[76:79], a[124:127], v[212:215]
v_mfma_f32_16x16x32_bf16 v[216:219], a[80:83], a[120:123], v[216:219]
buffer_load_dwordx4 v5, s[20:23], s44 offen offset:1024 lds
v_mfma_f32_16x16x32_bf16 v[216:219], a[84:87], a[124:127], v[216:219]
v_mfma_f32_16x16x32_bf16 v[220:223], a[88:91], a[120:123], v[220:223]
v_mfma_f32_16x16x32_bf16 v[220:223], a[92:95], a[124:127], v[220:223]
v_mfma_f32_16x16x32_bf16 v[224:227], a[64:67], a[96:99], v[224:227]
buffer_load_dwordx4 v4, s[20:23], s44 offen offset:2048 lds
ds_read_b128 a[120:123], v14 offset:34560
v_mfma_f32_16x16x32_bf16 v[224:227], a[68:71], a[100:103], v[224:227]
ds_read_b128 a[124:127], v14 offset:50944
v_mfma_f32_16x16x32_bf16 v[228:231], a[72:75], a[96:99], v[228:231]
v_mfma_f32_16x16x32_bf16 v[228:231], a[76:79], a[100:103], v[228:231]
v_mfma_f32_16x16x32_bf16 v[232:235], a[80:83], a[96:99], v[232:235]
buffer_load_dwordx4 v5, s[20:23], s44 offen offset:3072 lds
v_mfma_f32_16x16x32_bf16 v[232:235], a[84:87], a[100:103], v[232:235]
s_getpc_b64 s[76:77]
KF_ct2:
s_add_u32 s76, s76, KF_k2+8192-KF_ct2
v_mfma_f32_16x16x32_bf16 v[236:239], a[88:91], a[96:99], v[236:239]
s_addc_u32 s77, s77, 0
s_lshl_b32 s78, s3, 4
v_and_b32 v1, 15, v0
v_add_lshl_u32 v1, v1, s78, 7
v_min_u32 v1, KF_last-(KF_k2+8192), v1
v_mfma_f32_16x16x32_bf16 v[236:239], a[92:95], a[100:103], v[236:239]
global_load_dword a255, v1, s[76:77]
s_waitcnt lgkmcnt(0) vmcnt(22)
s_barrier
v_mfma_f32_16x16x32_bf16 v[240:243], a[64:67], a[104:107], v[240:243]
s_waitcnt vmcnt(13)
v_cmp_ne_u32 vcc, s75, v29
v_mfma_f32_16x16x32_bf16 v[240:243], a[68:71], a[108:111], v[240:243]
ds_read_b64_tr_b16 a[32:33], v18 offset:32768
v_mfma_f32_16x16x32_bf16 v[244:247], a[72:75], a[104:107], v[244:247]
s_cbranch_vccnz KF_f2_slow
KF_f2_ok:
v_mfma_f32_16x16x32_bf16 v[244:247], a[76:79], a[108:111], v[244:247]
s_nop 0
ds_read_b64_tr_b16 a[34:35], v18 offset:33792
v_mfma_f32_16x16x32_bf16 v[248:251], a[80:83], a[104:107], v[248:251]
ds_read_b64_tr_b16 a[36:37], v18 offset:40960
v_mfma_f32_16x16x32_bf16 v[248:251], a[84:87], a[108:111], v[248:251]
ds_read_b64_tr_b16 a[38:39], v18 offset:41984
v_mfma_f32_16x16x32_bf16 v[252:255], a[88:91], a[104:107], v[252:255]
ds_read_b128 a[96:99], v15 offset:0
v_mfma_f32_16x16x32_bf16 v[252:255], a[92:95], a[108:111], v[252:255]
ds_read_b128 a[100:103], v15 offset:16384
v_mfma_f32_16x16x32_bf16 a[0:3], a[64:67], a[112:115], a[0:3]
s_add_u32 s45, s41, 32768
v_mfma_f32_16x16x32_bf16 a[0:3], a[68:71], a[116:119], a[0:3]
s_add_u32 m0, s43, 16384
v_mfma_f32_16x16x32_bf16 a[4:7], a[72:75], a[112:115], a[4:7]
ds_read_b64_tr_b16 a[40:41], v19 offset:32768
v_mfma_f32_16x16x32_bf16 a[4:7], a[76:79], a[116:119], a[4:7]
ds_read_b64_tr_b16 a[42:43], v19 offset:33792
v_mfma_f32_16x16x32_bf16 a[8:11], a[80:83], a[112:115], a[8:11]
ds_read_b64_tr_b16 a[44:45], v19 offset:40960
v_mfma_f32_16x16x32_bf16 a[8:11], a[84:87], a[116:119], a[8:11]
ds_read_b64_tr_b16 a[46:47], v19 offset:41984
v_mfma_f32_16x16x32_bf16 a[12:15], a[88:91], a[112:115], a[12:15]
buffer_load_dwordx4 v10, s[12:15], s45 offen offset:0 lds
v_mfma_f32_16x16x32_bf16 a[12:15], a[92:95], a[116:119], a[12:15]
ds_read_b64_tr_b16 a[48:49], v20 offset:32768
v_mfma_f32_16x16x32_bf16 a[16:19], a[64:67], a[120:123], a[16:19]
ds_read_b64_tr_b16 a[50:51], v20 offset:33792
v_mfma_f32_16x16x32_bf16 a[16:19], a[68:71], a[124:127], a[16:19]
ds_read_b64_tr_b16 a[52:53], v20 offset:40960
v_mfma_f32_16x16x32_bf16 a[20:23], a[72:75], a[120:123], a[20:23]
ds_read_b64_tr_b16 a[54:55], v20 offset:41984
v_mfma_f32_16x16x32_bf16 a[20:23], a[76:79], a[124:127], a[20:23]
ds_read_b64_tr_b16 a[56:57], v21 offset:32768
v_mfma_f32_16x16x32_bf16 a[24:27], a[80:83], a[120:123], a[24:27]
s_waitcnt lgkmcnt(5)
ds_read_b64_tr_b16 a[58:59], v21 offset:33792
v_mfma_f32_16x16x32_bf16 a[24:27], a[84:87], a[124:127], a[24:27]
ds_read_b64_tr_b16 a[60:61], v21 offset:40960
v_mfma_f32_16x16x32_bf16 a[28:31], a[88:91], a[120:123], a[28:31]
ds_read_b64_tr_b16 a[62:63], v21 offset:41984
v_mfma_f32_16x16x32_bf16 a[28:31], a[92:95], a[124:127], a[28:31]
buffer_load_dwordx4 v11, s[12:15], s45 offen offset:1024 lds
v_mfma_f32_16x16x32_bf16 v[160:163], a[32:35], a[96:99], v[160:163]
ds_read_b128 a[104:107], v15 offset:256
v_mfma_f32_16x16x32_bf16 v[160:163], a[36:39], a[100:103], v[160:163]
ds_read_b128 a[108:111], v15 offset:16640
v_mfma_f32_16x16x32_bf16 v[164:167], a[40:43], a[96:99], v[164:167]
ds_read_b128 a[112:115], v15 offset:512
v_mfma_f32_16x16x32_bf16 v[164:167], a[44:47], a[100:103], v[164:167]
buffer_load_dwordx4 v12, s[12:15], s45 offen offset:2048 lds
s_waitcnt lgkmcnt(4)
v_mfma_f32_16x16x32_bf16 v[168:171], a[48:51], a[96:99], v[168:171]
ds_read_b128 a[116:119], v15 offset:16896
v_mfma_f32_16x16x32_bf16 v[168:171], a[52:55], a[100:103], v[168:171]
ds_read_b128 a[120:123], v15 offset:768
v_mfma_f32_16x16x32_bf16 v[172:175], a[56:59], a[96:99], v[172:175]
s_waitcnt lgkmcnt(4)
v_mfma_f32_16x16x32_bf16 v[172:175], a[60:63], a[100:103], v[172:175]
buffer_load_dwordx4 v13, s[12:15], s45 offen offset:3072 lds
v_mfma_f32_16x16x32_bf16 v[176:179], a[32:35], a[104:107], v[176:179]
s_add_u32 s44, s39, 65536
s_waitcnt lgkmcnt(2)
v_mfma_f32_16x16x32_bf16 v[176:179], a[36:39], a[108:111], v[176:179]
s_add_u32 m0, s42, 32768
v_mfma_f32_16x16x32_bf16 v[180:183], a[40:43], a[104:107], v[180:183]
buffer_load_dwordx4 v2, s[20:23], s44 offen offset:0 lds
v_mfma_f32_16x16x32_bf16 v[180:183], a[44:47], a[108:111], v[180:183]
ds_read_b128 a[124:127], v15 offset:17152
v_mfma_f32_16x16x32_bf16 v[184:187], a[48:51], a[104:107], v[184:187]
ds_read_b128 a[96:99], v15 offset:1024
v_mfma_f32_16x16x32_bf16 v[184:187], a[52:55], a[108:111], v[184:187]
ds_read_b128 a[100:103], v15 offset:17408
v_mfma_f32_16x16x32_bf16 v[188:191], a[56:59], a[104:107], v[188:191]
buffer_load_dwordx4 v3, s[20:23], s44 offen offset:1024 lds
v_mfma_f32_16x16x32_bf16 v[188:191], a[60:63], a[108:111], v[188:191]
v_mfma_f32_16x16x32_bf16 v[192:195], a[32:35], a[112:115], v[192:195]
s_waitcnt lgkmcnt(3)
v_mfma_f32_16x16x32_bf16 v[192:195], a[36:39], a[116:119], v[192:195]
ds_read_b128 a[104:107], v15 offset:1280
v_mfma_f32_16x16x32_bf16 v[196:199], a[40:43], a[112:115], v[196:199]
buffer_load_dwordx4 v2, s[20:23], s44 offen offset:2048 lds
v_mfma_f32_16x16x32_bf16 v[196:199], a[44:47], a[116:119], v[196:199]
ds_read_b128 a[108:111], v15 offset:17664
v_mfma_f32_16x16x32_bf16 v[200:203], a[48:51], a[112:115], v[200:203]
v_mfma_f32_16x16x32_bf16 v[200:203], a[52:55], a[116:119], v[200:203]
v_mfma_f32_16x16x32_bf16 v[204:207], a[56:59], a[112:115], v[204:207]
buffer_load_dwordx4 v3, s[20:23], s44 offen offset:3072 lds
v_mfma_f32_16x16x32_bf16 v[204:207], a[60:63], a[116:119], v[204:207]
s_add_u32 m0, s42, 36864
v_mfma_f32_16x16x32_bf16 v[208:211], a[32:35], a[120:123], v[208:211]
buffer_load_dwordx4 v4, s[20:23], s44 offen offset:0 lds
s_waitcnt lgkmcnt(1)
v_mfma_f32_16x16x32_bf16 v[208:211], a[36:39], a[124:127], v[208:211]
ds_read_b128 a[112:115], v15 offset:1536
v_mfma_f32_16x16x32_bf16 v[212:215], a[40:43], a[120:123], v[212:215]
ds_read_b128 a[116:119], v15 offset:17920
v_mfma_f32_16x16x32_bf16 v[212:215], a[44:47], a[124:127], v[212:215]
v_mfma_f32_16x16x32_bf16 v[216:219], a[48:51], a[120:123], v[216:219]
buffer_load_dwordx4 v5, s[20:23], s44 offen offset:1024 lds
v_mfma_f32_16x16x32_bf16 v[216:219], a[52:55], a[124:127], v[216:219]
v_mfma_f32_16x16x32_bf16 v[220:223], a[56:59], a[120:123], v[220:223]
v_mfma_f32_16x16x32_bf16 v[220:223], a[60:63], a[124:127], v[220:223]
v_mfma_f32_16x16x32_bf16 v[224:227], a[32:35], a[96:99], v[224:227]
buffer_load_dwordx4 v4, s[20:23], s44 offen offset:2048 lds
ds_read_b128 a[120:123], v15 offset:1792
v_mfma_f32_16x16x32_bf16 v[224:227], a[36:39], a[100:103], v[224:227]
ds_read_b128 a[124:127], v15 offset:18176
v_mfma_f32_16x16x32_bf16 v[228:231], a[40:43], a[96:99], v[228:231]
v_mfma_f32_16x16x32_bf16 v[228:231], a[44:47], a[100:103], v[228:231]
v_mfma_f32_16x16x32_bf16 v[232:235], a[48:51], a[96:99], v[232:235]
buffer_load_dwordx4 v5, s[20:23], s44 offen offset:3072 lds
v_mfma_f32_16x16x32_bf16 v[232:235], a[52:55], a[100:103], v[232:235]
v_mfma_f32_16x16x32_bf16 v[236:239], a[56:59], a[96:99], v[236:239]
v_mfma_f32_16x16x32_bf16 v[236:239], a[60:63], a[100:103], v[236:239]
s_waitcnt lgkmcnt(0) vmcnt(13)
s_barrier
v_mfma_f32_16x16x32_bf16 v[240:243], a[32:35], a[104:107], v[240:243]
ds_read_b64_tr_b16 a[64:65], v18 offset:0
ds_read_b64_tr_b16 a[66:67], v18 offset:1024
v_mfma_f32_16x16x32_bf16 v[240:243], a[36:39], a[108:111], v[240:243]
ds_read_b64_tr_b16 a[68:69], v18 offset:8192
ds_read_b64_tr_b16 a[70:71], v18 offset:9216
v_mfma_f32_16x16x32_bf16 v[244:247], a[40:43], a[104:107], v[244:247]
ds_read_b128 a[96:99], v14 offset:0
ds_read_b128 a[100:103], v14 offset:16384
v_mfma_f32_16x16x32_bf16 v[244:247], a[44:47], a[108:111], v[244:247]
s_add_u32 s45, s41, 491520
ds_read_b64_tr_b16 a[72:73], v19 offset:0
v_mfma_f32_16x16x32_bf16 v[248:251], a[48:51], a[104:107], v[248:251]
s_add_u32 m0, s43, 32768
ds_read_b64_tr_b16 a[74:75], v19 offset:1024
v_mfma_f32_16x16x32_bf16 v[248:251], a[52:55], a[108:111], v[248:251]
ds_read_b64_tr_b16 a[76:77], v19 offset:8192
ds_read_b64_tr_b16 a[78:79], v19 offset:9216
v_mfma_f32_16x16x32_bf16 v[252:255], a[56:59], a[104:107], v[252:255]
buffer_load_dwordx4 v10, s[12:15], s45 offen offset:0 lds
ds_read_b64_tr_b16 a[80:81], v20 offset:0
v_mfma_f32_16x16x32_bf16 v[252:255], a[60:63], a[108:111], v[252:255]
ds_read_b64_tr_b16 a[82:83], v20 offset:1024
ds_read_b64_tr_b16 a[84:85], v20 offset:8192
v_mfma_f32_16x16x32_bf16 a[0:3], a[32:35], a[112:115], a[0:3]
ds_read_b64_tr_b16 a[86:87], v20 offset:9216
ds_read_b64_tr_b16 a[88:89], v21 offset:0
v_mfma_f32_16x16x32_bf16 a[0:3], a[36:39], a[116:119], a[0:3]
s_waitcnt lgkmcnt(8)
ds_read_b64_tr_b16 a[90:91], v21 offset:1024
v_mfma_f32_16x16x32_bf16 a[4:7], a[40:43], a[112:115], a[4:7]
ds_read_b64_tr_b16 a[92:93], v21 offset:8192
ds_read_b64_tr_b16 a[94:95], v21 offset:9216
v_mfma_f32_16x16x32_bf16 a[4:7], a[44:47], a[116:119], a[4:7]
buffer_load_dwordx4 v11, s[12:15], s45 offen offset:1024 lds
ds_read_b128 a[104:107], v14 offset:256
v_mfma_f32_16x16x32_bf16 a[8:11], a[48:51], a[112:115], a[8:11]
ds_read_b128 a[108:111], v14 offset:16640
v_lshrrev_b32 v28, 3, v0
v_mfma_f32_16x16x32_bf16 a[8:11], a[52:55], a[116:119], a[8:11]
v_and_b32 v29, 7, v0
v_lshrrev_b32 v1, 1, v28
v_mfma_f32_16x16x32_bf16 a[12:15], a[56:59], a[112:115], a[12:15]
v_xor_b32_e64 v29, v29, v1
v_mfma_f32_16x16x32_bf16 a[12:15], a[60:63], a[116:119], a[12:15]
buffer_load_dwordx4 v12, s[12:15], s45 offen offset:2048 lds
v_mfma_f32_16x16x32_bf16 a[16:19], a[32:35], a[120:123], a[16:19]
ds_read_b128 a[112:115], v14 offset:512
v_mfma_f32_16x16x32_bf16 a[16:19], a[36:39], a[124:127], a[16:19]
ds_read_b128 a[116:119], v14 offset:16896
v_mfma_f32_16x16x32_bf16 a[20:23], a[40:43], a[120:123], a[20:23]
v_lshlrev_b32_e64 v29, 4, v29
v_mfma_f32_16x16x32_bf16 a[20:23], a[44:47], a[124:127], a[20:23]
buffer_load_dwordx4 v13, s[12:15], s45 offen offset:3072 lds
v_mfma_f32_16x16x32_bf16 a[24:27], a[48:51], a[120:123], a[24:27]
s_add_u32 s44, s39, 983040
v_mfma_f32_16x16x32_bf16 a[24:27], a[52:55], a[124:127], a[24:27]
s_add_u32 m0, s42, 65536
v_mfma_f32_16x16x32_bf16 a[28:31], a[56:59], a[120:123], a[28:31]
buffer_load_dwordx4 v2, s[20:23], s44 offen offset:0 lds
v_mfma_f32_16x16x32_bf16 a[28:31], a[60:63], a[124:127], a[28:31]
s_lshl_b32 s66, s99, 7
v_mfma_f32_16x16x32_bf16 v[160:163], a[64:67], a[96:99], v[160:163]
s_waitcnt lgkmcnt(0)
ds_read_b128 a[120:123], v14 offset:768
v_mfma_f32_16x16x32_bf16 v[160:163], a[68:71], a[100:103], v[160:163]
ds_read_b128 a[124:127], v14 offset:17152
v_mfma_f32_16x16x32_bf16 v[164:167], a[72:75], a[96:99], v[164:167]
buffer_load_dwordx4 v3, s[20:23], s44 offen offset:1024 lds
v_mfma_f32_16x16x32_bf16 v[164:167], a[76:79], a[100:103], v[164:167]
s_lshl_b32 s67, s3, 5
v_mfma_f32_16x16x32_bf16 v[168:171], a[80:83], a[96:99], v[168:171]
s_add_u32 s66, s66, s67
v_mfma_f32_16x16x32_bf16 v[168:171], a[84:87], a[100:103], v[168:171]
v_add_u32_e64 v28, s66, v28
v_mfma_f32_16x16x32_bf16 v[172:175], a[88:91], a[96:99], v[172:175]
buffer_load_dwordx4 v2, s[20:23], s44 offen offset:2048 lds
v_mfma_f32_16x16x32_bf16 v[172:175], a[92:95], a[100:103], v[172:175]
v_lshlrev_b32_e64 v28, 11, v28
v_mfma_f32_16x16x32_bf16 v[176:179], a[64:67], a[104:107], v[176:179]
ds_read_b128 a[96:99], v14 offset:1024
v_mfma_f32_16x16x32_bf16 v[176:179], a[68:71], a[108:111], v[176:179]
ds_read_b128 a[100:103], v14 offset:17408
v_mfma_f32_16x16x32_bf16 v[180:183], a[72:75], a[104:107], v[180:183]
buffer_load_dwordx4 v3, s[20:23], s44 offen offset:3072 lds
v_mfma_f32_16x16x32_bf16 v[180:183], a[76:79], a[108:111], v[180:183]
s_add_u32 m0, s42, 69632
v_mfma_f32_16x16x32_bf16 v[184:187], a[80:83], a[104:107], v[184:187]
buffer_load_dwordx4 v4, s[20:23], s44 offen offset:0 lds
v_mfma_f32_16x16x32_bf16 v[184:187], a[84:87], a[108:111], v[184:187]
v_add_u32_e64 v6, v28, v29
v_mfma_f32_16x16x32_bf16 v[188:191], a[88:91], a[104:107], v[188:191]
v_xor_b32_e64 v29, 64, v29
v_mfma_f32_16x16x32_bf16 v[188:191], a[92:95], a[108:111], v[188:191]
v_add_u32_e64 v7, v28, v29
v_mfma_f32_16x16x32_bf16 v[192:195], a[64:67], a[112:115], v[192:195]
buffer_load_dwordx4 v5, s[20:23], s44 offen offset:1024 lds
v_mfma_f32_16x16x32_bf16 v[192:195], a[68:71], a[116:119], v[192:195]
ds_read_b128 a[104:107], v14 offset:1280
v_mfma_f32_16x16x32_bf16 v[196:199], a[72:75], a[112:115], v[196:199]
ds_read_b128 a[108:111], v14 offset:17664
v_mfma_f32_16x16x32_bf16 v[196:199], a[76:79], a[116:119], v[196:199]
v_add_u32 v7, 15360, v7
v_mfma_f32_16x16x32_bf16 v[200:203], a[80:83], a[112:115], v[200:203]
buffer_load_dwordx4 v4, s[20:23], s44 offen offset:2048 lds
v_mfma_f32_16x16x32_bf16 v[200:203], a[84:87], a[116:119], v[200:203]
v_add_u32 v8, 30720, v6
v_mfma_f32_16x16x32_bf16 v[204:207], a[88:91], a[112:115], v[204:207]
v_add_u32 v9, 30720, v7
v_mfma_f32_16x16x32_bf16 v[204:207], a[92:95], a[116:119], v[204:207]
v_lshrrev_b32 v1, 1, v31
s_waitcnt lgkmcnt(1)
v_mfma_f32_16x16x32_bf16 v[208:211], a[64:67], a[120:123], v[208:211]
ds_read_b128 a[112:115], v14 offset:1536
v_mfma_f32_16x16x32_bf16 v[208:211], a[68:71], a[124:127], v[208:211]
ds_read_b128 a[116:119], v14 offset:17920
v_mfma_f32_16x16x32_bf16 v[212:215], a[72:75], a[120:123], v[212:215]
buffer_load_dwordx4 v5, s[20:23], s44 offen offset:3072 lds
v_mfma_f32_16x16x32_bf16 v[212:215], a[76:79], a[124:127], v[212:215]
v_xor_b32_e64 v1, v1, v30
v_mfma_f32_16x16x32_bf16 v[216:219], a[80:83], a[120:123], v[216:219]
buffer_store_dword v137, v138, s[20:23], s55 offen offset:256 sc1
v_mfma_f32_16x16x32_bf16 v[216:219], a[84:87], a[124:127], v[216:219]
v_lshlrev_b32_e64 v1, 4, v1
v_mfma_f32_16x16x32_bf16 v[220:223], a[88:91], a[120:123], v[220:223]
v_lshl_add_u32 v1, v31, 7, v1
v_mfma_f32_16x16x32_bf16 v[220:223], a[92:95], a[124:127], v[220:223]
s_lshl_b32 s66, s7, 13
v_mfma_f32_16x16x32_bf16 v[224:227], a[64:67], a[96:99], v[224:227]
ds_read_b128 a[120:123], v14 offset:1792
v_mfma_f32_16x16x32_bf16 v[224:227], a[68:71], a[100:103], v[224:227]
ds_read_b128 a[124:127], v14 offset:18176
v_mfma_f32_16x16x32_bf16 v[228:231], a[72:75], a[96:99], v[228:231]
s_add_u32 s66, s66, 98304
v_mfma_f32_16x16x32_bf16 v[228:231], a[76:79], a[100:103], v[228:231]
v_add_u32 v16, s66, v1
v_mfma_f32_16x16x32_bf16 v[232:235], a[80:83], a[96:99], v[232:235]
v_xor_b32_e64 v17, 64, v16
v_mfma_f32_16x16x32_bf16 v[232:235], a[84:87], a[100:103], v[232:235]
v_lshrrev_b32_e64 v1, 2, v31
v_mfma_f32_16x16x32_bf16 v[236:239], a[88:91], a[96:99], v[236:239]
v_lshlrev_b32_e64 v1, 5, v1
v_mfma_f32_16x16x32_bf16 v[236:239], a[92:95], a[100:103], v[236:239]
v_and_b32 v28, 1, v31
s_waitcnt lgkmcnt(0) vmcnt(13)
s_barrier
v_mfma_f32_16x16x32_bf16 v[240:243], a[64:67], a[104:107], v[240:243]
ds_read_b64_tr_b16 a[32:33], v18 offset:16384
ds_read_b64_tr_b16 a[34:35], v18 offset:17408
v_mfma_f32_16x16x32_bf16 v[240:243], a[68:71], a[108:111], v[240:243]
ds_read_b64_tr_b16 a[36:37], v18 offset:24576
ds_read_b64_tr_b16 a[38:39], v18 offset:25600
v_mfma_f32_16x16x32_bf16 v[244:247], a[72:75], a[104:107], v[244:247]
ds_read_b128 a[96:99], v14 offset:32768
ds_read_b128 a[100:103], v14 offset:49152
v_mfma_f32_16x16x32_bf16 v[244:247], a[76:79], a[108:111], v[244:247]
s_add_u32 s45, s41, 950272
ds_read_b64_tr_b16 a[40:41], v19 offset:16384
v_mfma_f32_16x16x32_bf16 v[248:251], a[80:83], a[104:107], v[248:251]
s_add_u32 m0, s43, 0
ds_read_b64_tr_b16 a[42:43], v19 offset:17408
v_mfma_f32_16x16x32_bf16 v[248:251], a[84:87], a[108:111], v[248:251]
ds_read_b64_tr_b16 a[44:45], v19 offset:24576
ds_read_b64_tr_b16 a[46:47], v19 offset:25600
v_mfma_f32_16x16x32_bf16 v[252:255], a[88:91], a[104:107], v[252:255]
buffer_load_dwordx4 v10, s[12:15], s45 offen offset:0 lds
ds_read_b64_tr_b16 a[48:49], v20 offset:16384
v_mfma_f32_16x16x32_bf16 v[252:255], a[92:95], a[108:111], v[252:255]
ds_read_b64_tr_b16 a[50:51], v20 offset:17408
ds_read_b64_tr_b16 a[52:53], v20 offset:24576
v_mfma_f32_16x16x32_bf16 a[0:3], a[64:67], a[112:115], a[0:3]
ds_read_b64_tr_b16 a[54:55], v20 offset:25600
ds_read_b64_tr_b16 a[56:57], v21 offset:16384
v_mfma_f32_16x16x32_bf16 a[0:3], a[68:71], a[116:119], a[0:3]
s_waitcnt lgkmcnt(8)
ds_read_b64_tr_b16 a[58:59], v21 offset:17408
v_mfma_f32_16x16x32_bf16 a[4:7], a[72:75], a[112:115], a[4:7]
ds_read_b64_tr_b16 a[60:61], v21 offset:24576
ds_read_b64_tr_b16 a[62:63], v21 offset:25600
v_mfma_f32_16x16x32_bf16 a[4:7], a[76:79], a[116:119], a[4:7]
buffer_load_dwordx4 v11, s[12:15], s45 offen offset:1024 lds
ds_read_b128 a[104:107], v14 offset:33024
v_mfma_f32_16x16x32_bf16 a[8:11], a[80:83], a[112:115], a[8:11]
ds_read_b128 a[108:111], v14 offset:49408
v_lshl_add_u32 v1, v28, 4, v1
v_mfma_f32_16x16x32_bf16 a[8:11], a[84:87], a[116:119], a[8:11]
v_bfe_u32 v28, v31, 1, 1
v_mfma_f32_16x16x32_bf16 a[12:15], a[88:91], a[112:115], a[12:15]
v_add_u32 v1, v1, v28
v_mfma_f32_16x16x32_bf16 a[12:15], a[92:95], a[116:119], a[12:15]
buffer_load_dwordx4 v12, s[12:15], s45 offen offset:2048 lds
v_mfma_f32_16x16x32_bf16 a[16:19], a[64:67], a[120:123], a[16:19]
ds_read_b128 a[112:115], v14 offset:33280
v_mfma_f32_16x16x32_bf16 a[16:19], a[68:71], a[124:127], a[16:19]
ds_read_b128 a[116:119], v14 offset:49664
v_mfma_f32_16x16x32_bf16 a[20:23], a[72:75], a[120:123], a[20:23]
s_lshl_b32 s66, s4, 8
v_mfma_f32_16x16x32_bf16 a[20:23], a[76:79], a[124:127], a[20:23]
buffer_load_dwordx4 v13, s[12:15], s45 offen offset:3072 lds
v_mfma_f32_16x16x32_bf16 a[24:27], a[80:83], a[120:123], a[24:27]
s_add_u32 s44, s39, 1900544
v_mfma_f32_16x16x32_bf16 a[24:27], a[84:87], a[124:127], a[24:27]
s_add_u32 m0, s42, 0
v_mfma_f32_16x16x32_bf16 a[28:31], a[88:91], a[120:123], a[28:31]
buffer_load_dwordx4 v2, s[20:23], s44 offen offset:0 lds
v_mfma_f32_16x16x32_bf16 a[28:31], a[92:95], a[124:127], a[28:31]
s_lshl_b32 s67, s6, 7
v_mfma_f32_16x16x32_bf16 v[160:163], a[32:35], a[96:99], v[160:163]
s_waitcnt lgkmcnt(0)
ds_read_b128 a[120:123], v14 offset:33536
v_mfma_f32_16x16x32_bf16 v[160:163], a[36:39], a[100:103], v[160:163]
ds_read_b128 a[124:127], v14 offset:49920
v_mfma_f32_16x16x32_bf16 v[164:167], a[40:43], a[96:99], v[164:167]
buffer_load_dwordx4 v3, s[20:23], s44 offen offset:1024 lds
v_mfma_f32_16x16x32_bf16 v[164:167], a[44:47], a[100:103], v[164:167]
s_add_u32 s66, s66, s67
v_mfma_f32_16x16x32_bf16 v[168:171], a[48:51], a[96:99], v[168:171]
s_lshl_b32 s67, s98, 2
v_mfma_f32_16x16x32_bf16 v[168:171], a[52:55], a[100:103], v[168:171]
s_add_u32 s66, s66, s67
v_mfma_f32_16x16x32_bf16 v[172:175], a[56:59], a[96:99], v[172:175]
buffer_load_dwordx4 v2, s[20:23], s44 offen offset:2048 lds
v_mfma_f32_16x16x32_bf16 v[172:175], a[60:63], a[100:103], v[172:175]
v_add_u32 v1, s66, v1
v_mfma_f32_16x16x32_bf16 v[176:179], a[32:35], a[104:107], v[176:179]
ds_read_b128 a[96:99], v14 offset:33792
v_mfma_f32_16x16x32_bf16 v[176:179], a[36:39], a[108:111], v[176:179]
ds_read_b128 a[100:103], v14 offset:50176
v_mfma_f32_16x16x32_bf16 v[180:183], a[40:43], a[104:107], v[180:183]
buffer_load_dwordx4 v3, s[20:23], s44 offen offset:3072 lds
v_mfma_f32_16x16x32_bf16 v[180:183], a[44:47], a[108:111], v[180:183]
s_add_u32 m0, s42, 4096
v_mfma_f32_16x16x32_bf16 v[184:187], a[48:51], a[104:107], v[184:187]
buffer_load_dwordx4 v4, s[20:23], s44 offen offset:0 lds
v_mfma_f32_16x16x32_bf16 v[184:187], a[52:55], a[108:111], v[184:187]
s_lshl_b32 s66, s99, 7
v_mfma_f32_16x16x32_bf16 v[188:191], a[56:59], a[104:107], v[188:191]
s_lshl_b32 s67, s7, 6
v_mfma_f32_16x16x32_bf16 v[188:191], a[60:63], a[108:111], v[188:191]
s_add_u32 s66, s66, s67
v_mfma_f32_16x16x32_bf16 v[192:195], a[32:35], a[112:115], v[192:195]
buffer_load_dwordx4 v5, s[20:23], s44 offen offset:1024 lds
v_mfma_f32_16x16x32_bf16 v[192:195], a[36:39], a[116:119], v[192:195]
ds_read_b128 a[104:107], v14 offset:34048
v_mfma_f32_16x16x32_bf16 v[196:199], a[40:43], a[112:115], v[196:199]
ds_read_b128 a[108:111], v14 offset:50432
v_mfma_f32_16x16x32_bf16 v[196:199], a[44:47], a[116:119], v[196:199]
v_lshl_add_u32 v28, v30, 2, s66
v_mfma_f32_16x16x32_bf16 v[200:203], a[48:51], a[112:115], v[200:203]
buffer_load_dwordx4 v4, s[20:23], s44 offen offset:2048 lds
v_mfma_f32_16x16x32_bf16 v[200:203], a[52:55], a[116:119], v[200:203]
v_accvgpr_write_b32 a169, v28
v_mfma_f32_16x16x32_bf16 v[204:207], a[56:59], a[112:115], v[204:207]
v_lshl_add_u32 v1, v1, 10, v28
v_mfma_f32_16x16x32_bf16 v[204:207], a[60:63], a[116:119], v[204:207]
v_accvgpr_write_b32 a168, v1
s_waitcnt lgkmcnt(1)
v_mfma_f32_16x16x32_bf16 v[208:211], a[32:35], a[120:123], v[208:211]
ds_read_b128 a[112:115], v14 offset:34304
v_mfma_f32_16x16x32_bf16 v[208:211], a[36:39], a[124:127], v[208:211]
ds_read_b128 a[116:119], v14 offset:50688
v_mfma_f32_16x16x32_bf16 v[212:215], a[40:43], a[120:123], v[212:215]
buffer_load_dwordx4 v5, s[20:23], s44 offen offset:3072 lds
v_mfma_f32_16x16x32_bf16 v[212:215], a[44:47], a[124:127], v[212:215]
s_lshl_b32 s66, s6, 10
v_mfma_f32_16x16x32_bf16 v[216:219], a[48:51], a[120:123], v[216:219]
s_add_u32 s66, s66, 147456
v_mfma_f32_16x16x32_bf16 v[216:219], a[52:55], a[124:127], v[216:219]
v_lshlrev_b32 v23, 3, v31
v_mfma_f32_16x16x32_bf16 v[220:223], a[56:59], a[120:123], v[220:223]
v_add_u32_e64 v23, s66, v23
v_mfma_f32_16x16x32_bf16 v[220:223], a[60:63], a[124:127], v[220:223]
s_lshl_b32 s67, s100, 8
v_mfma_f32_16x16x32_bf16 v[224:227], a[32:35], a[96:99], v[224:227]
ds_read_b128 a[120:123], v14 offset:34560
v_mfma_f32_16x16x32_bf16 v[224:227], a[36:39], a[100:103], v[224:227]
ds_read_b128 a[124:127], v14 offset:50944
v_mfma_f32_16x16x32_bf16 v[228:231], a[40:43], a[96:99], v[228:231]
v_xor_b32 v23, s67, v23
v_mfma_f32_16x16x32_bf16 v[228:231], a[44:47], a[100:103], v[228:231]
v_xor_b32 v24, 256, v23
v_mfma_f32_16x16x32_bf16 v[232:235], a[48:51], a[96:99], v[232:235]
v_xor_b32 v25, 512, v23
v_mfma_f32_16x16x32_bf16 v[232:235], a[52:55], a[100:103], v[232:235]
v_xor_b32 v26, 768, v23
v_mfma_f32_16x16x32_bf16 v[236:239], a[56:59], a[96:99], v[236:239]
v_min_u32_e64 v27, 43, v0
v_mfma_f32_16x16x32_bf16 v[236:239], a[60:63], a[100:103], v[236:239]
v_lshlrev_b32 v27, 2, v27
s_waitcnt lgkmcnt(0) vmcnt(13)
s_barrier
v_mfma_f32_16x16x32_bf16 v[240:243], a[32:35], a[104:107], v[240:243]
ds_read_b64_tr_b16 a[64:65], v18 offset:32768
v_mfma_f32_16x16x32_bf16 v[240:243], a[36:39], a[108:111], v[240:243]
ds_read_b64_tr_b16 a[66:67], v18 offset:33792
v_mfma_f32_16x16x32_bf16 v[244:247], a[40:43], a[104:107], v[244:247]
ds_read_b64_tr_b16 a[68:69], v18 offset:40960
v_mfma_f32_16x16x32_bf16 v[244:247], a[44:47], a[108:111], v[244:247]
ds_read_b64_tr_b16 a[70:71], v18 offset:41984
v_mfma_f32_16x16x32_bf16 v[248:251], a[48:51], a[104:107], v[248:251]
ds_read_b128 a[96:99], v15 offset:0
v_mfma_f32_16x16x32_bf16 v[248:251], a[52:55], a[108:111], v[248:251]
ds_read_b128 a[100:103], v15 offset:16384
v_mfma_f32_16x16x32_bf16 v[252:255], a[56:59], a[104:107], v[252:255]
s_add_u32 s45, s41, 1409024
v_mfma_f32_16x16x32_bf16 v[252:255], a[60:63], a[108:111], v[252:255]
s_add_u32 m0, s43, 16384
v_mfma_f32_16x16x32_bf16 a[0:3], a[32:35], a[112:115], a[0:3]
ds_read_b64_tr_b16 a[72:73], v19 offset:32768
v_mfma_f32_16x16x32_bf16 a[0:3], a[36:39], a[116:119], a[0:3]
ds_read_b64_tr_b16 a[74:75], v19 offset:33792
v_mfma_f32_16x16x32_bf16 a[4:7], a[40:43], a[112:115], a[4:7]
ds_read_b64_tr_b16 a[76:77], v19 offset:40960
v_mfma_f32_16x16x32_bf16 a[4:7], a[44:47], a[116:119], a[4:7]
ds_read_b64_tr_b16 a[78:79], v19 offset:41984
v_mfma_f32_16x16x32_bf16 a[8:11], a[48:51], a[112:115], a[8:11]
buffer_load_dwordx4 v10, s[12:15], s45 offen offset:0 lds
v_mfma_f32_16x16x32_bf16 a[8:11], a[52:55], a[116:119], a[8:11]
ds_read_b64_tr_b16 a[80:81], v20 offset:32768
v_mfma_f32_16x16x32_bf16 a[12:15], a[56:59], a[112:115], a[12:15]
ds_read_b64_tr_b16 a[82:83], v20 offset:33792
v_mfma_f32_16x16x32_bf16 a[12:15], a[60:63], a[116:119], a[12:15]
ds_read_b64_tr_b16 a[84:85], v20 offset:40960
v_mfma_f32_16x16x32_bf16 a[16:19], a[32:35], a[120:123], a[16:19]
ds_read_b64_tr_b16 a[86:87], v20 offset:41984
v_mfma_f32_16x16x32_bf16 a[16:19], a[36:39], a[124:127], a[16:19]
ds_read_b64_tr_b16 a[88:89], v21 offset:32768
v_mfma_f32_16x16x32_bf16 a[20:23], a[40:43], a[120:123], a[20:23]
v_mfma_f32_16x16x32_bf16 a[20:23], a[44:47], a[124:127], a[20:23]
v_mfma_f32_16x16x32_bf16 a[24:27], a[48:51], a[120:123], a[24:27]
s_waitcnt lgkmcnt(3)
ds_read_b64_tr_b16 a[90:91], v21 offset:33792
v_mfma_f32_16x16x32_bf16 a[24:27], a[52:55], a[124:127], a[24:27]
ds_read_b64_tr_b16 a[92:93], v21 offset:40960
v_mfma_f32_16x16x32_bf16 a[28:31], a[56:59], a[120:123], a[28:31]
ds_read_b64_tr_b16 a[94:95], v21 offset:41984
v_mfma_f32_16x16x32_bf16 a[28:31], a[60:63], a[124:127], a[28:31]
buffer_load_dwordx4 v11, s[12:15], s45 offen offset:1024 lds
v_mfma_f32_16x16x32_bf16 v[160:163], a[64:67], a[96:99], v[160:163]
ds_read_b128 a[104:107], v15 offset:256
v_mfma_f32_16x16x32_bf16 v[160:163], a[68:71], a[100:103], v[160:163]
ds_read_b128 a[108:111], v15 offset:16640
v_mfma_f32_16x16x32_bf16 v[164:167], a[72:75], a[96:99], v[164:167]
ds_read_b128 a[112:115], v15 offset:512
v_mfma_f32_16x16x32_bf16 v[164:167], a[76:79], a[100:103], v[164:167]
buffer_load_dwordx4 v12, s[12:15], s45 offen offset:2048 lds
v_mfma_f32_16x16x32_bf16 v[168:171], a[80:83], a[96:99], v[168:171]
s_waitcnt lgkmcnt(3)
v_mfma_f32_16x16x32_bf16 v[168:171], a[84:87], a[100:103], v[168:171]
ds_read_b128 a[116:119], v15 offset:16896
v_mfma_f32_16x16x32_bf16 v[172:175], a[88:91], a[96:99], v[172:175]
ds_read_b128 a[120:123], v15 offset:768
v_mfma_f32_16x16x32_bf16 v[172:175], a[92:95], a[100:103], v[172:175]
buffer_load_dwordx4 v13, s[12:15], s45 offen offset:3072 lds
s_waitcnt lgkmcnt(3)
v_mfma_f32_16x16x32_bf16 v[176:179], a[64:67], a[104:107], v[176:179]
s_add_u32 s44, s39, 2818048
v_mfma_f32_16x16x32_bf16 v[176:179], a[68:71], a[108:111], v[176:179]
s_add_u32 m0, s42, 32768
v_mfma_f32_16x16x32_bf16 v[180:183], a[72:75], a[104:107], v[180:183]
buffer_load_dwordx4 v2, s[20:23], s44 offen offset:0 lds
v_mfma_f32_16x16x32_bf16 v[180:183], a[76:79], a[108:111], v[180:183]
ds_read_b128 a[124:127], v15 offset:17152
v_mfma_f32_16x16x32_bf16 v[184:187], a[80:83], a[104:107], v[184:187]
ds_read_b128 a[96:99], v15 offset:1024
v_mfma_f32_16x16x32_bf16 v[184:187], a[84:87], a[108:111], v[184:187]
ds_read_b128 a[100:103], v15 offset:17408
v_mfma_f32_16x16x32_bf16 v[188:191], a[88:91], a[104:107], v[188:191]
buffer_load_dwordx4 v3, s[20:23], s44 offen offset:1024 lds
v_mfma_f32_16x16x32_bf16 v[188:191], a[92:95], a[108:111], v[188:191]
s_waitcnt lgkmcnt(3)
v_mfma_f32_16x16x32_bf16 v[192:195], a[64:67], a[112:115], v[192:195]
v_mfma_f32_16x16x32_bf16 v[192:195], a[68:71], a[116:119], v[192:195]
ds_read_b128 a[104:107], v15 offset:1280
v_mfma_f32_16x16x32_bf16 v[196:199], a[72:75], a[112:115], v[196:199]
buffer_load_dwordx4 v2, s[20:23], s44 offen offset:2048 lds
v_mfma_f32_16x16x32_bf16 v[196:199], a[76:79], a[116:119], v[196:199]
ds_read_b128 a[108:111], v15 offset:17664
v_mfma_f32_16x16x32_bf16 v[200:203], a[80:83], a[112:115], v[200:203]
v_mfma_f32_16x16x32_bf16 v[200:203], a[84:87], a[116:119], v[200:203]
v_mfma_f32_16x16x32_bf16 v[204:207], a[88:91], a[112:115], v[204:207]
buffer_load_dwordx4 v3, s[20:23], s44 offen offset:3072 lds
v_mfma_f32_16x16x32_bf16 v[204:207], a[92:95], a[116:119], v[204:207]
s_add_u32 m0, s42, 36864
v_mfma_f32_16x16x32_bf16 v[208:211], a[64:67], a[120:123], v[208:211]
buffer_load_dwordx4 v4, s[20:23], s44 offen offset:0 lds
s_waitcnt lgkmcnt(1)
v_mfma_f32_16x16x32_bf16 v[208:211], a[68:71], a[124:127], v[208:211]
ds_read_b128 a[112:115], v15 offset:1536
v_mfma_f32_16x16x32_bf16 v[212:215], a[72:75], a[120:123], v[212:215]
ds_read_b128 a[116:119], v15 offset:17920
v_mfma_f32_16x16x32_bf16 v[212:215], a[76:79], a[124:127], v[212:215]
v_mfma_f32_16x16x32_bf16 v[216:219], a[80:83], a[120:123], v[216:219]
buffer_load_dwordx4 v5, s[20:23], s44 offen offset:1024 lds
v_mfma_f32_16x16x32_bf16 v[216:219], a[84:87], a[124:127], v[216:219]
v_mfma_f32_16x16x32_bf16 v[220:223], a[88:91], a[120:123], v[220:223]
v_mfma_f32_16x16x32_bf16 v[220:223], a[92:95], a[124:127], v[220:223]
v_mfma_f32_16x16x32_bf16 v[224:227], a[64:67], a[96:99], v[224:227]
buffer_load_dwordx4 v4, s[20:23], s44 offen offset:2048 lds
ds_read_b128 a[120:123], v15 offset:1792
v_mfma_f32_16x16x32_bf16 v[224:227], a[68:71], a[100:103], v[224:227]
ds_read_b128 a[124:127], v15 offset:18176
v_mfma_f32_16x16x32_bf16 v[228:231], a[72:75], a[96:99], v[228:231]
v_mfma_f32_16x16x32_bf16 v[228:231], a[76:79], a[100:103], v[228:231]
v_mfma_f32_16x16x32_bf16 v[232:235], a[80:83], a[96:99], v[232:235]
buffer_load_dwordx4 v5, s[20:23], s44 offen offset:3072 lds
v_mfma_f32_16x16x32_bf16 v[232:235], a[84:87], a[100:103], v[232:235]
s_mov_b32 m0, s59
v_mfma_f32_16x16x32_bf16 v[236:239], a[88:91], a[96:99], v[236:239]
buffer_load_dwordx4 v22, s[20:23], s58 offen sc1 lds
v_mfma_f32_16x16x32_bf16 v[236:239], a[92:95], a[100:103], v[236:239]
s_waitcnt lgkmcnt(0) vmcnt(13)
s_barrier
v_mfma_f32_16x16x32_bf16 v[240:243], a[64:67], a[104:107], v[240:243]
ds_read_b64_tr_b16 a[32:33], v18 offset:0
v_mfma_f32_16x16x32_bf16 v[240:243], a[68:71], a[108:111], v[240:243]
ds_read_b64_tr_b16 a[34:35], v18 offset:1024
v_mfma_f32_16x16x32_bf16 v[244:247], a[72:75], a[104:107], v[244:247]
ds_read_b64_tr_b16 a[36:37], v18 offset:8192
v_mfma_f32_16x16x32_bf16 v[244:247], a[76:79], a[108:111], v[244:247]
ds_read_b64_tr_b16 a[38:39], v18 offset:9216
v_mfma_f32_16x16x32_bf16 v[248:251], a[80:83], a[104:107], v[248:251]
ds_read_b128 a[96:99], v14 offset:0
v_mfma_f32_16x16x32_bf16 v[248:251], a[84:87], a[108:111], v[248:251]
ds_read_b128 a[100:103], v14 offset:16384
v_mfma_f32_16x16x32_bf16 v[252:255], a[88:91], a[104:107], v[252:255]
s_add_u32 s45, s41, 65536
v_mfma_f32_16x16x32_bf16 v[252:255], a[92:95], a[108:111], v[252:255]
s_add_u32 m0, s43, 32768
v_mfma_f32_16x16x32_bf16 a[0:3], a[64:67], a[112:115], a[0:3]
ds_read_b64_tr_b16 a[40:41], v19 offset:0
v_mfma_f32_16x16x32_bf16 a[0:3], a[68:71], a[116:119], a[0:3]
ds_read_b64_tr_b16 a[42:43], v19 offset:1024
v_mfma_f32_16x16x32_bf16 a[4:7], a[72:75], a[112:115], a[4:7]
ds_read_b64_tr_b16 a[44:45], v19 offset:8192
v_mfma_f32_16x16x32_bf16 a[4:7], a[76:79], a[116:119], a[4:7]
ds_read_b64_tr_b16 a[46:47], v19 offset:9216
v_mfma_f32_16x16x32_bf16 a[8:11], a[80:83], a[112:115], a[8:11]
buffer_load_dwordx4 v10, s[12:15], s45 offen offset:0 lds
v_mfma_f32_16x16x32_bf16 a[8:11], a[84:87], a[116:119], a[8:11]
ds_read_b64_tr_b16 a[48:49], v20 offset:0
v_mfma_f32_16x16x32_bf16 a[12:15], a[88:91], a[112:115], a[12:15]
ds_read_b64_tr_b16 a[50:51], v20 offset:1024
v_mfma_f32_16x16x32_bf16 a[12:15], a[92:95], a[116:119], a[12:15]
ds_read_b64_tr_b16 a[52:53], v20 offset:8192
v_mfma_f32_16x16x32_bf16 a[16:19], a[64:67], a[120:123], a[16:19]
ds_read_b64_tr_b16 a[54:55], v20 offset:9216
v_mfma_f32_16x16x32_bf16 a[16:19], a[68:71], a[124:127], a[16:19]
ds_read_b64_tr_b16 a[56:57], v21 offset:0
v_mfma_f32_16x16x32_bf16 a[20:23], a[72:75], a[120:123], a[20:23]
v_mfma_f32_16x16x32_bf16 a[20:23], a[76:79], a[124:127], a[20:23]
v_mfma_f32_16x16x32_bf16 a[24:27], a[80:83], a[120:123], a[24:27]
s_waitcnt lgkmcnt(3)
ds_read_b64_tr_b16 a[58:59], v21 offset:1024
v_mfma_f32_16x16x32_bf16 a[24:27], a[84:87], a[124:127], a[24:27]
ds_read_b64_tr_b16 a[60:61], v21 offset:8192
v_mfma_f32_16x16x32_bf16 a[28:31], a[88:91], a[120:123], a[28:31]
ds_read_b64_tr_b16 a[62:63], v21 offset:9216
v_mfma_f32_16x16x32_bf16 a[28:31], a[92:95], a[124:127], a[28:31]
buffer_load_dwordx4 v11, s[12:15], s45 offen offset:1024 lds
v_mfma_f32_16x16x32_bf16 v[160:163], a[32:35], a[96:99], v[160:163]
ds_read_b128 a[104:107], v14 offset:256
v_mfma_f32_16x16x32_bf16 v[160:163], a[36:39], a[100:103], v[160:163]
ds_read_b128 a[108:111], v14 offset:16640
v_mfma_f32_16x16x32_bf16 v[164:167], a[40:43], a[96:99], v[164:167]
ds_read_b128 a[112:115], v14 offset:512
v_mfma_f32_16x16x32_bf16 v[164:167], a[44:47], a[100:103], v[164:167]
buffer_load_dwordx4 v12, s[12:15], s45 offen offset:2048 lds
v_mfma_f32_16x16x32_bf16 v[168:171], a[48:51], a[96:99], v[168:171]
s_waitcnt lgkmcnt(3)
v_mfma_f32_16x16x32_bf16 v[168:171], a[52:55], a[100:103], v[168:171]
ds_read_b128 a[116:119], v14 offset:16896
v_mfma_f32_16x16x32_bf16 v[172:175], a[56:59], a[96:99], v[172:175]
ds_read_b128 a[120:123], v14 offset:768
v_mfma_f32_16x16x32_bf16 v[172:175], a[60:63], a[100:103], v[172:175]
buffer_load_dwordx4 v13, s[12:15], s45 offen offset:3072 lds
s_waitcnt lgkmcnt(3)
v_mfma_f32_16x16x32_bf16 v[176:179], a[32:35], a[104:107], v[176:179]
s_add_u32 s44, s39, 131072
v_mfma_f32_16x16x32_bf16 v[176:179], a[36:39], a[108:111], v[176:179]
s_add_u32 m0, s42, 65536
v_mfma_f32_16x16x32_bf16 v[180:183], a[40:43], a[104:107], v[180:183]
buffer_load_dwordx4 v2, s[20:23], s44 offen offset:0 lds
v_mfma_f32_16x16x32_bf16 v[180:183], a[44:47], a[108:111], v[180:183]
ds_read_b128 a[124:127], v14 offset:17152
v_mfma_f32_16x16x32_bf16 v[184:187], a[48:51], a[104:107], v[184:187]
ds_read_b128 a[96:99], v14 offset:1024
v_mfma_f32_16x16x32_bf16 v[184:187], a[52:55], a[108:111], v[184:187]
ds_read_b128 a[100:103], v14 offset:17408
v_mfma_f32_16x16x32_bf16 v[188:191], a[56:59], a[104:107], v[188:191]
buffer_load_dwordx4 v3, s[20:23], s44 offen offset:1024 lds
v_mfma_f32_16x16x32_bf16 v[188:191], a[60:63], a[108:111], v[188:191]
s_waitcnt lgkmcnt(3)
v_mfma_f32_16x16x32_bf16 v[192:195], a[32:35], a[112:115], v[192:195]
v_mfma_f32_16x16x32_bf16 v[192:195], a[36:39], a[116:119], v[192:195]
ds_read_b128 a[104:107], v14 offset:1280
v_mfma_f32_16x16x32_bf16 v[196:199], a[40:43], a[112:115], v[196:199]
buffer_load_dwordx4 v2, s[20:23], s44 offen offset:2048 lds
v_mfma_f32_16x16x32_bf16 v[196:199], a[44:47], a[116:119], v[196:199]
ds_read_b128 a[108:111], v14 offset:17664
v_mfma_f32_16x16x32_bf16 v[200:203], a[48:51], a[112:115], v[200:203]
v_mfma_f32_16x16x32_bf16 v[200:203], a[52:55], a[116:119], v[200:203]
v_mfma_f32_16x16x32_bf16 v[204:207], a[56:59], a[112:115], v[204:207]
buffer_load_dwordx4 v3, s[20:23], s44 offen offset:3072 lds
v_mfma_f32_16x16x32_bf16 v[204:207], a[60:63], a[116:119], v[204:207]
s_add_u32 m0, s42, 69632
v_mfma_f32_16x16x32_bf16 v[208:211], a[32:35], a[120:123], v[208:211]
buffer_load_dwordx4 v4, s[20:23], s44 offen offset:0 lds
s_waitcnt lgkmcnt(1)
v_mfma_f32_16x16x32_bf16 v[208:211], a[36:39], a[124:127], v[208:211]
ds_read_b128 a[112:115], v14 offset:1536
v_mfma_f32_16x16x32_bf16 v[212:215], a[40:43], a[120:123], v[212:215]
ds_read_b128 a[116:119], v14 offset:17920
v_mfma_f32_16x16x32_bf16 v[212:215], a[44:47], a[124:127], v[212:215]
v_mfma_f32_16x16x32_bf16 v[216:219], a[48:51], a[120:123], v[216:219]
buffer_load_dwordx4 v5, s[20:23], s44 offen offset:1024 lds
v_mfma_f32_16x16x32_bf16 v[216:219], a[52:55], a[124:127], v[216:219]
v_mfma_f32_16x16x32_bf16 v[220:223], a[56:59], a[120:123], v[220:223]
v_mfma_f32_16x16x32_bf16 v[220:223], a[60:63], a[124:127], v[220:223]
v_mfma_f32_16x16x32_bf16 v[224:227], a[32:35], a[96:99], v[224:227]
buffer_load_dwordx4 v4, s[20:23], s44 offen offset:2048 lds
ds_read_b128 a[120:123], v14 offset:1792
v_mfma_f32_16x16x32_bf16 v[224:227], a[36:39], a[100:103], v[224:227]
ds_read_b128 a[124:127], v14 offset:18176
v_mfma_f32_16x16x32_bf16 v[228:231], a[40:43], a[96:99], v[228:231]
v_mfma_f32_16x16x32_bf16 v[228:231], a[44:47], a[100:103], v[228:231]
v_mfma_f32_16x16x32_bf16 v[232:235], a[48:51], a[96:99], v[232:235]
buffer_load_dwordx4 v5, s[20:23], s44 offen offset:3072 lds
v_mfma_f32_16x16x32_bf16 v[232:235], a[52:55], a[100:103], v[232:235]
s_getpc_b64 s[76:77]
KF_ct3:
s_add_u32 s76, s76, KF_k2+16384-KF_ct3
v_mfma_f32_16x16x32_bf16 v[236:239], a[56:59], a[96:99], v[236:239]
s_addc_u32 s77, s77, 0
s_lshl_b32 s78, s3, 4
v_and_b32 v1, 15, v0
v_add_lshl_u32 v1, v1, s78, 7
v_min_u32 v1, KF_last-(KF_k2+16384), v1
v_mfma_f32_16x16x32_bf16 v[236:239], a[60:63], a[100:103], v[236:239]
global_load_dword a255, v1, s[76:77]
s_waitcnt lgkmcnt(0) vmcnt(14)
s_barrier
v_mfma_f32_16x16x32_bf16 v[240:243], a[32:35], a[104:107], v[240:243]
ds_read_b64_tr_b16 a[64:65], v18 offset:16384
v_mfma_f32_16x16x32_bf16 v[240:243], a[36:39], a[108:111], v[240:243]
ds_read_b64_tr_b16 a[66:67], v18 offset:17408
v_mfma_f32_16x16x32_bf16 v[244:247], a[40:43], a[104:107], v[244:247]
ds_read_b64_tr_b16 a[68:69], v18 offset:24576
v_mfma_f32_16x16x32_bf16 v[244:247], a[44:47], a[108:111], v[244:247]
ds_read_b64_tr_b16 a[70:71], v18 offset:25600
v_mfma_f32_16x16x32_bf16 v[248:251], a[48:51], a[104:107], v[248:251]
ds_read_b128 a[96:99], v14 offset:32768
v_mfma_f32_16x16x32_bf16 v[248:251], a[52:55], a[108:111], v[248:251]
ds_read_b128 a[100:103], v14 offset:49152
v_mfma_f32_16x16x32_bf16 v[252:255], a[56:59], a[104:107], v[252:255]
s_add_u32 s45, s41, 524288
v_mfma_f32_16x16x32_bf16 v[252:255], a[60:63], a[108:111], v[252:255]
s_add_u32 m0, s43, 0
v_mfma_f32_16x16x32_bf16 a[0:3], a[32:35], a[112:115], a[0:3]
ds_read_b64_tr_b16 a[72:73], v19 offset:16384
v_mfma_f32_16x16x32_bf16 a[0:3], a[36:39], a[116:119], a[0:3]
ds_read_b64_tr_b16 a[74:75], v19 offset:17408
v_mfma_f32_16x16x32_bf16 a[4:7], a[40:43], a[112:115], a[4:7]
ds_read_b64_tr_b16 a[76:77], v19 offset:24576
v_mfma_f32_16x16x32_bf16 a[4:7], a[44:47], a[116:119], a[4:7]
ds_read_b64_tr_b16 a[78:79], v19 offset:25600
v_mfma_f32_16x16x32_bf16 a[8:11], a[48:51], a[112:115], a[8:11]
buffer_load_dwordx4 v10, s[12:15], s45 offen offset:0 lds
v_mfma_f32_16x16x32_bf16 a[8:11], a[52:55], a[116:119], a[8:11]
ds_read_b64_tr_b16 a[80:81], v20 offset:16384
v_mfma_f32_16x16x32_bf16 a[12:15], a[56:59], a[112:115], a[12:15]
ds_read_b64_tr_b16 a[82:83], v20 offset:17408
v_mfma_f32_16x16x32_bf16 a[12:15], a[60:63], a[116:119], a[12:15]
ds_read_b64_tr_b16 a[84:85], v20 offset:24576
v_mfma_f32_16x16x32_bf16 a[16:19], a[32:35], a[120:123], a[16:19]
ds_read_b64_tr_b16 a[86:87], v20 offset:25600
v_mfma_f32_16x16x32_bf16 a[16:19], a[36:39], a[124:127], a[16:19]
ds_read_b64_tr_b16 a[88:89], v21 offset:16384
v_mfma_f32_16x16x32_bf16 a[20:23], a[40:43], a[120:123], a[20:23]
v_mfma_f32_16x16x32_bf16 a[20:23], a[44:47], a[124:127], a[20:23]
v_mfma_f32_16x16x32_bf16 a[24:27], a[48:51], a[120:123], a[24:27]
s_waitcnt lgkmcnt(3)
ds_read_b64_tr_b16 a[90:91], v21 offset:17408
v_mfma_f32_16x16x32_bf16 a[24:27], a[52:55], a[124:127], a[24:27]
ds_read_b64_tr_b16 a[92:93], v21 offset:24576
v_mfma_f32_16x16x32_bf16 a[28:31], a[56:59], a[120:123], a[28:31]
ds_read_b64_tr_b16 a[94:95], v21 offset:25600
v_mfma_f32_16x16x32_bf16 a[28:31], a[60:63], a[124:127], a[28:31]
buffer_load_dwordx4 v11, s[12:15], s45 offen offset:1024 lds
v_mfma_f32_16x16x32_bf16 v[160:163], a[64:67], a[96:99], v[160:163]
ds_read_b128 a[104:107], v14 offset:33024
v_mfma_f32_16x16x32_bf16 v[160:163], a[68:71], a[100:103], v[160:163]
ds_read_b128 a[108:111], v14 offset:49408
v_mfma_f32_16x16x32_bf16 v[164:167], a[72:75], a[96:99], v[164:167]
ds_read_b128 a[112:115], v14 offset:33280
v_mfma_f32_16x16x32_bf16 v[164:167], a[76:79], a[100:103], v[164:167]
buffer_load_dwordx4 v12, s[12:15], s45 offen offset:2048 lds
v_mfma_f32_16x16x32_bf16 v[168:171], a[80:83], a[96:99], v[168:171]
s_waitcnt lgkmcnt(3)
v_mfma_f32_16x16x32_bf16 v[168:171], a[84:87], a[100:103], v[168:171]
ds_read_b128 a[116:119], v14 offset:49664
v_mfma_f32_16x16x32_bf16 v[172:175], a[88:91], a[96:99], v[172:175]
ds_read_b128 a[120:123], v14 offset:33536
v_mfma_f32_16x16x32_bf16 v[172:175], a[92:95], a[100:103], v[172:175]
buffer_load_dwordx4 v13, s[12:15], s45 offen offset:3072 lds
s_waitcnt lgkmcnt(3)
v_mfma_f32_16x16x32_bf16 v[176:179], a[64:67], a[104:107], v[176:179]
s_add_u32 s44, s39, 1048576
v_mfma_f32_16x16x32_bf16 v[176:179], a[68:71], a[108:111], v[176:179]
s_add_u32 m0, s42, 0
v_mfma_f32_16x16x32_bf16 v[180:183], a[72:75], a[104:107], v[180:183]
buffer_load_dwordx4 v2, s[20:23], s44 offen offset:0 lds
v_mfma_f32_16x16x32_bf16 v[180:183], a[76:79], a[108:111], v[180:183]
ds_read_b128 a[124:127], v14 offset:49920
v_mfma_f32_16x16x32_bf16 v[184:187], a[80:83], a[104:107], v[184:187]
ds_read_b128 a[96:99], v14 offset:33792
v_mfma_f32_16x16x32_bf16 v[184:187], a[84:87], a[108:111], v[184:187]
ds_read_b128 a[100:103], v14 offset:50176
v_mfma_f32_16x16x32_bf16 v[188:191], a[88:91], a[104:107], v[188:191]
buffer_load_dwordx4 v3, s[20:23], s44 offen offset:1024 lds
v_mfma_f32_16x16x32_bf16 v[188:191], a[92:95], a[108:111], v[188:191]
s_waitcnt lgkmcnt(3)
v_mfma_f32_16x16x32_bf16 v[192:195], a[64:67], a[112:115], v[192:195]
v_mfma_f32_16x16x32_bf16 v[192:195], a[68:71], a[116:119], v[192:195]
ds_read_b128 a[104:107], v14 offset:34048
v_mfma_f32_16x16x32_bf16 v[196:199], a[72:75], a[112:115], v[196:199]
buffer_load_dwordx4 v2, s[20:23], s44 offen offset:2048 lds
v_mfma_f32_16x16x32_bf16 v[196:199], a[76:79], a[116:119], v[196:199]
ds_read_b128 a[108:111], v14 offset:50432
v_mfma_f32_16x16x32_bf16 v[200:203], a[80:83], a[112:115], v[200:203]
v_mfma_f32_16x16x32_bf16 v[200:203], a[84:87], a[116:119], v[200:203]
v_mfma_f32_16x16x32_bf16 v[204:207], a[88:91], a[112:115], v[204:207]
buffer_load_dwordx4 v3, s[20:23], s44 offen offset:3072 lds
v_mfma_f32_16x16x32_bf16 v[204:207], a[92:95], a[116:119], v[204:207]
s_add_u32 m0, s42, 4096
v_mfma_f32_16x16x32_bf16 v[208:211], a[64:67], a[120:123], v[208:211]
buffer_load_dwordx4 v4, s[20:23], s44 offen offset:0 lds
s_waitcnt lgkmcnt(1)
v_mfma_f32_16x16x32_bf16 v[208:211], a[68:71], a[124:127], v[208:211]
ds_read_b128 a[112:115], v14 offset:34304
v_mfma_f32_16x16x32_bf16 v[212:215], a[72:75], a[120:123], v[212:215]
ds_read_b128 a[116:119], v14 offset:50688
v_mfma_f32_16x16x32_bf16 v[212:215], a[76:79], a[124:127], v[212:215]
v_mfma_f32_16x16x32_bf16 v[216:219], a[80:83], a[120:123], v[216:219]
buffer_load_dwordx4 v5, s[20:23], s44 offen offset:1024 lds
v_mfma_f32_16x16x32_bf16 v[216:219], a[84:87], a[124:127], v[216:219]
v_mfma_f32_16x16x32_bf16 v[220:223], a[88:91], a[120:123], v[220:223]
v_mfma_f32_16x16x32_bf16 v[220:223], a[92:95], a[124:127], v[220:223]
v_mfma_f32_16x16x32_bf16 v[224:227], a[64:67], a[96:99], v[224:227]
buffer_load_dwordx4 v4, s[20:23], s44 offen offset:2048 lds
ds_read_b128 a[120:123], v14 offset:34560
v_mfma_f32_16x16x32_bf16 v[224:227], a[68:71], a[100:103], v[224:227]
ds_read_b128 a[124:127], v14 offset:50944
v_mfma_f32_16x16x32_bf16 v[228:231], a[72:75], a[96:99], v[228:231]
v_mfma_f32_16x16x32_bf16 v[228:231], a[76:79], a[100:103], v[228:231]
v_mfma_f32_16x16x32_bf16 v[232:235], a[80:83], a[96:99], v[232:235]
buffer_load_dwordx4 v5, s[20:23], s44 offen offset:3072 lds
v_mfma_f32_16x16x32_bf16 v[232:235], a[84:87], a[100:103], v[232:235]
v_mfma_f32_16x16x32_bf16 v[236:239], a[88:91], a[96:99], v[236:239]
buffer_load_dword v28, v27, s[20:23], s54 offen offset:256 sc1
v_mfma_f32_16x16x32_bf16 v[236:239], a[92:95], a[100:103], v[236:239]
s_waitcnt lgkmcnt(0) vmcnt(14)
s_barrier
v_mfma_f32_16x16x32_bf16 v[240:243], a[64:67], a[104:107], v[240:243]
ds_read_b64_tr_b16 a[32:33], v18 offset:32768
v_mfma_f32_16x16x32_bf16 v[240:243], a[68:71], a[108:111], v[240:243]
ds_read_b64_tr_b16 a[34:35], v18 offset:33792
v_mfma_f32_16x16x32_bf16 v[244:247], a[72:75], a[104:107], v[244:247]
ds_read_b64_tr_b16 a[36:37], v18 offset:40960
v_mfma_f32_16x16x32_bf16 v[244:247], a[76:79], a[108:111], v[244:247]
ds_read_b64_tr_b16 a[38:39], v18 offset:41984
v_mfma_f32_16x16x32_bf16 v[248:251], a[80:83], a[104:107], v[248:251]
ds_read_b128 a[96:99], v15 offset:0
v_mfma_f32_16x16x32_bf16 v[248:251], a[84:87], a[108:111], v[248:251]
ds_read_b128 a[100:103], v15 offset:16384
v_mfma_f32_16x16x32_bf16 v[252:255], a[88:91], a[104:107], v[252:255]
s_add_u32 s45, s41, 983040
v_mfma_f32_16x16x32_bf16 v[252:255], a[92:95], a[108:111], v[252:255]
s_add_u32 m0, s43, 16384
v_mfma_f32_16x16x32_bf16 a[0:3], a[64:67], a[112:115], a[0:3]
ds_read_b64_tr_b16 a[40:41], v19 offset:32768
v_mfma_f32_16x16x32_bf16 a[0:3], a[68:71], a[116:119], a[0:3]
ds_read_b64_tr_b16 a[42:43], v19 offset:33792
v_mfma_f32_16x16x32_bf16 a[4:7], a[72:75], a[112:115], a[4:7]
ds_read_b64_tr_b16 a[44:45], v19 offset:40960
v_mfma_f32_16x16x32_bf16 a[4:7], a[76:79], a[116:119], a[4:7]
ds_read_b64_tr_b16 a[46:47], v19 offset:41984
v_mfma_f32_16x16x32_bf16 a[8:11], a[80:83], a[112:115], a[8:11]
buffer_load_dwordx4 v10, s[12:15], s45 offen offset:0 lds
v_mfma_f32_16x16x32_bf16 a[8:11], a[84:87], a[116:119], a[8:11]
ds_read_b64_tr_b16 a[48:49], v20 offset:32768
v_mfma_f32_16x16x32_bf16 a[12:15], a[88:91], a[112:115], a[12:15]
ds_read_b64_tr_b16 a[50:51], v20 offset:33792
v_mfma_f32_16x16x32_bf16 a[12:15], a[92:95], a[116:119], a[12:15]
ds_read_b64_tr_b16 a[52:53], v20 offset:40960
v_mfma_f32_16x16x32_bf16 a[16:19], a[64:67], a[120:123], a[16:19]
ds_read_b64_tr_b16 a[54:55], v20 offset:41984
v_mfma_f32_16x16x32_bf16 a[16:19], a[68:71], a[124:127], a[16:19]
ds_read_b64_tr_b16 a[56:57], v21 offset:32768
v_mfma_f32_16x16x32_bf16 a[20:23], a[72:75], a[120:123], a[20:23]
v_mfma_f32_16x16x32_bf16 a[20:23], a[76:79], a[124:127], a[20:23]
v_mfma_f32_16x16x32_bf16 a[24:27], a[80:83], a[120:123], a[24:27]
s_waitcnt lgkmcnt(3)
ds_read_b64_tr_b16 a[58:59], v21 offset:33792
v_mfma_f32_16x16x32_bf16 a[24:27], a[84:87], a[124:127], a[24:27]
ds_read_b64_tr_b16 a[60:61], v21 offset:40960
v_mfma_f32_16x16x32_bf16 a[28:31], a[88:91], a[120:123], a[28:31]
ds_read_b64_tr_b16 a[62:63], v21 offset:41984
v_mfma_f32_16x16x32_bf16 a[28:31], a[92:95], a[124:127], a[28:31]
buffer_load_dwordx4 v11, s[12:15], s45 offen offset:1024 lds
v_mfma_f32_16x16x32_bf16 v[160:163], a[32:35], a[96:99], v[160:163]
ds_read_b128 a[104:107], v15 offset:256
v_mfma_f32_16x16x32_bf16 v[160:163], a[36:39], a[100:103], v[160:163]
ds_read_b128 a[108:111], v15 offset:16640
v_mfma_f32_16x16x32_bf16 v[164:167], a[40:43], a[96:99], v[164:167]
ds_read_b128 a[112:115], v15 offset:512
v_mfma_f32_16x16x32_bf16 v[164:167], a[44:47], a[100:103], v[164:167]
buffer_load_dwordx4 v12, s[12:15], s45 offen offset:2048 lds
v_mfma_f32_16x16x32_bf16 v[168:171], a[48:51], a[96:99], v[168:171]
ds_read_b128 a[116:119], v15 offset:16896
s_waitcnt lgkmcnt(4)
v_mfma_f32_16x16x32_bf16 v[168:171], a[52:55], a[100:103], v[168:171]
ds_read_b128 a[120:123], v15 offset:768
v_mfma_f32_16x16x32_bf16 v[172:175], a[56:59], a[96:99], v[172:175]
ds_read_b128 a[124:127], v15 offset:17152
v_mfma_f32_16x16x32_bf16 v[172:175], a[60:63], a[100:103], v[172:175]
buffer_load_dwordx4 v13, s[12:15], s45 offen offset:3072 lds
s_waitcnt lgkmcnt(4)
v_mfma_f32_16x16x32_bf16 v[176:179], a[32:35], a[104:107], v[176:179]
s_add_u32 s44, s39, 1966080
v_mfma_f32_16x16x32_bf16 v[176:179], a[36:39], a[108:111], v[176:179]
s_add_u32 m0, s42, 32768
v_mfma_f32_16x16x32_bf16 v[180:183], a[40:43], a[104:107], v[180:183]
buffer_load_dwordx4 v2, s[20:23], s44 offen offset:0 lds
v_mfma_f32_16x16x32_bf16 v[180:183], a[44:47], a[108:111], v[180:183]
ds_read_b128 a[96:99], v15 offset:1024
v_mfma_f32_16x16x32_bf16 v[184:187], a[48:51], a[104:107], v[184:187]
ds_read_b128 a[100:103], v15 offset:17408
v_mfma_f32_16x16x32_bf16 v[184:187], a[52:55], a[108:111], v[184:187]
ds_read_b64 a[128:129], v23 offset:0
v_mfma_f32_16x16x32_bf16 v[188:191], a[56:59], a[104:107], v[188:191]
buffer_load_dwordx4 v3, s[20:23], s44 offen offset:1024 lds
v_mfma_f32_16x16x32_bf16 v[188:191], a[60:63], a[108:111], v[188:191]
ds_read_b64 a[130:131], v23 offset:128
s_waitcnt lgkmcnt(4)
v_mfma_f32_16x16x32_bf16 v[192:195], a[32:35], a[112:115], v[192:195]
ds_read_b64 a[132:133], v24 offset:0
v_mfma_f32_16x16x32_bf16 v[192:195], a[36:39], a[116:119], v[192:195]
ds_read_b64 a[134:135], v24 offset:128
v_mfma_f32_16x16x32_bf16 v[196:199], a[40:43], a[112:115], v[196:199]
buffer_load_dwordx4 v2, s[20:23], s44 offen offset:2048 lds
v_mfma_f32_16x16x32_bf16 v[196:199], a[44:47], a[116:119], v[196:199]
ds_read_b64 a[136:137], v25 offset:0
v_mfma_f32_16x16x32_bf16 v[200:203], a[48:51], a[112:115], v[200:203]
ds_read_b64 a[138:139], v25 offset:128
v_mfma_f32_16x16x32_bf16 v[200:203], a[52:55], a[116:119], v[200:203]
ds_read_b64 a[140:141], v26 offset:0
v_mfma_f32_16x16x32_bf16 v[204:207], a[56:59], a[112:115], v[204:207]
buffer_load_dwordx4 v3, s[20:23], s44 offen offset:3072 lds
v_mfma_f32_16x16x32_bf16 v[204:207], a[60:63], a[116:119], v[204:207]
s_add_u32 m0, s42, 36864
v_mfma_f32_16x16x32_bf16 v[208:211], a[32:35], a[120:123], v[208:211]
buffer_load_dwordx4 v4, s[20:23], s44 offen offset:0 lds
v_mfma_f32_16x16x32_bf16 v[208:211], a[36:39], a[124:127], v[208:211]
ds_read_b64 a[142:143], v26 offset:128
v_mfma_f32_16x16x32_bf16 v[212:215], a[40:43], a[120:123], v[212:215]
ds_read_b128 a[104:107], v15 offset:1280
v_mfma_f32_16x16x32_bf16 v[212:215], a[44:47], a[124:127], v[212:215]
ds_read_b128 a[108:111], v15 offset:17664
v_mfma_f32_16x16x32_bf16 v[216:219], a[48:51], a[120:123], v[216:219]
buffer_load_dwordx4 v5, s[20:23], s44 offen offset:1024 lds
v_mfma_f32_16x16x32_bf16 v[216:219], a[52:55], a[124:127], v[216:219]
ds_read_b128 a[112:115], v15 offset:1536
v_mfma_f32_16x16x32_bf16 v[220:223], a[56:59], a[120:123], v[220:223]
ds_read_b128 a[116:119], v15 offset:17920
v_mfma_f32_16x16x32_bf16 v[220:223], a[60:63], a[124:127], v[220:223]
s_waitcnt lgkmcnt(4)
v_mfma_f32_16x16x32_bf16 v[224:227], a[32:35], a[96:99], v[224:227]
buffer_load_dwordx4 v4, s[20:23], s44 offen offset:2048 lds
ds_read_b128 a[120:123], v15 offset:1792
v_mfma_f32_16x16x32_bf16 v[224:227], a[36:39], a[100:103], v[224:227]
ds_read_b128 a[124:127], v15 offset:18176
v_mfma_f32_16x16x32_bf16 v[228:231], a[40:43], a[96:99], v[228:231]
v_mfma_f32_16x16x32_bf16 v[228:231], a[44:47], a[100:103], v[228:231]
v_mfma_f32_16x16x32_bf16 v[232:235], a[48:51], a[96:99], v[232:235]
buffer_load_dwordx4 v5, s[20:23], s44 offen offset:3072 lds
v_mfma_f32_16x16x32_bf16 v[232:235], a[52:55], a[100:103], v[232:235]
v_mfma_f32_16x16x32_bf16 v[236:239], a[56:59], a[96:99], v[236:239]
v_mfma_f32_16x16x32_bf16 v[236:239], a[60:63], a[100:103], v[236:239]
s_waitcnt lgkmcnt(0) vmcnt(13)
s_barrier
v_mfma_f32_16x16x32_bf16 v[240:243], a[32:35], a[104:107], v[240:243]
ds_read_b64_tr_b16 a[64:65], v18 offset:0
ds_read_b64_tr_b16 a[66:67], v18 offset:1024
v_mfma_f32_16x16x32_bf16 v[240:243], a[36:39], a[108:111], v[240:243]
ds_read_b64_tr_b16 a[68:69], v18 offset:8192
ds_read_b64_tr_b16 a[70:71], v18 offset:9216
v_mfma_f32_16x16x32_bf16 v[244:247], a[40:43], a[104:107], v[244:247]
ds_read_b128 a[96:99], v14 offset:0
ds_read_b128 a[100:103], v14 offset:16384
v_mfma_f32_16x16x32_bf16 v[244:247], a[44:47], a[108:111], v[244:247]
s_add_u32 s45, s41, 1441792
ds_read_b64_tr_b16 a[72:73], v19 offset:0
v_mfma_f32_16x16x32_bf16 v[248:251], a[48:51], a[104:107], v[248:251]
s_add_u32 m0, s43, 32768
ds_read_b64_tr_b16 a[74:75], v19 offset:1024
v_mfma_f32_16x16x32_bf16 v[248:251], a[52:55], a[108:111], v[248:251]
ds_read_b64_tr_b16 a[76:77], v19 offset:8192
ds_read_b64_tr_b16 a[78:79], v19 offset:9216
v_mfma_f32_16x16x32_bf16 v[252:255], a[56:59], a[104:107], v[252:255]
buffer_load_dwordx4 v10, s[12:15], s45 offen offset:0 lds
ds_read_b64_tr_b16 a[80:81], v20 offset:0
v_mfma_f32_16x16x32_bf16 v[252:255], a[60:63], a[108:111], v[252:255]
ds_read_b64_tr_b16 a[82:83], v20 offset:1024
ds_read_b64_tr_b16 a[84:85], v20 offset:8192
v_mfma_f32_16x16x32_bf16 a[0:3], a[32:35], a[112:115], a[0:3]
ds_read_b64_tr_b16 a[86:87], v20 offset:9216
ds_read_b64_tr_b16 a[88:89], v21 offset:0
v_mfma_f32_16x16x32_bf16 a[0:3], a[36:39], a[116:119], a[0:3]
s_waitcnt lgkmcnt(8)
ds_read_b64_tr_b16 a[90:91], v21 offset:1024
v_mfma_f32_16x16x32_bf16 a[4:7], a[40:43], a[112:115], a[4:7]
ds_read_b64_tr_b16 a[92:93], v21 offset:8192
ds_read_b64_tr_b16 a[94:95], v21 offset:9216
v_mfma_f32_16x16x32_bf16 a[4:7], a[44:47], a[116:119], a[4:7]
buffer_load_dwordx4 v11, s[12:15], s45 offen offset:1024 lds
ds_read_b128 a[104:107], v14 offset:256
v_mfma_f32_16x16x32_bf16 a[8:11], a[48:51], a[112:115], a[8:11]
ds_read_b128 a[108:111], v14 offset:16640
v_mov_b32 v1, 0
v_mfma_f32_16x16x32_bf16 a[8:11], a[52:55], a[116:119], a[8:11]
v_accvgpr_read_b32 v30, a129
v_xor_b32_e64 v30, s75, v30
v_mfma_f32_16x16x32_bf16 a[12:15], a[56:59], a[112:115], a[12:15]
v_or_b32_e64 v1, v1, v30
v_accvgpr_read_b32 v30, a131
v_mfma_f32_16x16x32_bf16 a[12:15], a[60:63], a[116:119], a[12:15]
buffer_load_dwordx4 v12, s[12:15], s45 offen offset:2048 lds
v_xor_b32_e64 v30, s75, v30
v_mfma_f32_16x16x32_bf16 a[16:19], a[32:35], a[120:123], a[16:19]
ds_read_b128 a[112:115], v14 offset:512
v_mfma_f32_16x16x32_bf16 a[16:19], a[36:39], a[124:127], a[16:19]
ds_read_b128 a[116:119], v14 offset:16896
v_mfma_f32_16x16x32_bf16 a[20:23], a[40:43], a[120:123], a[20:23]
v_or_b32_e64 v1, v1, v30
v_mfma_f32_16x16x32_bf16 a[20:23], a[44:47], a[124:127], a[20:23]
buffer_load_dwordx4 v13, s[12:15], s45 offen offset:3072 lds
v_mfma_f32_16x16x32_bf16 a[24:27], a[48:51], a[120:123], a[24:27]
s_add_u32 s44, s39, 2883584
v_mfma_f32_16x16x32_bf16 a[24:27], a[52:55], a[124:127], a[24:27]
s_add_u32 m0, s42, 65536
v_mfma_f32_16x16x32_bf16 a[28:31], a[56:59], a[120:123], a[28:31]
buffer_load_dwordx4 v2, s[20:23], s44 offen offset:0 lds
v_mfma_f32_16x16x32_bf16 a[28:31], a[60:63], a[124:127], a[28:31]
v_accvgpr_read_b32 v30, a133
v_mfma_f32_16x16x32_bf16 v[160:163], a[64:67], a[96:99], v[160:163]
s_waitcnt lgkmcnt(0)
ds_read_b128 a[120:123], v14 offset:768
v_mfma_f32_16x16x32_bf16 v[160:163], a[68:71], a[100:103], v[160:163]
ds_read_b128 a[124:127], v14 offset:17152
v_mfma_f32_16x16x32_bf16 v[164:167], a[72:75], a[96:99], v[164:167]
buffer_load_dwordx4 v3, s[20:23], s44 offen offset:1024 lds
v_mfma_f32_16x16x32_bf16 v[164:167], a[76:79], a[100:103], v[164:167]
v_xor_b32 v30, s75, v30
v_mfma_f32_16x16x32_bf16 v[168:171], a[80:83], a[96:99], v[168:171]
v_or_b32_e64 v1, v1, v30
v_mfma_f32_16x16x32_bf16 v[168:171], a[84:87], a[100:103], v[168:171]
v_accvgpr_read_b32 v30, a135
v_mfma_f32_16x16x32_bf16 v[172:175], a[88:91], a[96:99], v[172:175]
buffer_load_dwordx4 v2, s[20:23], s44 offen offset:2048 lds
v_mfma_f32_16x16x32_bf16 v[172:175], a[92:95], a[100:103], v[172:175]
v_xor_b32_e64 v30, s75, v30
v_mfma_f32_16x16x32_bf16 v[176:179], a[64:67], a[104:107], v[176:179]
ds_read_b128 a[96:99], v14 offset:1024
v_mfma_f32_16x16x32_bf16 v[176:179], a[68:71], a[108:111], v[176:179]
ds_read_b128 a[100:103], v14 offset:17408
v_mfma_f32_16x16x32_bf16 v[180:183], a[72:75], a[104:107], v[180:183]
buffer_load_dwordx4 v3, s[20:23], s44 offen offset:3072 lds
v_mfma_f32_16x16x32_bf16 v[180:183], a[76:79], a[108:111], v[180:183]
s_add_u32 m0, s42, 69632
v_mfma_f32_16x16x32_bf16 v[184:187], a[80:83], a[104:107], v[184:187]
buffer_load_dwordx4 v4, s[20:23], s44 offen offset:0 lds
v_mfma_f32_16x16x32_bf16 v[184:187], a[84:87], a[108:111], v[184:187]
v_or_b32_e64 v1, v1, v30
v_mfma_f32_16x16x32_bf16 v[188:191], a[88:91], a[104:107], v[188:191]
v_accvgpr_read_b32 v30, a137
v_mfma_f32_16x16x32_bf16 v[188:191], a[92:95], a[108:111], v[188:191]
v_xor_b32_e64 v30, s75, v30
v_mfma_f32_16x16x32_bf16 v[192:195], a[64:67], a[112:115], v[192:195]
buffer_load_dwordx4 v5, s[20:23], s44 offen offset:1024 lds
v_mfma_f32_16x16x32_bf16 v[192:195], a[68:71], a[116:119], v[192:195]
ds_read_b128 a[104:107], v14 offset:1280
v_mfma_f32_16x16x32_bf16 v[196:199], a[72:75], a[112:115], v[196:199]
ds_read_b128 a[108:111], v14 offset:17664
v_mfma_f32_16x16x32_bf16 v[196:199], a[76:79], a[116:119], v[196:199]
v_or_b32_e64 v1, v1, v30
v_mfma_f32_16x16x32_bf16 v[200:203], a[80:83], a[112:115], v[200:203]
buffer_load_dwordx4 v4, s[20:23], s44 offen offset:2048 lds
v_mfma_f32_16x16x32_bf16 v[200:203], a[84:87], a[116:119], v[200:203]
v_accvgpr_read_b32 v30, a139
v_mfma_f32_16x16x32_bf16 v[204:207], a[88:91], a[112:115], v[204:207]
v_xor_b32_e64 v30, s75, v30
v_mfma_f32_16x16x32_bf16 v[204:207], a[92:95], a[116:119], v[204:207]
v_or_b32 v1, v1, v30
s_waitcnt lgkmcnt(1)
v_mfma_f32_16x16x32_bf16 v[208:211], a[64:67], a[120:123], v[208:211]
ds_read_b128 a[112:115], v14 offset:1536
v_mfma_f32_16x16x32_bf16 v[208:211], a[68:71], a[124:127], v[208:211]
ds_read_b128 a[116:119], v14 offset:17920
v_mfma_f32_16x16x32_bf16 v[212:215], a[72:75], a[120:123], v[212:215]
v_accvgpr_read_b32 v30, a141
v_mfma_f32_16x16x32_bf16 v[212:215], a[76:79], a[124:127], v[212:215]
v_xor_b32_e64 v30, s75, v30
v_mfma_f32_16x16x32_bf16 v[216:219], a[80:83], a[120:123], v[216:219]
v_or_b32_e64 v1, v1, v30
v_mfma_f32_16x16x32_bf16 v[216:219], a[84:87], a[124:127], v[216:219]
v_accvgpr_read_b32 v30, a143
v_mfma_f32_16x16x32_bf16 v[220:223], a[88:91], a[120:123], v[220:223]
v_xor_b32_e64 v30, s75, v30
v_mfma_f32_16x16x32_bf16 v[220:223], a[92:95], a[124:127], v[220:223]
v_or_b32_e64 v1, v1, v30
v_mfma_f32_16x16x32_bf16 v[224:227], a[64:67], a[96:99], v[224:227]
ds_read_b128 a[120:123], v14 offset:1792
v_mfma_f32_16x16x32_bf16 v[224:227], a[68:71], a[100:103], v[224:227]
ds_read_b128 a[124:127], v14 offset:18176
v_mfma_f32_16x16x32_bf16 v[228:231], a[72:75], a[96:99], v[228:231]
v_cmp_ne_u32_e64 vcc, 0, v1
v_mfma_f32_16x16x32_bf16 v[228:231], a[76:79], a[100:103], v[228:231]
buffer_load_dwordx4 v5, s[20:23], s44 offen offset:3072 lds
v_mfma_f32_16x16x32_bf16 v[232:235], a[80:83], a[96:99], v[232:235]
v_mfma_f32_16x16x32_bf16 v[232:235], a[84:87], a[100:103], v[232:235]
s_cbranch_vccnz KF_g_slow
KF_g_ok:
v_mfma_f32_16x16x32_bf16 v[236:239], a[88:91], a[96:99], v[236:239]
v_mfma_f32_16x16x32_bf16 v[236:239], a[92:95], a[100:103], v[236:239]
s_waitcnt lgkmcnt(0) vmcnt(12)
s_barrier
v_mfma_f32_16x16x32_bf16 v[240:243], a[64:67], a[104:107], v[240:243]
s_mul_i32 s66, s3, 229376
s_add_u32 s66, s66, 196608
v_mfma_f32_16x16x32_bf16 v[240:243], a[68:71], a[108:111], v[240:243]
s_mul_i32 s67, s3, 114688
s_add_u32 s67, s67, 98304
v_mfma_f32_16x16x32_bf16 v[244:247], a[72:75], a[104:107], v[244:247]
s_add_u32 s69, s67, 98304
v_add_u32 v10, s67, v10
v_mfma_f32_16x16x32_bf16 v[244:247], a[76:79], a[108:111], v[244:247]
v_add_u32 v11, s67, v11
v_add_u32 v12, s69, v12
v_mfma_f32_16x16x32_bf16 v[248:251], a[80:83], a[104:107], v[248:251]
v_add_u32 v13, s69, v13
v_add_u32 v2, s66, v2
v_mfma_f32_16x16x32_bf16 v[248:251], a[84:87], a[108:111], v[248:251]
v_add_u32_e64 v3, s66, v3
v_add_u32 v4, 229376, v2
v_mfma_f32_16x16x32_bf16 v[252:255], a[88:91], a[104:107], v[252:255]
v_add_u32 v5, 229376, v3
ds_read_b64_tr_b16 a[32:33], v18 offset:16384
v_mfma_f32_16x16x32_bf16 v[252:255], a[92:95], a[108:111], v[252:255]
ds_read_b64_tr_b16 a[34:35], v18 offset:17408
ds_read_b64_tr_b16 a[36:37], v18 offset:24576
v_mfma_f32_16x16x32_bf16 a[0:3], a[64:67], a[112:115], a[0:3]
ds_read_b64_tr_b16 a[38:39], v18 offset:25600
ds_read_b128 a[96:99], v14 offset:32768
v_mfma_f32_16x16x32_bf16 a[0:3], a[68:71], a[116:119], a[0:3]
ds_read_b128 a[100:103], v14 offset:49152
s_add_u32 s45, s41, 0
v_mfma_f32_16x16x32_bf16 a[4:7], a[72:75], a[112:115], a[4:7]
s_add_u32 m0, s43, 0
ds_read_b64_tr_b16 a[40:41], v19 offset:16384
v_mfma_f32_16x16x32_bf16 a[4:7], a[76:79], a[116:119], a[4:7]
ds_read_b64_tr_b16 a[42:43], v19 offset:17408
v_mfma_f32_16x16x32_bf16 a[8:11], a[80:83], a[112:115], a[8:11]
ds_read_b64_tr_b16 a[44:45], v19 offset:24576
v_mfma_f32_16x16x32_bf16 a[8:11], a[84:87], a[116:119], a[8:11]
ds_read_b64_tr_b16 a[46:47], v19 offset:25600
v_mfma_f32_16x16x32_bf16 a[12:15], a[88:91], a[112:115], a[12:15]
buffer_load_dwordx4 v10, s[12:15], s45 offen offset:0 lds
v_mfma_f32_16x16x32_bf16 a[12:15], a[92:95], a[116:119], a[12:15]
ds_read_b64_tr_b16 a[48:49], v20 offset:16384
v_mfma_f32_16x16x32_bf16 a[16:19], a[64:67], a[120:123], a[16:19]
ds_read_b64_tr_b16 a[50:51], v20 offset:17408
v_mfma_f32_16x16x32_bf16 a[16:19], a[68:71], a[124:127], a[16:19]
ds_read_b64_tr_b16 a[52:53], v20 offset:24576
v_mfma_f32_16x16x32_bf16 a[20:23], a[72:75], a[120:123], a[20:23]
ds_read_b64_tr_b16 a[54:55], v20 offset:25600
v_mfma_f32_16x16x32_bf16 a[20:23], a[76:79], a[124:127], a[20:23]
ds_read_b64_tr_b16 a[56:57], v21 offset:16384
v_mfma_f32_16x16x32_bf16 a[24:27], a[80:83], a[120:123], a[24:27]
s_waitcnt lgkmcnt(5)
ds_read_b64_tr_b16 a[58:59], v21 offset:17408
v_mfma_f32_16x16x32_bf16 a[24:27], a[84:87], a[124:127], a[24:27]
ds_read_b64_tr_b16 a[60:61], v21 offset:24576
v_mfma_f32_16x16x32_bf16 a[28:31], a[88:91], a[120:123], a[28:31]
ds_read_b64_tr_b16 a[62:63], v21 offset:25600
v_mfma_f32_16x16x32_bf16 a[28:31], a[92:95], a[124:127], a[28:31]
buffer_load_dwordx4 v11, s[12:15], s45 offen offset:1024 lds
v_mfma_f32_16x16x32_bf16 v[160:163], a[32:35], a[96:99], v[160:163]
ds_read_b128 a[104:107], v14 offset:33024
v_mfma_f32_16x16x32_bf16 v[160:163], a[36:39], a[100:103], v[160:163]
ds_read_b128 a[108:111], v14 offset:49408
v_mfma_f32_16x16x32_bf16 v[164:167], a[40:43], a[96:99], v[164:167]
ds_read_b128 a[112:115], v14 offset:33280
v_mfma_f32_16x16x32_bf16 v[164:167], a[44:47], a[100:103], v[164:167]
buffer_load_dwordx4 v12, s[12:15], s45 offen offset:2048 lds
s_waitcnt lgkmcnt(4)
v_mfma_f32_16x16x32_bf16 v[168:171], a[48:51], a[96:99], v[168:171]
ds_read_b128 a[116:119], v14 offset:49664
v_mfma_f32_16x16x32_bf16 v[168:171], a[52:55], a[100:103], v[168:171]
ds_read_b128 a[120:123], v14 offset:33536
v_mfma_f32_16x16x32_bf16 v[172:175], a[56:59], a[96:99], v[172:175]
s_waitcnt lgkmcnt(4)
v_mfma_f32_16x16x32_bf16 v[172:175], a[60:63], a[100:103], v[172:175]
buffer_load_dwordx4 v13, s[12:15], s45 offen offset:3072 lds
v_mfma_f32_16x16x32_bf16 v[176:179], a[32:35], a[104:107], v[176:179]
s_add_u32 s44, s39, 0
s_waitcnt lgkmcnt(2)
v_mfma_f32_16x16x32_bf16 v[176:179], a[36:39], a[108:111], v[176:179]
s_add_u32 m0, s42, 0
v_mfma_f32_16x16x32_bf16 v[180:183], a[40:43], a[104:107], v[180:183]
buffer_load_dwordx4 v2, s[20:23], s44 offen offset:0 lds
v_mfma_f32_16x16x32_bf16 v[180:183], a[44:47], a[108:111], v[180:183]
ds_read_b128 a[124:127], v14 offset:49920
v_mfma_f32_16x16x32_bf16 v[184:187], a[48:51], a[104:107], v[184:187]
ds_read_b128 a[96:99], v14 offset:33792
v_mfma_f32_16x16x32_bf16 v[184:187], a[52:55], a[108:111], v[184:187]
ds_read_b128 a[100:103], v14 offset:50176
v_mfma_f32_16x16x32_bf16 v[188:191], a[56:59], a[104:107], v[188:191]
buffer_load_dwordx4 v3, s[20:23], s44 offen offset:1024 lds
v_mfma_f32_16x16x32_bf16 v[188:191], a[60:63], a[108:111], v[188:191]
v_mfma_f32_16x16x32_bf16 v[192:195], a[32:35], a[112:115], v[192:195]
s_waitcnt lgkmcnt(3)
v_mfma_f32_16x16x32_bf16 v[192:195], a[36:39], a[116:119], v[192:195]
ds_read_b128 a[104:107], v14 offset:34048
v_mfma_f32_16x16x32_bf16 v[196:199], a[40:43], a[112:115], v[196:199]
buffer_load_dwordx4 v2, s[20:23], s44 offen offset:2048 lds
v_mfma_f32_16x16x32_bf16 v[196:199], a[44:47], a[116:119], v[196:199]
ds_read_b128 a[108:111], v14 offset:50432
v_mfma_f32_16x16x32_bf16 v[200:203], a[48:51], a[112:115], v[200:203]
v_mfma_f32_16x16x32_bf16 v[200:203], a[52:55], a[116:119], v[200:203]
v_mfma_f32_16x16x32_bf16 v[204:207], a[56:59], a[112:115], v[204:207]
buffer_load_dwordx4 v3, s[20:23], s44 offen offset:3072 lds
v_mfma_f32_16x16x32_bf16 v[204:207], a[60:63], a[116:119], v[204:207]
s_add_u32 m0, s42, 4096
v_mfma_f32_16x16x32_bf16 v[208:211], a[32:35], a[120:123], v[208:211]
buffer_load_dwordx4 v4, s[20:23], s44 offen offset:0 lds
s_waitcnt lgkmcnt(1)
v_mfma_f32_16x16x32_bf16 v[208:211], a[36:39], a[124:127], v[208:211]
ds_read_b128 a[112:115], v14 offset:34304
v_mfma_f32_16x16x32_bf16 v[212:215], a[40:43], a[120:123], v[212:215]
ds_read_b128 a[116:119], v14 offset:50688
v_mfma_f32_16x16x32_bf16 v[212:215], a[44:47], a[124:127], v[212:215]
v_mfma_f32_16x16x32_bf16 v[216:219], a[48:51], a[120:123], v[216:219]
buffer_load_dwordx4 v5, s[20:23], s44 offen offset:1024 lds
v_mfma_f32_16x16x32_bf16 v[216:219], a[52:55], a[124:127], v[216:219]
v_mfma_f32_16x16x32_bf16 v[220:223], a[56:59], a[120:123], v[220:223]
v_mfma_f32_16x16x32_bf16 v[220:223], a[60:63], a[124:127], v[220:223]
v_mfma_f32_16x16x32_bf16 v[224:227], a[32:35], a[96:99], v[224:227]
buffer_load_dwordx4 v4, s[20:23], s44 offen offset:2048 lds
ds_read_b128 a[120:123], v14 offset:34560
v_mfma_f32_16x16x32_bf16 v[224:227], a[36:39], a[100:103], v[224:227]
ds_read_b128 a[124:127], v14 offset:50944
v_mfma_f32_16x16x32_bf16 v[228:231], a[40:43], a[96:99], v[228:231]
v_mfma_f32_16x16x32_bf16 v[228:231], a[44:47], a[100:103], v[228:231]
v_mfma_f32_16x16x32_bf16 v[232:235], a[48:51], a[96:99], v[232:235]
buffer_load_dwordx4 v5, s[20:23], s44 offen offset:3072 lds
v_mfma_f32_16x16x32_bf16 v[232:235], a[52:55], a[100:103], v[232:235]
v_mfma_f32_16x16x32_bf16 v[236:239], a[56:59], a[96:99], v[236:239]
v_mfma_f32_16x16x32_bf16 v[236:239], a[60:63], a[100:103], v[236:239]
s_waitcnt lgkmcnt(0) vmcnt(12)
s_barrier
v_mfma_f32_16x16x32_bf16 v[240:243], a[32:35], a[104:107], v[240:243]
ds_read_b64_tr_b16 a[64:65], v18 offset:32768
v_mfma_f32_16x16x32_bf16 v[240:243], a[36:39], a[108:111], v[240:243]
ds_read_b64_tr_b16 a[66:67], v18 offset:33792
v_mfma_f32_16x16x32_bf16 v[244:247], a[40:43], a[104:107], v[244:247]
ds_read_b64_tr_b16 a[68:69], v18 offset:40960
v_mfma_f32_16x16x32_bf16 v[244:247], a[44:47], a[108:111], v[244:247]
ds_read_b64_tr_b16 a[70:71], v18 offset:41984
v_mfma_f32_16x16x32_bf16 v[248:251], a[48:51], a[104:107], v[248:251]
ds_read_b128 a[96:99], v15 offset:0
v_mfma_f32_16x16x32_bf16 v[248:251], a[52:55], a[108:111], v[248:251]
ds_read_b128 a[100:103], v15 offset:16384
v_mfma_f32_16x16x32_bf16 v[252:255], a[56:59], a[104:107], v[252:255]
s_add_u32 s45, s41, 917504
v_mfma_f32_16x16x32_bf16 v[252:255], a[60:63], a[108:111], v[252:255]
s_add_u32 m0, s43, 16384
v_mfma_f32_16x16x32_bf16 a[0:3], a[32:35], a[112:115], a[0:3]
ds_read_b64_tr_b16 a[72:73], v19 offset:32768
v_mfma_f32_16x16x32_bf16 a[0:3], a[36:39], a[116:119], a[0:3]
ds_read_b64_tr_b16 a[74:75], v19 offset:33792
v_mfma_f32_16x16x32_bf16 a[4:7], a[40:43], a[112:115], a[4:7]
ds_read_b64_tr_b16 a[76:77], v19 offset:40960
v_mfma_f32_16x16x32_bf16 a[4:7], a[44:47], a[116:119], a[4:7]
ds_read_b64_tr_b16 a[78:79], v19 offset:41984
v_mfma_f32_16x16x32_bf16 a[8:11], a[48:51], a[112:115], a[8:11]
buffer_load_dwordx4 v10, s[12:15], s45 offen offset:0 lds
v_mfma_f32_16x16x32_bf16 a[8:11], a[52:55], a[116:119], a[8:11]
ds_read_b64_tr_b16 a[80:81], v20 offset:32768
v_mfma_f32_16x16x32_bf16 a[12:15], a[56:59], a[112:115], a[12:15]
ds_read_b64_tr_b16 a[82:83], v20 offset:33792
v_mfma_f32_16x16x32_bf16 a[12:15], a[60:63], a[116:119], a[12:15]
ds_read_b64_tr_b16 a[84:85], v20 offset:40960
v_mfma_f32_16x16x32_bf16 a[16:19], a[32:35], a[120:123], a[16:19]
ds_read_b64_tr_b16 a[86:87], v20 offset:41984
v_mfma_f32_16x16x32_bf16 a[16:19], a[36:39], a[124:127], a[16:19]
ds_read_b64_tr_b16 a[88:89], v21 offset:32768
v_mfma_f32_16x16x32_bf16 a[20:23], a[40:43], a[120:123], a[20:23]
v_mfma_f32_16x16x32_bf16 a[20:23], a[44:47], a[124:127], a[20:23]
v_mfma_f32_16x16x32_bf16 a[24:27], a[48:51], a[120:123], a[24:27]
s_waitcnt lgkmcnt(3)
ds_read_b64_tr_b16 a[90:91], v21 offset:33792
v_mfma_f32_16x16x32_bf16 a[24:27], a[52:55], a[124:127], a[24:27]
ds_read_b64_tr_b16 a[92:93], v21 offset:40960
v_mfma_f32_16x16x32_bf16 a[28:31], a[56:59], a[120:123], a[28:31]
ds_read_b64_tr_b16 a[94:95], v21 offset:41984
v_mfma_f32_16x16x32_bf16 a[28:31], a[60:63], a[124:127], a[28:31]
buffer_load_dwordx4 v11, s[12:15], s45 offen offset:1024 lds
v_mfma_f32_16x16x32_bf16 v[160:163], a[64:67], a[96:99], v[160:163]
ds_read_b128 a[104:107], v15 offset:256
v_mfma_f32_16x16x32_bf16 v[160:163], a[68:71], a[100:103], v[160:163]
ds_read_b128 a[108:111], v15 offset:16640
v_mfma_f32_16x16x32_bf16 v[164:167], a[72:75], a[96:99], v[164:167]
ds_read_b128 a[112:115], v15 offset:512
v_mfma_f32_16x16x32_bf16 v[164:167], a[76:79], a[100:103], v[164:167]
buffer_load_dwordx4 v12, s[12:15], s45 offen offset:2048 lds
v_mfma_f32_16x16x32_bf16 v[168:171], a[80:83], a[96:99], v[168:171]
s_waitcnt lgkmcnt(3)
v_mfma_f32_16x16x32_bf16 v[168:171], a[84:87], a[100:103], v[168:171]
ds_read_b128 a[116:119], v15 offset:16896
v_mfma_f32_16x16x32_bf16 v[172:175], a[88:91], a[96:99], v[172:175]
ds_read_b128 a[120:123], v15 offset:768
v_mfma_f32_16x16x32_bf16 v[172:175], a[92:95], a[100:103], v[172:175]
buffer_load_dwordx4 v13, s[12:15], s45 offen offset:3072 lds
s_waitcnt lgkmcnt(3)
v_mfma_f32_16x16x32_bf16 v[176:179], a[64:67], a[104:107], v[176:179]
s_add_u32 s44, s39, 1835008
v_mfma_f32_16x16x32_bf16 v[176:179], a[68:71], a[108:111], v[176:179]
s_add_u32 m0, s42, 32768
v_mfma_f32_16x16x32_bf16 v[180:183], a[72:75], a[104:107], v[180:183]
buffer_load_dwordx4 v2, s[20:23], s44 offen offset:0 lds
v_mfma_f32_16x16x32_bf16 v[180:183], a[76:79], a[108:111], v[180:183]
ds_read_b128 a[124:127], v15 offset:17152
v_mfma_f32_16x16x32_bf16 v[184:187], a[80:83], a[104:107], v[184:187]
ds_read_b128 a[96:99], v15 offset:1024
v_mfma_f32_16x16x32_bf16 v[184:187], a[84:87], a[108:111], v[184:187]
ds_read_b128 a[100:103], v15 offset:17408
v_mfma_f32_16x16x32_bf16 v[188:191], a[88:91], a[104:107], v[188:191]
buffer_load_dwordx4 v3, s[20:23], s44 offen offset:1024 lds
v_mfma_f32_16x16x32_bf16 v[188:191], a[92:95], a[108:111], v[188:191]
s_waitcnt lgkmcnt(3)
v_mfma_f32_16x16x32_bf16 v[192:195], a[64:67], a[112:115], v[192:195]
v_mfma_f32_16x16x32_bf16 v[192:195], a[68:71], a[116:119], v[192:195]
v_cmp_ne_u32_e64 vcc, s75, v28
v_mfma_f32_16x16x32_bf16 v[196:199], a[72:75], a[112:115], v[196:199]
buffer_load_dwordx4 v2, s[20:23], s44 offen offset:2048 lds
v_mfma_f32_16x16x32_bf16 v[196:199], a[76:79], a[116:119], v[196:199]
ds_read_b128 a[104:107], v15 offset:1280
v_mfma_f32_16x16x32_bf16 v[200:203], a[80:83], a[112:115], v[200:203]
ds_read_b128 a[108:111], v15 offset:17664
v_mfma_f32_16x16x32_bf16 v[200:203], a[84:87], a[116:119], v[200:203]
s_cbranch_vccnz KF_f3_slow
KF_f3_ok:
v_mfma_f32_16x16x32_bf16 v[204:207], a[88:91], a[112:115], v[204:207]
buffer_load_dwordx4 v3, s[20:23], s44 offen offset:3072 lds
v_mfma_f32_16x16x32_bf16 v[204:207], a[92:95], a[116:119], v[204:207]
s_add_u32 m0, s42, 36864
v_mfma_f32_16x16x32_bf16 v[208:211], a[64:67], a[120:123], v[208:211]
buffer_load_dwordx4 v4, s[20:23], s44 offen offset:0 lds
s_waitcnt lgkmcnt(2)
v_mfma_f32_16x16x32_bf16 v[208:211], a[68:71], a[124:127], v[208:211]
ds_read_b128 a[112:115], v15 offset:1536
v_mfma_f32_16x16x32_bf16 v[212:215], a[72:75], a[120:123], v[212:215]
ds_read_b128 a[116:119], v15 offset:17920
v_mfma_f32_16x16x32_bf16 v[212:215], a[76:79], a[124:127], v[212:215]
v_mfma_f32_16x16x32_bf16 v[216:219], a[80:83], a[120:123], v[216:219]
buffer_load_dwordx4 v5, s[20:23], s44 offen offset:1024 lds
v_mfma_f32_16x16x32_bf16 v[216:219], a[84:87], a[124:127], v[216:219]
v_mfma_f32_16x16x32_bf16 v[220:223], a[88:91], a[120:123], v[220:223]
v_mfma_f32_16x16x32_bf16 v[220:223], a[92:95], a[124:127], v[220:223]
v_mfma_f32_16x16x32_bf16 v[224:227], a[64:67], a[96:99], v[224:227]
buffer_load_dwordx4 v4, s[20:23], s44 offen offset:2048 lds
ds_read_b128 a[120:123], v15 offset:1792
v_mfma_f32_16x16x32_bf16 v[224:227], a[68:71], a[100:103], v[224:227]
ds_read_b128 a[124:127], v15 offset:18176
v_mfma_f32_16x16x32_bf16 v[228:231], a[72:75], a[96:99], v[228:231]
v_mfma_f32_16x16x32_bf16 v[228:231], a[76:79], a[100:103], v[228:231]
v_mfma_f32_16x16x32_bf16 v[232:235], a[80:83], a[96:99], v[232:235]
buffer_load_dwordx4 v5, s[20:23], s44 offen offset:3072 lds
v_mfma_f32_16x16x32_bf16 v[232:235], a[84:87], a[100:103], v[232:235]
v_mfma_f32_16x16x32_bf16 v[236:239], a[88:91], a[96:99], v[236:239]
v_mfma_f32_16x16x32_bf16 v[236:239], a[92:95], a[100:103], v[236:239]
s_waitcnt lgkmcnt(0) vmcnt(12)
s_barrier
v_mfma_f32_16x16x32_bf16 v[240:243], a[64:67], a[104:107], v[240:243]
s_mul_i32 s66, s3, 393216
s_add_u32 s66, s66, 196608
v_mfma_f32_16x16x32_bf16 v[240:243], a[68:71], a[108:111], v[240:243]
v_subrev_u32 v2, s66, v2
v_subrev_u32 v3, s66, v3
v_mfma_f32_16x16x32_bf16 v[244:247], a[72:75], a[104:107], v[244:247]
v_add_u32 v4, 0x8000, v2
v_add_u32 v5, 0x8000, v3
v_mfma_f32_16x16x32_bf16 v[244:247], a[76:79], a[108:111], v[244:247]
ds_read_b64_tr_b16 a[32:33], v18 offset:0
ds_read_b64_tr_b16 a[34:35], v18 offset:1024
v_mfma_f32_16x16x32_bf16 v[248:251], a[80:83], a[104:107], v[248:251]
ds_read_b64_tr_b16 a[36:37], v18 offset:8192
v_mfma_f32_16x16x32_bf16 v[248:251], a[84:87], a[108:111], v[248:251]
ds_read_b64_tr_b16 a[38:39], v18 offset:9216
v_mfma_f32_16x16x32_bf16 v[252:255], a[88:91], a[104:107], v[252:255]
ds_read_b128 a[96:99], v14 offset:0
v_mfma_f32_16x16x32_bf16 v[252:255], a[92:95], a[108:111], v[252:255]
ds_read_b128 a[100:103], v14 offset:16384
v_mfma_f32_16x16x32_bf16 a[0:3], a[64:67], a[112:115], a[0:3]
s_add_u32 s45, s40, 0
v_mfma_f32_16x16x32_bf16 a[0:3], a[68:71], a[116:119], a[0:3]
s_add_u32 m0, s43, 32768
v_mfma_f32_16x16x32_bf16 a[4:7], a[72:75], a[112:115], a[4:7]
ds_read_b64_tr_b16 a[40:41], v19 offset:0
v_mfma_f32_16x16x32_bf16 a[4:7], a[76:79], a[116:119], a[4:7]
ds_read_b64_tr_b16 a[42:43], v19 offset:1024
v_mfma_f32_16x16x32_bf16 a[8:11], a[80:83], a[112:115], a[8:11]
ds_read_b64_tr_b16 a[44:45], v19 offset:8192
v_mfma_f32_16x16x32_bf16 a[8:11], a[84:87], a[116:119], a[8:11]
ds_read_b64_tr_b16 a[46:47], v19 offset:9216
v_mfma_f32_16x16x32_bf16 a[12:15], a[88:91], a[112:115], a[12:15]
buffer_load_dwordx4 v6, s[16:19], s45 offen offset:0 lds
v_mfma_f32_16x16x32_bf16 a[12:15], a[92:95], a[116:119], a[12:15]
ds_read_b64_tr_b16 a[48:49], v20 offset:0
v_mfma_f32_16x16x32_bf16 a[16:19], a[64:67], a[120:123], a[16:19]
ds_read_b64_tr_b16 a[50:51], v20 offset:1024
v_mfma_f32_16x16x32_bf16 a[16:19], a[68:71], a[124:127], a[16:19]
ds_read_b64_tr_b16 a[52:53], v20 offset:8192
v_mfma_f32_16x16x32_bf16 a[20:23], a[72:75], a[120:123], a[20:23]
ds_read_b64_tr_b16 a[54:55], v20 offset:9216
v_mfma_f32_16x16x32_bf16 a[20:23], a[76:79], a[124:127], a[20:23]
ds_read_b64_tr_b16 a[56:57], v21 offset:0
v_mfma_f32_16x16x32_bf16 a[24:27], a[80:83], a[120:123], a[24:27]
s_waitcnt lgkmcnt(5)
ds_read_b64_tr_b16 a[58:59], v21 offset:1024
v_mfma_f32_16x16x32_bf16 a[24:27], a[84:87], a[124:127], a[24:27]
ds_read_b64_tr_b16 a[60:61], v21 offset:8192
v_mfma_f32_16x16x32_bf16 a[28:31], a[88:91], a[120:123], a[28:31]
ds_read_b64_tr_b16 a[62:63], v21 offset:9216
v_mfma_f32_16x16x32_bf16 a[28:31], a[92:95], a[124:127], a[28:31]
buffer_load_dwordx4 v7, s[16:19], s45 offen offset:1024 lds
v_mfma_f32_16x16x32_bf16 v[160:163], a[32:35], a[96:99], v[160:163]
ds_read_b128 a[104:107], v14 offset:256
v_mfma_f32_16x16x32_bf16 v[160:163], a[36:39], a[100:103], v[160:163]
ds_read_b128 a[108:111], v14 offset:16640
v_mfma_f32_16x16x32_bf16 v[164:167], a[40:43], a[96:99], v[164:167]
ds_read_b128 a[112:115], v14 offset:512
v_mfma_f32_16x16x32_bf16 v[164:167], a[44:47], a[100:103], v[164:167]
buffer_load_dwordx4 v8, s[16:19], s45 offen offset:2048 lds
s_waitcnt lgkmcnt(4)
v_mfma_f32_16x16x32_bf16 v[168:171], a[48:51], a[96:99], v[168:171]
ds_read_b128 a[116:119], v14 offset:16896
v_mfma_f32_16x16x32_bf16 v[168:171], a[52:55], a[100:103], v[168:171]
ds_read_b128 a[120:123], v14 offset:768
v_mfma_f32_16x16x32_bf16 v[172:175], a[56:59], a[96:99], v[172:175]
s_waitcnt lgkmcnt(4)
v_mfma_f32_16x16x32_bf16 v[172:175], a[60:63], a[100:103], v[172:175]
buffer_load_dwordx4 v9, s[16:19], s45 offen offset:3072 lds
v_mfma_f32_16x16x32_bf16 v[176:179], a[32:35], a[104:107], v[176:179]
s_add_u32 s44, s38, 0
s_waitcnt lgkmcnt(2)
v_mfma_f32_16x16x32_bf16 v[176:179], a[36:39], a[108:111], v[176:179]
s_add_u32 m0, s42, 65536
v_mfma_f32_16x16x32_bf16 v[180:183], a[40:43], a[104:107], v[180:183]
buffer_load_dwordx4 v2, s[20:23], s44 offen offset:0 lds
v_mfma_f32_16x16x32_bf16 v[180:183], a[44:47], a[108:111], v[180:183]
ds_read_b128 a[124:127], v14 offset:17152
v_mfma_f32_16x16x32_bf16 v[184:187], a[48:51], a[104:107], v[184:187]
ds_read_b128 a[96:99], v14 offset:1024
v_mfma_f32_16x16x32_bf16 v[184:187], a[52:55], a[108:111], v[184:187]
ds_read_b128 a[100:103], v14 offset:17408
v_mfma_f32_16x16x32_bf16 v[188:191], a[56:59], a[104:107], v[188:191]
buffer_load_dwordx4 v3, s[20:23], s44 offen offset:1024 lds
v_mfma_f32_16x16x32_bf16 v[188:191], a[60:63], a[108:111], v[188:191]
v_mfma_f32_16x16x32_bf16 v[192:195], a[32:35], a[112:115], v[192:195]
s_waitcnt lgkmcnt(3)
v_mfma_f32_16x16x32_bf16 v[192:195], a[36:39], a[116:119], v[192:195]
ds_read_b128 a[104:107], v14 offset:1280
v_mfma_f32_16x16x32_bf16 v[196:199], a[40:43], a[112:115], v[196:199]
buffer_load_dwordx4 v2, s[20:23], s44 offen offset:2048 lds
v_mfma_f32_16x16x32_bf16 v[196:199], a[44:47], a[116:119], v[196:199]
ds_read_b128 a[108:111], v14 offset:17664
v_mfma_f32_16x16x32_bf16 v[200:203], a[48:51], a[112:115], v[200:203]
v_mfma_f32_16x16x32_bf16 v[200:203], a[52:55], a[116:119], v[200:203]
v_mfma_f32_16x16x32_bf16 v[204:207], a[56:59], a[112:115], v[204:207]
buffer_load_dwordx4 v3, s[20:23], s44 offen offset:3072 lds
v_mfma_f32_16x16x32_bf16 v[204:207], a[60:63], a[116:119], v[204:207]
s_add_u32 m0, s42, 69632
v_mfma_f32_16x16x32_bf16 v[208:211], a[32:35], a[120:123], v[208:211]
buffer_load_dwordx4 v4, s[20:23], s44 offen offset:0 lds
s_waitcnt lgkmcnt(1)
v_mfma_f32_16x16x32_bf16 v[208:211], a[36:39], a[124:127], v[208:211]
ds_read_b128 a[112:115], v14 offset:1536
v_mfma_f32_16x16x32_bf16 v[212:215], a[40:43], a[120:123], v[212:215]
ds_read_b128 a[116:119], v14 offset:17920
v_mfma_f32_16x16x32_bf16 v[212:215], a[44:47], a[124:127], v[212:215]
v_mfma_f32_16x16x32_bf16 v[216:219], a[48:51], a[120:123], v[216:219]
buffer_load_dwordx4 v5, s[20:23], s44 offen offset:1024 lds
v_mfma_f32_16x16x32_bf16 v[216:219], a[52:55], a[124:127], v[216:219]
v_mfma_f32_16x16x32_bf16 v[220:223], a[56:59], a[120:123], v[220:223]
v_mfma_f32_16x16x32_bf16 v[220:223], a[60:63], a[124:127], v[220:223]
v_mfma_f32_16x16x32_bf16 v[224:227], a[32:35], a[96:99], v[224:227]
buffer_load_dwordx4 v4, s[20:23], s44 offen offset:2048 lds
ds_read_b128 a[120:123], v14 offset:1792
v_mfma_f32_16x16x32_bf16 v[224:227], a[36:39], a[100:103], v[224:227]
ds_read_b128 a[124:127], v14 offset:18176
v_mfma_f32_16x16x32_bf16 v[228:231], a[40:43], a[96:99], v[228:231]
v_mfma_f32_16x16x32_bf16 v[228:231], a[44:47], a[100:103], v[228:231]
v_mfma_f32_16x16x32_bf16 v[232:235], a[48:51], a[96:99], v[232:235]
buffer_load_dwordx4 v5, s[20:23], s44 offen offset:3072 lds
v_mfma_f32_16x16x32_bf16 v[232:235], a[52:55], a[100:103], v[232:235]
v_mfma_f32_16x16x32_bf16 v[236:239], a[56:59], a[96:99], v[236:239]
v_mfma_f32_16x16x32_bf16 v[236:239], a[60:63], a[100:103], v[236:239]
s_waitcnt lgkmcnt(0) vmcnt(12)
s_barrier
v_mfma_f32_16x16x32_bf16 v[240:243], a[32:35], a[104:107], v[240:243]
ds_read_b64_tr_b16 a[64:65], v18 offset:16384
v_mfma_f32_16x16x32_bf16 v[240:243], a[36:39], a[108:111], v[240:243]
ds_read_b64_tr_b16 a[66:67], v18 offset:17408
v_mfma_f32_16x16x32_bf16 v[244:247], a[40:43], a[104:107], v[244:247]
ds_read_b64_tr_b16 a[68:69], v18 offset:24576
v_mfma_f32_16x16x32_bf16 v[244:247], a[44:47], a[108:111], v[244:247]
ds_read_b64_tr_b16 a[70:71], v18 offset:25600
v_mfma_f32_16x16x32_bf16 v[248:251], a[48:51], a[104:107], v[248:251]
ds_read_b128 a[96:99], v14 offset:32768
v_mfma_f32_16x16x32_bf16 v[248:251], a[52:55], a[108:111], v[248:251]
ds_read_b128 a[100:103], v14 offset:49152
v_mfma_f32_16x16x32_bf16 v[252:255], a[56:59], a[104:107], v[252:255]
s_add_u32 s45, s40, 0
v_mfma_f32_16x16x32_bf16 v[252:255], a[60:63], a[108:111], v[252:255]
s_add_u32 m0, s43, 0
v_mfma_f32_16x16x32_bf16 a[0:3], a[32:35], a[112:115], a[0:3]
ds_read_b64_tr_b16 a[72:73], v19 offset:16384
v_mfma_f32_16x16x32_bf16 a[0:3], a[36:39], a[116:119], a[0:3]
ds_read_b64_tr_b16 a[74:75], v19 offset:17408
v_mfma_f32_16x16x32_bf16 a[4:7], a[40:43], a[112:115], a[4:7]
ds_read_b64_tr_b16 a[76:77], v19 offset:24576
v_mfma_f32_16x16x32_bf16 a[4:7], a[44:47], a[116:119], a[4:7]
ds_read_b64_tr_b16 a[78:79], v19 offset:25600
v_mfma_f32_16x16x32_bf16 a[8:11], a[48:51], a[112:115], a[8:11]
buffer_load_dwordx4 v6, s[24:27], s45 offen offset:0 lds
v_mfma_f32_16x16x32_bf16 a[8:11], a[52:55], a[116:119], a[8:11]
ds_read_b64_tr_b16 a[80:81], v20 offset:16384
v_mfma_f32_16x16x32_bf16 a[12:15], a[56:59], a[112:115], a[12:15]
ds_read_b64_tr_b16 a[82:83], v20 offset:17408
v_mfma_f32_16x16x32_bf16 a[12:15], a[60:63], a[116:119], a[12:15]
ds_read_b64_tr_b16 a[84:85], v20 offset:24576
v_mfma_f32_16x16x32_bf16 a[16:19], a[32:35], a[120:123], a[16:19]
ds_read_b64_tr_b16 a[86:87], v20 offset:25600
v_mfma_f32_16x16x32_bf16 a[16:19], a[36:39], a[124:127], a[16:19]
ds_read_b64_tr_b16 a[88:89], v21 offset:16384
v_mfma_f32_16x16x32_bf16 a[20:23], a[40:43], a[120:123], a[20:23]
v_mfma_f32_16x16x32_bf16 a[20:23], a[44:47], a[124:127], a[20:23]
v_mfma_f32_16x16x32_bf16 a[24:27], a[48:51], a[120:123], a[24:27]
s_waitcnt lgkmcnt(3)
ds_read_b64_tr_b16 a[90:91], v21 offset:17408
v_mfma_f32_16x16x32_bf16 a[24:27], a[52:55], a[124:127], a[24:27]
ds_read_b64_tr_b16 a[92:93], v21 offset:24576
v_mfma_f32_16x16x32_bf16 a[28:31], a[56:59], a[120:123], a[28:31]
ds_read_b64_tr_b16 a[94:95], v21 offset:25600
v_mfma_f32_16x16x32_bf16 a[28:31], a[60:63], a[124:127], a[28:31]
buffer_load_dwordx4 v7, s[24:27], s45 offen offset:1024 lds
v_mfma_f32_16x16x32_bf16 v[160:163], a[64:67], a[96:99], v[160:163]
ds_read_b128 a[104:107], v14 offset:33024
v_mfma_f32_16x16x32_bf16 v[160:163], a[68:71], a[100:103], v[160:163]
ds_read_b128 a[108:111], v14 offset:49408
v_mfma_f32_16x16x32_bf16 v[164:167], a[72:75], a[96:99], v[164:167]
ds_read_b128 a[112:115], v14 offset:33280
v_mfma_f32_16x16x32_bf16 v[164:167], a[76:79], a[100:103], v[164:167]
buffer_load_dwordx4 v8, s[24:27], s45 offen offset:2048 lds
v_mfma_f32_16x16x32_bf16 v[168:171], a[80:83], a[96:99], v[168:171]
s_waitcnt lgkmcnt(3)
v_mfma_f32_16x16x32_bf16 v[168:171], a[84:87], a[100:103], v[168:171]
ds_read_b128 a[116:119], v14 offset:49664
v_mfma_f32_16x16x32_bf16 v[172:175], a[88:91], a[96:99], v[172:175]
ds_read_b128 a[120:123], v14 offset:33536
v_mfma_f32_16x16x32_bf16 v[172:175], a[92:95], a[100:103], v[172:175]
buffer_load_dwordx4 v9, s[24:27], s45 offen offset:3072 lds
s_waitcnt lgkmcnt(3)
v_mfma_f32_16x16x32_bf16 v[176:179], a[64:67], a[104:107], v[176:179]
s_add_u32 s44, s38, 4194304
v_mfma_f32_16x16x32_bf16 v[176:179], a[68:71], a[108:111], v[176:179]
s_add_u32 m0, s42, 0
v_mfma_f32_16x16x32_bf16 v[180:183], a[72:75], a[104:107], v[180:183]
buffer_load_dwordx4 v2, s[20:23], s44 offen offset:0 lds
v_mfma_f32_16x16x32_bf16 v[180:183], a[76:79], a[108:111], v[180:183]
ds_read_b128 a[124:127], v14 offset:49920
v_mfma_f32_16x16x32_bf16 v[184:187], a[80:83], a[104:107], v[184:187]
ds_read_b128 a[96:99], v14 offset:33792
v_mfma_f32_16x16x32_bf16 v[184:187], a[84:87], a[108:111], v[184:187]
ds_read_b128 a[100:103], v14 offset:50176
v_mfma_f32_16x16x32_bf16 v[188:191], a[88:91], a[104:107], v[188:191]
buffer_load_dwordx4 v3, s[20:23], s44 offen offset:1024 lds
v_mfma_f32_16x16x32_bf16 v[188:191], a[92:95], a[108:111], v[188:191]
s_waitcnt lgkmcnt(3)
v_mfma_f32_16x16x32_bf16 v[192:195], a[64:67], a[112:115], v[192:195]
v_mfma_f32_16x16x32_bf16 v[192:195], a[68:71], a[116:119], v[192:195]
ds_read_b128 a[104:107], v14 offset:34048
v_mfma_f32_16x16x32_bf16 v[196:199], a[72:75], a[112:115], v[196:199]
buffer_load_dwordx4 v2, s[20:23], s44 offen offset:2048 lds
v_mfma_f32_16x16x32_bf16 v[196:199], a[76:79], a[116:119], v[196:199]
ds_read_b128 a[108:111], v14 offset:50432
v_mfma_f32_16x16x32_bf16 v[200:203], a[80:83], a[112:115], v[200:203]
v_mfma_f32_16x16x32_bf16 v[200:203], a[84:87], a[116:119], v[200:203]
v_mfma_f32_16x16x32_bf16 v[204:207], a[88:91], a[112:115], v[204:207]
buffer_load_dwordx4 v3, s[20:23], s44 offen offset:3072 lds
v_mfma_f32_16x16x32_bf16 v[204:207], a[92:95], a[116:119], v[204:207]
s_add_u32 m0, s42, 4096
v_mfma_f32_16x16x32_bf16 v[208:211], a[64:67], a[120:123], v[208:211]
buffer_load_dwordx4 v4, s[20:23], s44 offen offset:0 lds
s_waitcnt lgkmcnt(1)
v_mfma_f32_16x16x32_bf16 v[208:211], a[68:71], a[124:127], v[208:211]
ds_read_b128 a[112:115], v14 offset:34304
v_mfma_f32_16x16x32_bf16 v[212:215], a[72:75], a[120:123], v[212:215]
ds_read_b128 a[116:119], v14 offset:50688
v_mfma_f32_16x16x32_bf16 v[212:215], a[76:79], a[124:127], v[212:215]
v_mfma_f32_16x16x32_bf16 v[216:219], a[80:83], a[120:123], v[216:219]
buffer_load_dwordx4 v5, s[20:23], s44 offen offset:1024 lds
v_mfma_f32_16x16x32_bf16 v[216:219], a[84:87], a[124:127], v[216:219]
v_mfma_f32_16x16x32_bf16 v[220:223], a[88:91], a[120:123], v[220:223]
v_mfma_f32_16x16x32_bf16 v[220:223], a[92:95], a[124:127], v[220:223]
v_mfma_f32_16x16x32_bf16 v[224:227], a[64:67], a[96:99], v[224:227]
buffer_load_dwordx4 v4, s[20:23], s44 offen offset:2048 lds
ds_read_b128 a[120:123], v14 offset:34560
v_mfma_f32_16x16x32_bf16 v[224:227], a[68:71], a[100:103], v[224:227]
ds_read_b128 a[124:127], v14 offset:50944
v_mfma_f32_16x16x32_bf16 v[228:231], a[72:75], a[96:99], v[228:231]
v_mfma_f32_16x16x32_bf16 v[228:231], a[76:79], a[100:103], v[228:231]
v_mfma_f32_16x16x32_bf16 v[232:235], a[80:83], a[96:99], v[232:235]
buffer_load_dwordx4 v5, s[20:23], s44 offen offset:3072 lds
v_mfma_f32_16x16x32_bf16 v[232:235], a[84:87], a[100:103], v[232:235]
s_getpc_b64 s[76:77]
KF_ct4:
s_add_u32 s76, s76, KF_k2+24576-KF_ct4
v_mfma_f32_16x16x32_bf16 v[236:239], a[88:91], a[96:99], v[236:239]
s_addc_u32 s77, s77, 0
s_lshl_b32 s78, s3, 4
v_and_b32 v1, 15, v0
v_add_lshl_u32 v1, v1, s78, 7
v_min_u32 v1, KF_last-(KF_k2+24576), v1
v_mfma_f32_16x16x32_bf16 v[236:239], a[92:95], a[100:103], v[236:239]
global_load_dword a255, v1, s[76:77]
s_waitcnt lgkmcnt(0) vmcnt(13)
s_barrier
v_mfma_f32_16x16x32_bf16 v[240:243], a[64:67], a[104:107], v[240:243]
ds_read_b128 a[32:35], v16 offset:32768
ds_read_b128 a[36:39], v17 offset:32768
v_mfma_f32_16x16x32_bf16 v[240:243], a[68:71], a[108:111], v[240:243]
ds_read_b128 a[96:99], v15 offset:0
ds_read_b128 a[100:103], v15 offset:16384
v_mfma_f32_16x16x32_bf16 v[244:247], a[72:75], a[104:107], v[244:247]
s_add_u32 s45, s40, 128
ds_read_b128 a[40:43], v16 offset:34816
v_mfma_f32_16x16x32_bf16 v[244:247], a[76:79], a[108:111], v[244:247]
s_add_u32 m0, s43, 16384
ds_read_b128 a[44:47], v17 offset:34816
v_mfma_f32_16x16x32_bf16 v[248:251], a[80:83], a[104:107], v[248:251]
buffer_load_dwordx4 v6, s[16:19], s45 offen offset:0 lds
ds_read_b128 a[48:51], v16 offset:36864
v_mfma_f32_16x16x32_bf16 v[248:251], a[84:87], a[108:111], v[248:251]
ds_read_b128 a[52:55], v17 offset:36864
ds_read_b128 a[56:59], v16 offset:38912
v_mfma_f32_16x16x32_bf16 v[252:255], a[88:91], a[104:107], v[252:255]
ds_read_b128 a[60:63], v17 offset:38912
v_mfma_f32_16x16x32_bf16 v[252:255], a[92:95], a[108:111], v[252:255]
v_mfma_f32_16x16x32_bf16 a[0:3], a[64:67], a[112:115], a[0:3]
buffer_load_dwordx4 v7, s[16:19], s45 offen offset:1024 lds
ds_read_b128 a[104:107], v15 offset:256
v_mfma_f32_16x16x32_bf16 a[0:3], a[68:71], a[116:119], a[0:3]
ds_read_b128 a[108:111], v15 offset:16640
v_mfma_f32_16x16x32_bf16 a[4:7], a[72:75], a[112:115], a[4:7]
v_mfma_f32_16x16x32_bf16 a[4:7], a[76:79], a[116:119], a[4:7]
v_mfma_f32_16x16x32_bf16 a[8:11], a[80:83], a[112:115], a[8:11]
buffer_load_dwordx4 v8, s[16:19], s45 offen offset:2048 lds
v_mfma_f32_16x16x32_bf16 a[8:11], a[84:87], a[116:119], a[8:11]
v_mfma_f32_16x16x32_bf16 a[12:15], a[88:91], a[112:115], a[12:15]
v_mfma_f32_16x16x32_bf16 a[12:15], a[92:95], a[116:119], a[12:15]
v_mfma_f32_16x16x32_bf16 a[16:19], a[64:67], a[120:123], a[16:19]
buffer_load_dwordx4 v9, s[16:19], s45 offen offset:3072 lds
ds_read_b128 a[112:115], v15 offset:512
v_mfma_f32_16x16x32_bf16 a[16:19], a[68:71], a[124:127], a[16:19]
s_add_u32 s44, s38, 262144
ds_read_b128 a[116:119], v15 offset:16896
v_mfma_f32_16x16x32_bf16 a[20:23], a[72:75], a[120:123], a[20:23]
s_add_u32 m0, s42, 32768
v_mfma_f32_16x16x32_bf16 a[20:23], a[76:79], a[124:127], a[20:23]
buffer_load_dwordx4 v2, s[20:23], s44 offen offset:0 lds
v_mfma_f32_16x16x32_bf16 a[24:27], a[80:83], a[120:123], a[24:27]
v_mfma_f32_16x16x32_bf16 a[24:27], a[84:87], a[124:127], a[24:27]
v_mfma_f32_16x16x32_bf16 a[28:31], a[88:91], a[120:123], a[28:31]
v_mfma_f32_16x16x32_bf16 a[28:31], a[92:95], a[124:127], a[28:31]
buffer_load_dwordx4 v3, s[20:23], s44 offen offset:1024 lds
s_waitcnt lgkmcnt(0)
v_mfma_f32_16x16x32_bf16 v[32:35], a[32:35], a[96:99], 0
ds_read_b128 a[120:123], v15 offset:768
ds_read_b128 a[124:127], v15 offset:17152
v_mfma_f32_16x16x32_bf16 v[32:35], a[36:39], a[100:103], v[32:35]
v_mfma_f32_16x16x32_bf16 v[36:39], a[40:43], a[96:99], 0
v_mfma_f32_16x16x32_bf16 v[36:39], a[44:47], a[100:103], v[36:39]
buffer_load_dwordx4 v2, s[20:23], s44 offen offset:2048 lds
v_mfma_f32_16x16x32_bf16 v[40:43], a[48:51], a[96:99], 0
v_mfma_f32_16x16x32_bf16 v[40:43], a[52:55], a[100:103], v[40:43]
v_mfma_f32_16x16x32_bf16 v[44:47], a[56:59], a[96:99], 0
v_accvgpr_read_b32 v22, a128
v_and_b32 v22, 0xffff0000, v22
v_mfma_f32_16x16x32_bf16 v[44:47], a[60:63], a[100:103], v[44:47]
buffer_load_dwordx4 v3, s[20:23], s44 offen offset:3072 lds
v_accvgpr_read_b32 v23, a130
v_mfma_f32_16x16x32_bf16 v[48:51], a[32:35], a[104:107], 0
s_add_u32 m0, s42, 36864
ds_read_b128 a[96:99], v15 offset:1024
v_mfma_f32_16x16x32_bf16 v[48:51], a[36:39], a[108:111], v[48:51]
buffer_load_dwordx4 v4, s[20:23], s44 offen offset:0 lds
ds_read_b128 a[100:103], v15 offset:17408
v_mfma_f32_16x16x32_bf16 v[52:55], a[40:43], a[104:107], 0
v_and_b32 v23, 0xffff0000, v23
v_accvgpr_read_b32 v24, a132
v_mfma_f32_16x16x32_bf16 v[52:55], a[44:47], a[108:111], v[52:55]
v_and_b32 v24, 0xffff0000, v24
v_accvgpr_read_b32 v25, a134
v_mfma_f32_16x16x32_bf16 v[56:59], a[48:51], a[104:107], 0
v_and_b32 v25, 0xffff0000, v25
v_accvgpr_read_b32 v26, a136
v_mfma_f32_16x16x32_bf16 v[56:59], a[52:55], a[108:111], v[56:59]
buffer_load_dwordx4 v5, s[20:23], s44 offen offset:1024 lds
v_and_b32 v26, 0xffff0000, v26
v_mfma_f32_16x16x32_bf16 v[60:63], a[56:59], a[104:107], 0
v_accvgpr_read_b32 v27, a138
v_and_b32 v27, 0xffff0000, v27
v_mfma_f32_16x16x32_bf16 v[60:63], a[60:63], a[108:111], v[60:63]
v_accvgpr_read_b32 v28, a140
v_and_b32 v28, 0xffff0000, v28
v_mfma_f32_16x16x32_bf16 v[64:67], a[32:35], a[112:115], 0
ds_read_b128 a[104:107], v15 offset:1280
ds_read_b128 a[108:111], v15 offset:17664
v_mfma_f32_16x16x32_bf16 v[64:67], a[36:39], a[116:119], v[64:67]
buffer_load_dwordx4 v4, s[20:23], s44 offen offset:2048 lds
v_accvgpr_read_b32 v29, a142
v_mfma_f32_16x16x32_bf16 v[68:71], a[40:43], a[112:115], 0
v_and_b32 v29, 0xffff0000, v29
v_mul_f32 v160, v22, v160
v_mfma_f32_16x16x32_bf16 v[68:71], a[44:47], a[116:119], v[68:71]
v_mul_f32 v161, v22, v161
v_mul_f32 v162, v22, v162
v_mfma_f32_16x16x32_bf16 v[72:75], a[48:51], a[112:115], 0
v_mul_f32 v163, v22, v163
v_mul_f32 v164, v22, v164
v_mfma_f32_16x16x32_bf16 v[72:75], a[52:55], a[116:119], v[72:75]
buffer_load_dwordx4 v5, s[20:23], s44 offen offset:3072 lds
v_mfma_f32_16x16x32_bf16 v[76:79], a[56:59], a[112:115], 0
v_mul_f32_e64 v165, v22, v165
v_mfma_f32_16x16x32_bf16 v[76:79], a[60:63], a[116:119], v[76:79]
v_mul_f32 v166, v22, v166
s_waitcnt lgkmcnt(0)
v_mfma_f32_16x16x32_bf16 v[80:83], a[32:35], a[120:123], 0
ds_read_b128 a[112:115], v15 offset:1536
v_mfma_f32_16x16x32_bf16 v[80:83], a[36:39], a[124:127], v[80:83]
ds_read_b128 a[116:119], v15 offset:17920
v_mfma_f32_16x16x32_bf16 v[84:87], a[40:43], a[120:123], 0
v_mul_f32_e64 v167, v22, v167
v_mfma_f32_16x16x32_bf16 v[84:87], a[44:47], a[124:127], v[84:87]
v_mul_f32_e64 v168, v22, v168
v_mfma_f32_16x16x32_bf16 v[88:91], a[48:51], a[120:123], 0
v_mul_f32_e64 v169, v22, v169
v_mfma_f32_16x16x32_bf16 v[88:91], a[52:55], a[124:127], v[88:91]
v_mul_f32_e64 v170, v22, v170
v_mfma_f32_16x16x32_bf16 v[92:95], a[56:59], a[120:123], 0
v_mul_f32_e64 v171, v22, v171
v_mfma_f32_16x16x32_bf16 v[92:95], a[60:63], a[124:127], v[92:95]
v_mul_f32_e64 v172, v22, v172
v_mfma_f32_16x16x32_bf16 v[96:99], a[32:35], a[96:99], 0
ds_read_b128 a[120:123], v15 offset:1792
v_mfma_f32_16x16x32_bf16 v[96:99], a[36:39], a[100:103], v[96:99]
ds_read_b128 a[124:127], v15 offset:18176
v_mfma_f32_16x16x32_bf16 v[100:103], a[40:43], a[96:99], 0
v_mul_f32_e64 v173, v22, v173
v_mfma_f32_16x16x32_bf16 v[100:103], a[44:47], a[100:103], v[100:103]
v_mul_f32_e64 v174, v22, v174
v_mfma_f32_16x16x32_bf16 v[104:107], a[48:51], a[96:99], 0
v_mul_f32_e64 v175, v22, v175
v_mfma_f32_16x16x32_bf16 v[104:107], a[52:55], a[100:103], v[104:107]
v_mul_f32_e64 v176, v23, v176
v_mfma_f32_16x16x32_bf16 v[108:111], a[56:59], a[96:99], 0
v_mul_f32_e64 v177, v23, v177
v_mfma_f32_16x16x32_bf16 v[108:111], a[60:63], a[100:103], v[108:111]
v_mul_f32 v178, v23, v178
s_waitcnt lgkmcnt(0) vmcnt(13)
s_barrier
v_mfma_f32_16x16x32_bf16 v[112:115], a[32:35], a[104:107], 0
ds_read_b128 a[64:67], v16 offset:0
ds_read_b128 a[68:71], v17 offset:0
v_mfma_f32_16x16x32_bf16 v[112:115], a[36:39], a[108:111], v[112:115]
ds_read_b128 a[96:99], v14 offset:0
ds_read_b128 a[100:103], v14 offset:16384
v_mfma_f32_16x16x32_bf16 v[116:119], a[40:43], a[104:107], 0
s_add_u32 s45, s40, 128
ds_read_b128 a[72:75], v16 offset:2048
v_mfma_f32_16x16x32_bf16 v[116:119], a[44:47], a[108:111], v[116:119]
s_add_u32 m0, s43, 32768
ds_read_b128 a[76:79], v17 offset:2048
v_mfma_f32_16x16x32_bf16 v[120:123], a[48:51], a[104:107], 0
buffer_load_dwordx4 v6, s[24:27], s45 offen offset:0 lds
ds_read_b128 a[80:83], v16 offset:4096
v_mfma_f32_16x16x32_bf16 v[120:123], a[52:55], a[108:111], v[120:123]
ds_read_b128 a[84:87], v17 offset:4096
ds_read_b128 a[88:91], v16 offset:6144
v_mfma_f32_16x16x32_bf16 v[124:127], a[56:59], a[104:107], 0
ds_read_b128 a[92:95], v17 offset:6144
v_mul_f32 v179, v23, v179
v_mfma_f32_16x16x32_bf16 v[124:127], a[60:63], a[108:111], v[124:127]
v_mul_f32 v180, v23, v180
v_mul_f32 v181, v23, v181
v_mfma_f32_16x16x32_bf16 v[128:131], a[32:35], a[112:115], 0
buffer_load_dwordx4 v7, s[24:27], s45 offen offset:1024 lds
ds_read_b128 a[104:107], v14 offset:256
v_mfma_f32_16x16x32_bf16 v[128:131], a[36:39], a[116:119], v[128:131]
ds_read_b128 a[108:111], v14 offset:16640
v_mul_f32_e64 v182, v23, v182
v_mfma_f32_16x16x32_bf16 v[132:135], a[40:43], a[112:115], 0
v_mul_f32 v183, v23, v183
v_mul_f32 v184, v23, v184
v_mfma_f32_16x16x32_bf16 v[132:135], a[44:47], a[116:119], v[132:135]
v_mul_f32 v185, v23, v185
v_mul_f32 v186, v23, v186
v_mfma_f32_16x16x32_bf16 v[136:139], a[48:51], a[112:115], 0
buffer_load_dwordx4 v8, s[24:27], s45 offen offset:2048 lds
v_mfma_f32_16x16x32_bf16 v[136:139], a[52:55], a[116:119], v[136:139]
v_mul_f32_e64 v187, v23, v187
v_mfma_f32_16x16x32_bf16 v[140:143], a[56:59], a[112:115], 0
v_mul_f32_e64 v188, v23, v188
v_mfma_f32_16x16x32_bf16 v[140:143], a[60:63], a[116:119], v[140:143]
v_mul_f32_e64 v189, v23, v189
v_mfma_f32_16x16x32_bf16 v[144:147], a[32:35], a[120:123], 0
buffer_load_dwordx4 v9, s[24:27], s45 offen offset:3072 lds
v_mfma_f32_16x16x32_bf16 v[144:147], a[36:39], a[124:127], v[144:147]
s_add_u32 s44, s38, 4456448
v_mfma_f32_16x16x32_bf16 v[148:151], a[40:43], a[120:123], 0
ds_read_b128 a[112:115], v14 offset:512
v_mfma_f32_16x16x32_bf16 v[148:151], a[44:47], a[124:127], v[148:151]
ds_read_b128 a[116:119], v14 offset:16896
v_mfma_f32_16x16x32_bf16 v[152:155], a[48:51], a[120:123], 0
s_add_u32 m0, s42, 65536
v_mfma_f32_16x16x32_bf16 v[152:155], a[52:55], a[124:127], v[152:155]
buffer_load_dwordx4 v2, s[20:23], s44 offen offset:0 lds
v_mfma_f32_16x16x32_bf16 v[156:159], a[56:59], a[120:123], 0
v_mul_f32_e64 v190, v23, v190
v_mfma_f32_16x16x32_bf16 v[156:159], a[60:63], a[124:127], v[156:159]
v_mul_f32 v191, v23, v191
s_waitcnt lgkmcnt(2)
v_mfma_f32_16x16x32_bf16 v[32:35], a[64:67], a[96:99], v[32:35]
ds_read_b128 a[120:123], v14 offset:768
v_mfma_f32_16x16x32_bf16 v[32:35], a[68:71], a[100:103], v[32:35]
buffer_load_dwordx4 v3, s[20:23], s44 offen offset:1024 lds
v_mfma_f32_16x16x32_bf16 v[36:39], a[72:75], a[96:99], v[36:39]
ds_read_b128 a[124:127], v14 offset:17152
v_mfma_f32_16x16x32_bf16 v[36:39], a[76:79], a[100:103], v[36:39]
v_mul_f32_e64 v192, v24, v192
v_mfma_f32_16x16x32_bf16 v[40:43], a[80:83], a[96:99], v[40:43]
v_mul_f32_e64 v193, v24, v193
v_mfma_f32_16x16x32_bf16 v[40:43], a[84:87], a[100:103], v[40:43]
buffer_load_dwordx4 v2, s[20:23], s44 offen offset:2048 lds
v_mfma_f32_16x16x32_bf16 v[44:47], a[88:91], a[96:99], v[44:47]
v_mul_f32_e64 v194, v24, v194
v_mfma_f32_16x16x32_bf16 v[44:47], a[92:95], a[100:103], v[44:47]
v_mul_f32_e64 v195, v24, v195
v_mfma_f32_16x16x32_bf16 v[48:51], a[64:67], a[104:107], v[48:51]
ds_read_b128 a[96:99], v14 offset:1024
v_mfma_f32_16x16x32_bf16 v[48:51], a[68:71], a[108:111], v[48:51]
buffer_load_dwordx4 v3, s[20:23], s44 offen offset:3072 lds
v_mfma_f32_16x16x32_bf16 v[52:55], a[72:75], a[104:107], v[52:55]
s_add_u32 m0, s42, 69632
v_mfma_f32_16x16x32_bf16 v[52:55], a[76:79], a[108:111], v[52:55]
buffer_load_dwordx4 v4, s[20:23], s44 offen offset:0 lds
v_mfma_f32_16x16x32_bf16 v[56:59], a[80:83], a[104:107], v[56:59]
ds_read_b128 a[100:103], v14 offset:17408
v_mfma_f32_16x16x32_bf16 v[56:59], a[84:87], a[108:111], v[56:59]
v_mul_f32_e64 v196, v24, v196
v_mfma_f32_16x16x32_bf16 v[60:63], a[88:91], a[104:107], v[60:63]
v_mul_f32_e64 v197, v24, v197
v_mfma_f32_16x16x32_bf16 v[60:63], a[92:95], a[108:111], v[60:63]
buffer_load_dwordx4 v5, s[20:23], s44 offen offset:1024 lds
s_waitcnt lgkmcnt(1)
v_mfma_f32_16x16x32_bf16 v[64:67], a[64:67], a[112:115], v[64:67]
ds_read_b128 a[104:107], v14 offset:1280
v_mfma_f32_16x16x32_bf16 v[64:67], a[68:71], a[116:119], v[64:67]
ds_read_b128 a[108:111], v14 offset:17664
v_mfma_f32_16x16x32_bf16 v[68:71], a[72:75], a[112:115], v[68:71]
v_mul_f32 v198, v24, v198
v_mfma_f32_16x16x32_bf16 v[68:71], a[76:79], a[116:119], v[68:71]
buffer_load_dwordx4 v4, s[20:23], s44 offen offset:2048 lds
v_mfma_f32_16x16x32_bf16 v[72:75], a[80:83], a[112:115], v[72:75]
v_mul_f32_e64 v199, v24, v199
v_mfma_f32_16x16x32_bf16 v[72:75], a[84:87], a[116:119], v[72:75]
v_mul_f32_e64 v200, v24, v200
v_mfma_f32_16x16x32_bf16 v[76:79], a[88:91], a[112:115], v[76:79]
v_mul_f32_e64 v201, v24, v201
v_mfma_f32_16x16x32_bf16 v[76:79], a[92:95], a[116:119], v[76:79]
buffer_load_dwordx4 v5, s[20:23], s44 offen offset:3072 lds
v_mfma_f32_16x16x32_bf16 v[80:83], a[64:67], a[120:123], v[80:83]
ds_read_b128 a[112:115], v14 offset:1536
v_mfma_f32_16x16x32_bf16 v[80:83], a[68:71], a[124:127], v[80:83]
ds_read_b128 a[116:119], v14 offset:17920
v_mfma_f32_16x16x32_bf16 v[84:87], a[72:75], a[120:123], v[84:87]
v_mul_f32_e64 v202, v24, v202
v_mfma_f32_16x16x32_bf16 v[84:87], a[76:79], a[124:127], v[84:87]
v_mul_f32_e64 v203, v24, v203
v_mfma_f32_16x16x32_bf16 v[88:91], a[80:83], a[120:123], v[88:91]
v_mul_f32_e64 v204, v24, v204
v_mfma_f32_16x16x32_bf16 v[88:91], a[84:87], a[124:127], v[88:91]
v_mul_f32_e64 v205, v24, v205
v_mfma_f32_16x16x32_bf16 v[92:95], a[88:91], a[120:123], v[92:95]
v_mul_f32_e64 v206, v24, v206
v_mfma_f32_16x16x32_bf16 v[92:95], a[92:95], a[124:127], v[92:95]
v_mul_f32_e64 v207, v24, v207
v_mfma_f32_16x16x32_bf16 v[96:99], a[64:67], a[96:99], v[96:99]
ds_read_b128 a[120:123], v14 offset:1792
s_waitcnt lgkmcnt(1)
v_mfma_f32_16x16x32_bf16 v[96:99], a[68:71], a[100:103], v[96:99]
ds_read_b128 a[124:127], v14 offset:18176
v_mfma_f32_16x16x32_bf16 v[100:103], a[72:75], a[96:99], v[100:103]
v_mul_f32 v208, v25, v208
v_mfma_f32_16x16x32_bf16 v[100:103], a[76:79], a[100:103], v[100:103]
v_mul_f32_e64 v209, v25, v209
v_mfma_f32_16x16x32_bf16 v[104:107], a[80:83], a[96:99], v[104:107]
v_mul_f32_e64 v210, v25, v210
v_mfma_f32_16x16x32_bf16 v[104:107], a[84:87], a[100:103], v[104:107]
v_mul_f32_e64 v211, v25, v211
v_mfma_f32_16x16x32_bf16 v[108:111], a[88:91], a[96:99], v[108:111]
v_mul_f32_e64 v212, v25, v212
v_mfma_f32_16x16x32_bf16 v[108:111], a[92:95], a[100:103], v[108:111]
v_mul_f32 v213, v25, v213
s_waitcnt lgkmcnt(0) vmcnt(12)
s_barrier
v_mfma_f32_16x16x32_bf16 v[112:115], a[64:67], a[104:107], v[112:115]
ds_read_b128 a[32:35], v16 offset:16384
ds_read_b128 a[36:39], v17 offset:16384
v_mfma_f32_16x16x32_bf16 v[112:115], a[68:71], a[108:111], v[112:115]
ds_read_b128 a[96:99], v14 offset:32768
ds_read_b128 a[100:103], v14 offset:49152
v_mfma_f32_16x16x32_bf16 v[116:119], a[72:75], a[104:107], v[116:119]
s_add_u32 s45, s40, 256
ds_read_b128 a[40:43], v16 offset:18432
v_mfma_f32_16x16x32_bf16 v[116:119], a[76:79], a[108:111], v[116:119]
s_add_u32 m0, s43, 0
ds_read_b128 a[44:47], v17 offset:18432
v_mfma_f32_16x16x32_bf16 v[120:123], a[80:83], a[104:107], v[120:123]
buffer_load_dwordx4 v6, s[16:19], s45 offen offset:0 lds
ds_read_b128 a[48:51], v16 offset:20480
v_mfma_f32_16x16x32_bf16 v[120:123], a[84:87], a[108:111], v[120:123]
ds_read_b128 a[52:55], v17 offset:20480
ds_read_b128 a[56:59], v16 offset:22528
v_mfma_f32_16x16x32_bf16 v[124:127], a[88:91], a[104:107], v[124:127]
ds_read_b128 a[60:63], v17 offset:22528
v_mul_f32_e64 v214, v25, v214
v_mfma_f32_16x16x32_bf16 v[124:127], a[92:95], a[108:111], v[124:127]
v_mul_f32 v215, v25, v215
v_mul_f32 v216, v25, v216
v_mfma_f32_16x16x32_bf16 v[128:131], a[64:67], a[112:115], v[128:131]
buffer_load_dwordx4 v7, s[16:19], s45 offen offset:1024 lds
ds_read_b128 a[104:107], v14 offset:33024
v_mfma_f32_16x16x32_bf16 v[128:131], a[68:71], a[116:119], v[128:131]
ds_read_b128 a[108:111], v14 offset:49408
v_mul_f32_e64 v217, v25, v217
v_mfma_f32_16x16x32_bf16 v[132:135], a[72:75], a[112:115], v[132:135]
v_mul_f32 v218, v25, v218
v_mul_f32 v219, v25, v219
v_mfma_f32_16x16x32_bf16 v[132:135], a[76:79], a[116:119], v[132:135]
v_mul_f32 v220, v25, v220
v_mul_f32 v221, v25, v221
v_mfma_f32_16x16x32_bf16 v[136:139], a[80:83], a[112:115], v[136:139]
buffer_load_dwordx4 v8, s[16:19], s45 offen offset:2048 lds
v_mfma_f32_16x16x32_bf16 v[136:139], a[84:87], a[116:119], v[136:139]
v_mul_f32_e64 v222, v25, v222
v_mfma_f32_16x16x32_bf16 v[140:143], a[88:91], a[112:115], v[140:143]
v_mul_f32_e64 v223, v25, v223
v_mfma_f32_16x16x32_bf16 v[140:143], a[92:95], a[116:119], v[140:143]
v_mul_f32_e64 v224, v26, v224
v_mfma_f32_16x16x32_bf16 v[144:147], a[64:67], a[120:123], v[144:147]
buffer_load_dwordx4 v9, s[16:19], s45 offen offset:3072 lds
v_mfma_f32_16x16x32_bf16 v[144:147], a[68:71], a[124:127], v[144:147]
s_add_u32 s44, s38, 524288
v_mfma_f32_16x16x32_bf16 v[148:151], a[72:75], a[120:123], v[148:151]
ds_read_b128 a[112:115], v14 offset:33280
v_mfma_f32_16x16x32_bf16 v[148:151], a[76:79], a[124:127], v[148:151]
ds_read_b128 a[116:119], v14 offset:49664
v_mfma_f32_16x16x32_bf16 v[152:155], a[80:83], a[120:123], v[152:155]
s_add_u32 m0, s42, 0
v_mfma_f32_16x16x32_bf16 v[152:155], a[84:87], a[124:127], v[152:155]
buffer_load_dwordx4 v2, s[20:23], s44 offen offset:0 lds
v_mfma_f32_16x16x32_bf16 v[156:159], a[88:91], a[120:123], v[156:159]
v_mul_f32 v225, v26, v225
v_mfma_f32_16x16x32_bf16 v[156:159], a[92:95], a[124:127], v[156:159]
v_mul_f32 v226, v26, v226
s_waitcnt lgkmcnt(2)
v_mfma_f32_16x16x32_bf16 v[32:35], a[32:35], a[96:99], v[32:35]
ds_read_b128 a[120:123], v14 offset:33536
v_mfma_f32_16x16x32_bf16 v[32:35], a[36:39], a[100:103], v[32:35]
buffer_load_dwordx4 v3, s[20:23], s44 offen offset:1024 lds
v_mfma_f32_16x16x32_bf16 v[36:39], a[40:43], a[96:99], v[36:39]
ds_read_b128 a[124:127], v14 offset:49920
v_mfma_f32_16x16x32_bf16 v[36:39], a[44:47], a[100:103], v[36:39]
v_mul_f32_e64 v227, v26, v227
v_mfma_f32_16x16x32_bf16 v[40:43], a[48:51], a[96:99], v[40:43]
v_mul_f32_e64 v228, v26, v228
v_mfma_f32_16x16x32_bf16 v[40:43], a[52:55], a[100:103], v[40:43]
buffer_load_dwordx4 v2, s[20:23], s44 offen offset:2048 lds
v_mfma_f32_16x16x32_bf16 v[44:47], a[56:59], a[96:99], v[44:47]
v_mul_f32_e64 v229, v26, v229
v_mfma_f32_16x16x32_bf16 v[44:47], a[60:63], a[100:103], v[44:47]
v_mul_f32_e64 v230, v26, v230
v_mfma_f32_16x16x32_bf16 v[48:51], a[32:35], a[104:107], v[48:51]
ds_read_b128 a[96:99], v14 offset:33792
v_mfma_f32_16x16x32_bf16 v[48:51], a[36:39], a[108:111], v[48:51]
buffer_load_dwordx4 v3, s[20:23], s44 offen offset:3072 lds
v_mfma_f32_16x16x32_bf16 v[52:55], a[40:43], a[104:107], v[52:55]
s_add_u32 m0, s42, 4096
v_mfma_f32_16x16x32_bf16 v[52:55], a[44:47], a[108:111], v[52:55]
buffer_load_dwordx4 v4, s[20:23], s44 offen offset:0 lds
v_mfma_f32_16x16x32_bf16 v[56:59], a[48:51], a[104:107], v[56:59]
ds_read_b128 a[100:103], v14 offset:50176
v_mfma_f32_16x16x32_bf16 v[56:59], a[52:55], a[108:111], v[56:59]
v_mul_f32_e64 v231, v26, v231
v_mfma_f32_16x16x32_bf16 v[60:63], a[56:59], a[104:107], v[60:63]
v_mul_f32_e64 v232, v26, v232
v_mfma_f32_16x16x32_bf16 v[60:63], a[60:63], a[108:111], v[60:63]
buffer_load_dwordx4 v5, s[20:23], s44 offen offset:1024 lds
s_waitcnt lgkmcnt(1)
v_mfma_f32_16x16x32_bf16 v[64:67], a[32:35], a[112:115], v[64:67]
ds_read_b128 a[104:107], v14 offset:34048
v_mfma_f32_16x16x32_bf16 v[64:67], a[36:39], a[116:119], v[64:67]
ds_read_b128 a[108:111], v14 offset:50432
v_mfma_f32_16x16x32_bf16 v[68:71], a[40:43], a[112:115], v[68:71]
v_mul_f32 v233, v26, v233
v_mfma_f32_16x16x32_bf16 v[68:71], a[44:47], a[116:119], v[68:71]
buffer_load_dwordx4 v4, s[20:23], s44 offen offset:2048 lds
v_mfma_f32_16x16x32_bf16 v[72:75], a[48:51], a[112:115], v[72:75]
v_mul_f32_e64 v234, v26, v234
v_mfma_f32_16x16x32_bf16 v[72:75], a[52:55], a[116:119], v[72:75]
v_mul_f32_e64 v235, v26, v235
v_mfma_f32_16x16x32_bf16 v[76:79], a[56:59], a[112:115], v[76:79]
v_mul_f32_e64 v236, v26, v236
v_mfma_f32_16x16x32_bf16 v[76:79], a[60:63], a[116:119], v[76:79]
buffer_load_dwordx4 v5, s[20:23], s44 offen offset:3072 lds
v_mfma_f32_16x16x32_bf16 v[80:83], a[32:35], a[120:123], v[80:83]
ds_read_b128 a[112:115], v14 offset:34304
v_mfma_f32_16x16x32_bf16 v[80:83], a[36:39], a[124:127], v[80:83]
ds_read_b128 a[116:119], v14 offset:50688
v_mfma_f32_16x16x32_bf16 v[84:87], a[40:43], a[120:123], v[84:87]
v_mul_f32_e64 v237, v26, v237
v_mfma_f32_16x16x32_bf16 v[84:87], a[44:47], a[124:127], v[84:87]
v_mul_f32_e64 v238, v26, v238
v_mfma_f32_16x16x32_bf16 v[88:91], a[48:51], a[120:123], v[88:91]
v_mul_f32_e64 v239, v26, v239
v_mfma_f32_16x16x32_bf16 v[88:91], a[52:55], a[124:127], v[88:91]
v_mul_f32_e64 v240, v27, v240
v_mfma_f32_16x16x32_bf16 v[92:95], a[56:59], a[120:123], v[92:95]
v_mul_f32_e64 v241, v27, v241
v_mfma_f32_16x16x32_bf16 v[92:95], a[60:63], a[124:127], v[92:95]
v_mul_f32_e64 v242, v27, v242
v_mfma_f32_16x16x32_bf16 v[96:99], a[32:35], a[96:99], v[96:99]
ds_read_b128 a[120:123], v14 offset:34560
s_waitcnt lgkmcnt(1)
v_mfma_f32_16x16x32_bf16 v[96:99], a[36:39], a[100:103], v[96:99]
ds_read_b128 a[124:127], v14 offset:50944
v_mfma_f32_16x16x32_bf16 v[100:103], a[40:43], a[96:99], v[100:103]
v_mul_f32 v243, v27, v243
v_mfma_f32_16x16x32_bf16 v[100:103], a[44:47], a[100:103], v[100:103]
v_mul_f32_e64 v244, v27, v244
v_mfma_f32_16x16x32_bf16 v[104:107], a[48:51], a[96:99], v[104:107]
v_mul_f32_e64 v245, v27, v245
v_mfma_f32_16x16x32_bf16 v[104:107], a[52:55], a[100:103], v[104:107]
v_mul_f32_e64 v246, v27, v246
v_mfma_f32_16x16x32_bf16 v[108:111], a[56:59], a[96:99], v[108:111]
v_mul_f32_e64 v247, v27, v247
v_mfma_f32_16x16x32_bf16 v[108:111], a[60:63], a[100:103], v[108:111]
v_mul_f32 v248, v27, v248
s_waitcnt lgkmcnt(0) vmcnt(12)
s_barrier
v_mfma_f32_16x16x32_bf16 v[112:115], a[32:35], a[104:107], v[112:115]
ds_read_b128 a[64:67], v16 offset:32768
ds_read_b128 a[68:71], v17 offset:32768
v_mfma_f32_16x16x32_bf16 v[112:115], a[36:39], a[108:111], v[112:115]
ds_read_b128 a[96:99], v15 offset:0
ds_read_b128 a[100:103], v15 offset:16384
v_mfma_f32_16x16x32_bf16 v[116:119], a[40:43], a[104:107], v[116:119]
s_add_u32 s45, s40, 256
ds_read_b128 a[72:75], v16 offset:34816
v_mfma_f32_16x16x32_bf16 v[116:119], a[44:47], a[108:111], v[116:119]
s_add_u32 m0, s43, 16384
ds_read_b128 a[76:79], v17 offset:34816
v_mfma_f32_16x16x32_bf16 v[120:123], a[48:51], a[104:107], v[120:123]
buffer_load_dwordx4 v6, s[24:27], s45 offen offset:0 lds
ds_read_b128 a[80:83], v16 offset:36864
v_mfma_f32_16x16x32_bf16 v[120:123], a[52:55], a[108:111], v[120:123]
ds_read_b128 a[84:87], v17 offset:36864
ds_read_b128 a[88:91], v16 offset:38912
v_mfma_f32_16x16x32_bf16 v[124:127], a[56:59], a[104:107], v[124:127]
ds_read_b128 a[92:95], v17 offset:38912
v_mul_f32 v249, v27, v249
v_mfma_f32_16x16x32_bf16 v[124:127], a[60:63], a[108:111], v[124:127]
v_mul_f32 v250, v27, v250
v_mul_f32 v251, v27, v251
v_mfma_f32_16x16x32_bf16 v[128:131], a[32:35], a[112:115], v[128:131]
buffer_load_dwordx4 v7, s[24:27], s45 offen offset:1024 lds
ds_read_b128 a[104:107], v15 offset:256
v_mfma_f32_16x16x32_bf16 v[128:131], a[36:39], a[116:119], v[128:131]
ds_read_b128 a[108:111], v15 offset:16640
v_mul_f32_e64 v252, v27, v252
v_mfma_f32_16x16x32_bf16 v[132:135], a[40:43], a[112:115], v[132:135]
v_mul_f32 v253, v27, v253
v_mul_f32 v254, v27, v254
v_mfma_f32_16x16x32_bf16 v[132:135], a[44:47], a[116:119], v[132:135]
v_mul_f32_e64 v255, v27, v255
v_accvgpr_read_b32 v30, a0
v_mfma_f32_16x16x32_bf16 v[136:139], a[48:51], a[112:115], v[136:139]
buffer_load_dwordx4 v8, s[24:27], s45 offen offset:2048 lds
v_mfma_f32_16x16x32_bf16 v[136:139], a[52:55], a[116:119], v[136:139]
v_mul_f32_e64 v30, v28, v30
v_mfma_f32_16x16x32_bf16 v[140:143], a[56:59], a[112:115], v[140:143]
v_accvgpr_write_b32 a0, v30
v_mfma_f32_16x16x32_bf16 v[140:143], a[60:63], a[116:119], v[140:143]
v_accvgpr_read_b32 v30, a1
v_mfma_f32_16x16x32_bf16 v[144:147], a[32:35], a[120:123], v[144:147]
buffer_load_dwordx4 v9, s[24:27], s45 offen offset:3072 lds
v_mfma_f32_16x16x32_bf16 v[144:147], a[36:39], a[124:127], v[144:147]
s_add_u32 s44, s38, 4718592
v_mfma_f32_16x16x32_bf16 v[148:151], a[40:43], a[120:123], v[148:151]
ds_read_b128 a[112:115], v15 offset:512
v_mfma_f32_16x16x32_bf16 v[148:151], a[44:47], a[124:127], v[148:151]
ds_read_b128 a[116:119], v15 offset:16896
v_mfma_f32_16x16x32_bf16 v[152:155], a[48:51], a[120:123], v[152:155]
s_add_u32 m0, s42, 32768
v_mfma_f32_16x16x32_bf16 v[152:155], a[52:55], a[124:127], v[152:155]
buffer_load_dwordx4 v2, s[20:23], s44 offen offset:0 lds
v_mfma_f32_16x16x32_bf16 v[156:159], a[56:59], a[120:123], v[156:159]
v_mul_f32_e64 v30, v28, v30
v_mfma_f32_16x16x32_bf16 v[156:159], a[60:63], a[124:127], v[156:159]
v_accvgpr_write_b32 a1, v30
s_waitcnt lgkmcnt(2)
v_mfma_f32_16x16x32_bf16 v[32:35], a[64:67], a[96:99], v[32:35]
ds_read_b128 a[120:123], v15 offset:768
v_mfma_f32_16x16x32_bf16 v[32:35], a[68:71], a[100:103], v[32:35]
buffer_load_dwordx4 v3, s[20:23], s44 offen offset:1024 lds
v_mfma_f32_16x16x32_bf16 v[36:39], a[72:75], a[96:99], v[36:39]
ds_read_b128 a[124:127], v15 offset:17152
v_mfma_f32_16x16x32_bf16 v[36:39], a[76:79], a[100:103], v[36:39]
v_accvgpr_read_b32 v30, a2
v_mfma_f32_16x16x32_bf16 v[40:43], a[80:83], a[96:99], v[40:43]
v_mul_f32 v30, v28, v30
v_mfma_f32_16x16x32_bf16 v[40:43], a[84:87], a[100:103], v[40:43]
buffer_load_dwordx4 v2, s[20:23], s44 offen offset:2048 lds
v_mfma_f32_16x16x32_bf16 v[44:47], a[88:91], a[96:99], v[44:47]
v_accvgpr_write_b32 a2, v30
v_mfma_f32_16x16x32_bf16 v[44:47], a[92:95], a[100:103], v[44:47]
v_accvgpr_read_b32 v30, a3
v_mfma_f32_16x16x32_bf16 v[48:51], a[64:67], a[104:107], v[48:51]
ds_read_b128 a[96:99], v15 offset:1024
v_mfma_f32_16x16x32_bf16 v[48:51], a[68:71], a[108:111], v[48:51]
buffer_load_dwordx4 v3, s[20:23], s44 offen offset:3072 lds
v_mfma_f32_16x16x32_bf16 v[52:55], a[72:75], a[104:107], v[52:55]
s_add_u32 m0, s42, 36864
v_mfma_f32_16x16x32_bf16 v[52:55], a[76:79], a[108:111], v[52:55]
buffer_load_dwordx4 v4, s[20:23], s44 offen offset:0 lds
v_mfma_f32_16x16x32_bf16 v[56:59], a[80:83], a[104:107], v[56:59]
ds_read_b128 a[100:103], v15 offset:17408
v_mfma_f32_16x16x32_bf16 v[56:59], a[84:87], a[108:111], v[56:59]
v_mul_f32_e64 v30, v28, v30
v_mfma_f32_16x16x32_bf16 v[60:63], a[88:91], a[104:107], v[60:63]
v_accvgpr_write_b32 a3, v30
v_mfma_f32_16x16x32_bf16 v[60:63], a[92:95], a[108:111], v[60:63]
buffer_load_dwordx4 v5, s[20:23], s44 offen offset:1024 lds
s_waitcnt lgkmcnt(1)
v_mfma_f32_16x16x32_bf16 v[64:67], a[64:67], a[112:115], v[64:67]
ds_read_b128 a[104:107], v15 offset:1280
v_mfma_f32_16x16x32_bf16 v[64:67], a[68:71], a[116:119], v[64:67]
ds_read_b128 a[108:111], v15 offset:17664
v_mfma_f32_16x16x32_bf16 v[68:71], a[72:75], a[112:115], v[68:71]
v_accvgpr_read_b32 v30, a4
v_mfma_f32_16x16x32_bf16 v[68:71], a[76:79], a[116:119], v[68:71]
buffer_load_dwordx4 v4, s[20:23], s44 offen offset:2048 lds
v_mfma_f32_16x16x32_bf16 v[72:75], a[80:83], a[112:115], v[72:75]
v_mul_f32 v30, v28, v30
v_mfma_f32_16x16x32_bf16 v[72:75], a[84:87], a[116:119], v[72:75]
v_accvgpr_write_b32 a4, v30
v_mfma_f32_16x16x32_bf16 v[76:79], a[88:91], a[112:115], v[76:79]
v_accvgpr_read_b32 v30, a5
v_mfma_f32_16x16x32_bf16 v[76:79], a[92:95], a[116:119], v[76:79]
buffer_load_dwordx4 v5, s[20:23], s44 offen offset:3072 lds
v_mfma_f32_16x16x32_bf16 v[80:83], a[64:67], a[120:123], v[80:83]
ds_read_b128 a[112:115], v15 offset:1536
v_mfma_f32_16x16x32_bf16 v[80:83], a[68:71], a[124:127], v[80:83]
ds_read_b128 a[116:119], v15 offset:17920
v_mfma_f32_16x16x32_bf16 v[84:87], a[72:75], a[120:123], v[84:87]
v_mul_f32_e64 v30, v28, v30
v_mfma_f32_16x16x32_bf16 v[84:87], a[76:79], a[124:127], v[84:87]
v_accvgpr_write_b32 a5, v30
v_mfma_f32_16x16x32_bf16 v[88:91], a[80:83], a[120:123], v[88:91]
v_accvgpr_read_b32 v30, a6
v_mfma_f32_16x16x32_bf16 v[88:91], a[84:87], a[124:127], v[88:91]
v_mul_f32_e64 v30, v28, v30
v_mfma_f32_16x16x32_bf16 v[92:95], a[88:91], a[120:123], v[92:95]
v_accvgpr_write_b32 a6, v30
v_mfma_f32_16x16x32_bf16 v[92:95], a[92:95], a[124:127], v[92:95]
v_accvgpr_read_b32 v30, a7
v_mfma_f32_16x16x32_bf16 v[96:99], a[64:67], a[96:99], v[96:99]
ds_read_b128 a[120:123], v15 offset:1792
s_waitcnt lgkmcnt(1)
v_mfma_f32_16x16x32_bf16 v[96:99], a[68:71], a[100:103], v[96:99]
ds_read_b128 a[124:127], v15 offset:18176
v_mfma_f32_16x16x32_bf16 v[100:103], a[72:75], a[96:99], v[100:103]
v_mul_f32 v30, v28, v30
v_mfma_f32_16x16x32_bf16 v[100:103], a[76:79], a[100:103], v[100:103]
v_accvgpr_write_b32 a7, v30
v_mfma_f32_16x16x32_bf16 v[104:107], a[80:83], a[96:99], v[104:107]
v_accvgpr_read_b32 v30, a8
v_mfma_f32_16x16x32_bf16 v[104:107], a[84:87], a[100:103], v[104:107]
v_mul_f32_e64 v30, v28, v30
v_mfma_f32_16x16x32_bf16 v[108:111], a[88:91], a[96:99], v[108:111]
v_accvgpr_write_b32 a8, v30
v_mfma_f32_16x16x32_bf16 v[108:111], a[92:95], a[100:103], v[108:111]
v_accvgpr_read_b32 v30, a9
s_waitcnt lgkmcnt(0) vmcnt(12)
s_barrier
v_mfma_f32_16x16x32_bf16 v[112:115], a[64:67], a[104:107], v[112:115]
ds_read_b128 a[32:35], v16 offset:0
ds_read_b128 a[36:39], v17 offset:0
v_mfma_f32_16x16x32_bf16 v[112:115], a[68:71], a[108:111], v[112:115]
ds_read_b128 a[96:99], v14 offset:0
ds_read_b128 a[100:103], v14 offset:16384
v_mfma_f32_16x16x32_bf16 v[116:119], a[72:75], a[104:107], v[116:119]
s_add_u32 s45, s40, 384
ds_read_b128 a[40:43], v16 offset:2048
v_mfma_f32_16x16x32_bf16 v[116:119], a[76:79], a[108:111], v[116:119]
s_add_u32 m0, s43, 32768
ds_read_b128 a[44:47], v17 offset:2048
v_mfma_f32_16x16x32_bf16 v[120:123], a[80:83], a[104:107], v[120:123]
buffer_load_dwordx4 v6, s[16:19], s45 offen offset:0 lds
ds_read_b128 a[48:51], v16 offset:4096
v_mfma_f32_16x16x32_bf16 v[120:123], a[84:87], a[108:111], v[120:123]
ds_read_b128 a[52:55], v17 offset:4096
ds_read_b128 a[56:59], v16 offset:6144
v_mfma_f32_16x16x32_bf16 v[124:127], a[88:91], a[104:107], v[124:127]
ds_read_b128 a[60:63], v17 offset:6144
v_mul_f32_e64 v30, v28, v30
v_mfma_f32_16x16x32_bf16 v[124:127], a[92:95], a[108:111], v[124:127]
v_accvgpr_write_b32 a9, v30
v_accvgpr_read_b32 v30, a10
v_mfma_f32_16x16x32_bf16 v[128:131], a[64:67], a[112:115], v[128:131]
buffer_load_dwordx4 v7, s[16:19], s45 offen offset:1024 lds
ds_read_b128 a[104:107], v14 offset:256
v_mfma_f32_16x16x32_bf16 v[128:131], a[68:71], a[116:119], v[128:131]
ds_read_b128 a[108:111], v14 offset:16640
v_mul_f32_e64 v30, v28, v30
v_mfma_f32_16x16x32_bf16 v[132:135], a[72:75], a[112:115], v[132:135]
v_accvgpr_write_b32 a10, v30
v_accvgpr_read_b32 v30, a11
v_mfma_f32_16x16x32_bf16 v[132:135], a[76:79], a[116:119], v[132:135]
v_mul_f32_e64 v30, v28, v30
v_accvgpr_write_b32 a11, v30
v_mfma_f32_16x16x32_bf16 v[136:139], a[80:83], a[112:115], v[136:139]
buffer_load_dwordx4 v8, s[16:19], s45 offen offset:2048 lds
v_mfma_f32_16x16x32_bf16 v[136:139], a[84:87], a[116:119], v[136:139]
v_accvgpr_read_b32 v30, a12
v_mfma_f32_16x16x32_bf16 v[140:143], a[88:91], a[112:115], v[140:143]
v_mul_f32_e64 v30, v28, v30
v_mfma_f32_16x16x32_bf16 v[140:143], a[92:95], a[116:119], v[140:143]
v_accvgpr_write_b32 a12, v30
v_mfma_f32_16x16x32_bf16 v[144:147], a[64:67], a[120:123], v[144:147]
buffer_load_dwordx4 v9, s[16:19], s45 offen offset:3072 lds
v_mfma_f32_16x16x32_bf16 v[144:147], a[68:71], a[124:127], v[144:147]
s_add_u32 s44, s38, 786432
v_mfma_f32_16x16x32_bf16 v[148:151], a[72:75], a[120:123], v[148:151]
ds_read_b128 a[112:115], v14 offset:512
v_mfma_f32_16x16x32_bf16 v[148:151], a[76:79], a[124:127], v[148:151]
ds_read_b128 a[116:119], v14 offset:16896
v_mfma_f32_16x16x32_bf16 v[152:155], a[80:83], a[120:123], v[152:155]
s_add_u32 m0, s42, 65536
v_mfma_f32_16x16x32_bf16 v[152:155], a[84:87], a[124:127], v[152:155]
buffer_load_dwordx4 v2, s[20:23], s44 offen offset:0 lds
v_mfma_f32_16x16x32_bf16 v[156:159], a[88:91], a[120:123], v[156:159]
v_accvgpr_read_b32 v30, a13
v_mfma_f32_16x16x32_bf16 v[156:159], a[92:95], a[124:127], v[156:159]
v_mul_f32 v30, v28, v30
s_waitcnt lgkmcnt(2)
v_mfma_f32_16x16x32_bf16 v[32:35], a[32:35], a[96:99], v[32:35]
ds_read_b128 a[120:123], v14 offset:768
v_mfma_f32_16x16x32_bf16 v[32:35], a[36:39], a[100:103], v[32:35]
buffer_load_dwordx4 v3, s[20:23], s44 offen offset:1024 lds
v_mfma_f32_16x16x32_bf16 v[36:39], a[40:43], a[96:99], v[36:39]
ds_read_b128 a[124:127], v14 offset:17152
v_mfma_f32_16x16x32_bf16 v[36:39], a[44:47], a[100:103], v[36:39]
v_accvgpr_write_b32 a13, v30
v_mfma_f32_16x16x32_bf16 v[40:43], a[48:51], a[96:99], v[40:43]
v_accvgpr_read_b32 v30, a14
v_mfma_f32_16x16x32_bf16 v[40:43], a[52:55], a[100:103], v[40:43]
buffer_load_dwordx4 v2, s[20:23], s44 offen offset:2048 lds
v_mfma_f32_16x16x32_bf16 v[44:47], a[56:59], a[96:99], v[44:47]
v_mul_f32_e64 v30, v28, v30
v_mfma_f32_16x16x32_bf16 v[44:47], a[60:63], a[100:103], v[44:47]
v_accvgpr_write_b32 a14, v30
v_mfma_f32_16x16x32_bf16 v[48:51], a[32:35], a[104:107], v[48:51]
ds_read_b128 a[96:99], v14 offset:1024
v_mfma_f32_16x16x32_bf16 v[48:51], a[36:39], a[108:111], v[48:51]
buffer_load_dwordx4 v3, s[20:23], s44 offen offset:3072 lds
v_mfma_f32_16x16x32_bf16 v[52:55], a[40:43], a[104:107], v[52:55]
s_add_u32 m0, s42, 69632
v_mfma_f32_16x16x32_bf16 v[52:55], a[44:47], a[108:111], v[52:55]
buffer_load_dwordx4 v4, s[20:23], s44 offen offset:0 lds
v_mfma_f32_16x16x32_bf16 v[56:59], a[48:51], a[104:107], v[56:59]
ds_read_b128 a[100:103], v14 offset:17408
v_mfma_f32_16x16x32_bf16 v[56:59], a[52:55], a[108:111], v[56:59]
v_accvgpr_read_b32 v30, a15
v_mfma_f32_16x16x32_bf16 v[60:63], a[56:59], a[104:107], v[60:63]
v_mul_f32_e64 v30, v28, v30
v_mfma_f32_16x16x32_bf16 v[60:63], a[60:63], a[108:111], v[60:63]
buffer_load_dwordx4 v5, s[20:23], s44 offen offset:1024 lds
s_waitcnt lgkmcnt(1)
v_mfma_f32_16x16x32_bf16 v[64:67], a[32:35], a[112:115], v[64:67]
ds_read_b128 a[104:107], v14 offset:1280
v_mfma_f32_16x16x32_bf16 v[64:67], a[36:39], a[116:119], v[64:67]
ds_read_b128 a[108:111], v14 offset:17664
v_mfma_f32_16x16x32_bf16 v[68:71], a[40:43], a[112:115], v[68:71]
v_accvgpr_write_b32 a15, v30
v_mfma_f32_16x16x32_bf16 v[68:71], a[44:47], a[116:119], v[68:71]
buffer_load_dwordx4 v4, s[20:23], s44 offen offset:2048 lds
v_mfma_f32_16x16x32_bf16 v[72:75], a[48:51], a[112:115], v[72:75]
v_accvgpr_read_b32 v30, a16
v_mfma_f32_16x16x32_bf16 v[72:75], a[52:55], a[116:119], v[72:75]
v_mul_f32 v30, v29, v30
v_mfma_f32_16x16x32_bf16 v[76:79], a[56:59], a[112:115], v[76:79]
v_accvgpr_write_b32 a16, v30
v_mfma_f32_16x16x32_bf16 v[76:79], a[60:63], a[116:119], v[76:79]
buffer_load_dwordx4 v5, s[20:23], s44 offen offset:3072 lds
v_mfma_f32_16x16x32_bf16 v[80:83], a[32:35], a[120:123], v[80:83]
ds_read_b128 a[112:115], v14 offset:1536
v_mfma_f32_16x16x32_bf16 v[80:83], a[36:39], a[124:127], v[80:83]
ds_read_b128 a[116:119], v14 offset:17920
v_mfma_f32_16x16x32_bf16 v[84:87], a[40:43], a[120:123], v[84:87]
v_accvgpr_read_b32 v30, a17
v_mfma_f32_16x16x32_bf16 v[84:87], a[44:47], a[124:127], v[84:87]
v_mul_f32_e64 v30, v29, v30
v_mfma_f32_16x16x32_bf16 v[88:91], a[48:51], a[120:123], v[88:91]
v_accvgpr_write_b32 a17, v30
v_mfma_f32_16x16x32_bf16 v[88:91], a[52:55], a[124:127], v[88:91]
v_accvgpr_read_b32 v30, a18
v_mfma_f32_16x16x32_bf16 v[92:95], a[56:59], a[120:123], v[92:95]
v_mul_f32_e64 v30, v29, v30
v_mfma_f32_16x16x32_bf16 v[92:95], a[60:63], a[124:127], v[92:95]
v_accvgpr_write_b32 a18, v30
v_mfma_f32_16x16x32_bf16 v[96:99], a[32:35], a[96:99], v[96:99]
ds_read_b128 a[120:123], v14 offset:1792
s_waitcnt lgkmcnt(1)
v_mfma_f32_16x16x32_bf16 v[96:99], a[36:39], a[100:103], v[96:99]
ds_read_b128 a[124:127], v14 offset:18176
v_mfma_f32_16x16x32_bf16 v[100:103], a[40:43], a[96:99], v[100:103]
v_accvgpr_read_b32 v30, a19
v_mfma_f32_16x16x32_bf16 v[100:103], a[44:47], a[100:103], v[100:103]
v_mul_f32 v30, v29, v30
v_mfma_f32_16x16x32_bf16 v[104:107], a[48:51], a[96:99], v[104:107]
v_accvgpr_write_b32 a19, v30
v_mfma_f32_16x16x32_bf16 v[104:107], a[52:55], a[100:103], v[104:107]
v_accvgpr_read_b32 v30, a20
v_mfma_f32_16x16x32_bf16 v[108:111], a[56:59], a[96:99], v[108:111]
v_mul_f32_e64 v30, v29, v30
v_mfma_f32_16x16x32_bf16 v[108:111], a[60:63], a[100:103], v[108:111]
v_accvgpr_write_b32 a20, v30
s_waitcnt lgkmcnt(0) vmcnt(12)
s_barrier
v_mfma_f32_16x16x32_bf16 v[112:115], a[32:35], a[104:107], v[112:115]
s_add_u32 s45, s40, 384
ds_read_b128 a[64:67], v16 offset:16384
v_mfma_f32_16x16x32_bf16 v[112:115], a[36:39], a[108:111], v[112:115]
s_add_u32 m0, s43, 0
ds_read_b128 a[68:71], v17 offset:16384
v_mfma_f32_16x16x32_bf16 v[116:119], a[40:43], a[104:107], v[116:119]
buffer_load_dwordx4 v6, s[24:27], s45 offen offset:0 lds
ds_read_b128 a[96:99], v14 offset:32768
v_mfma_f32_16x16x32_bf16 v[116:119], a[44:47], a[108:111], v[116:119]
ds_read_b128 a[100:103], v14 offset:49152
ds_read_b128 a[72:75], v16 offset:18432
v_mfma_f32_16x16x32_bf16 v[120:123], a[48:51], a[104:107], v[120:123]
ds_read_b128 a[76:79], v17 offset:18432
ds_read_b128 a[80:83], v16 offset:20480
v_mfma_f32_16x16x32_bf16 v[120:123], a[52:55], a[108:111], v[120:123]
ds_read_b128 a[84:87], v17 offset:20480
ds_read_b128 a[88:91], v16 offset:22528
v_mfma_f32_16x16x32_bf16 v[124:127], a[56:59], a[104:107], v[124:127]
buffer_load_dwordx4 v7, s[24:27], s45 offen offset:1024 lds
ds_read_b128 a[92:95], v17 offset:22528
v_mfma_f32_16x16x32_bf16 v[124:127], a[60:63], a[108:111], v[124:127]
v_accvgpr_read_b32 v30, a21
v_mul_f32 v30, v29, v30
v_mfma_f32_16x16x32_bf16 v[128:131], a[32:35], a[112:115], v[128:131]
ds_read_b128 a[104:107], v14 offset:33024
ds_read_b128 a[108:111], v14 offset:49408
v_mfma_f32_16x16x32_bf16 v[128:131], a[36:39], a[116:119], v[128:131]
v_accvgpr_write_b32 a21, v30
v_accvgpr_read_b32 v30, a22
v_mfma_f32_16x16x32_bf16 v[132:135], a[40:43], a[112:115], v[132:135]
buffer_load_dwordx4 v8, s[24:27], s45 offen offset:2048 lds
v_mfma_f32_16x16x32_bf16 v[132:135], a[44:47], a[116:119], v[132:135]
v_mul_f32_e64 v30, v29, v30
v_mfma_f32_16x16x32_bf16 v[136:139], a[48:51], a[112:115], v[136:139]
v_accvgpr_write_b32 a22, v30
v_mfma_f32_16x16x32_bf16 v[136:139], a[52:55], a[116:119], v[136:139]
v_accvgpr_read_b32 v30, a23
v_mfma_f32_16x16x32_bf16 v[140:143], a[56:59], a[112:115], v[140:143]
buffer_load_dwordx4 v9, s[24:27], s45 offen offset:3072 lds
v_mfma_f32_16x16x32_bf16 v[140:143], a[60:63], a[116:119], v[140:143]
s_add_u32 s44, s38, 4980736
v_mfma_f32_16x16x32_bf16 v[144:147], a[32:35], a[120:123], v[144:147]
s_add_u32 m0, s42, 0
v_mfma_f32_16x16x32_bf16 v[144:147], a[36:39], a[124:127], v[144:147]
buffer_load_dwordx4 v2, s[20:23], s44 offen offset:0 lds
v_mfma_f32_16x16x32_bf16 v[148:151], a[40:43], a[120:123], v[148:151]
ds_read_b128 a[112:115], v14 offset:33280
v_mfma_f32_16x16x32_bf16 v[148:151], a[44:47], a[124:127], v[148:151]
ds_read_b128 a[116:119], v14 offset:49664
v_mfma_f32_16x16x32_bf16 v[152:155], a[48:51], a[120:123], v[152:155]
v_mul_f32 v30, v29, v30
v_mfma_f32_16x16x32_bf16 v[152:155], a[52:55], a[124:127], v[152:155]
buffer_load_dwordx4 v3, s[20:23], s44 offen offset:1024 lds
v_mfma_f32_16x16x32_bf16 v[156:159], a[56:59], a[120:123], v[156:159]
v_accvgpr_write_b32 a23, v30
v_mfma_f32_16x16x32_bf16 v[156:159], a[60:63], a[124:127], v[156:159]
v_accvgpr_read_b32 v30, a24
s_waitcnt lgkmcnt(2)
v_mfma_f32_16x16x32_bf16 v[32:35], a[64:67], a[96:99], v[32:35]
ds_read_b128 a[120:123], v14 offset:33536
v_mfma_f32_16x16x32_bf16 v[32:35], a[68:71], a[100:103], v[32:35]
buffer_load_dwordx4 v2, s[20:23], s44 offen offset:2048 lds
v_mfma_f32_16x16x32_bf16 v[36:39], a[72:75], a[96:99], v[36:39]
ds_read_b128 a[124:127], v14 offset:49920
v_mfma_f32_16x16x32_bf16 v[36:39], a[76:79], a[100:103], v[36:39]
v_mul_f32 v30, v29, v30
v_mfma_f32_16x16x32_bf16 v[40:43], a[80:83], a[96:99], v[40:43]
v_accvgpr_write_b32 a24, v30
v_mfma_f32_16x16x32_bf16 v[40:43], a[84:87], a[100:103], v[40:43]
buffer_load_dwordx4 v3, s[20:23], s44 offen offset:3072 lds
v_mfma_f32_16x16x32_bf16 v[44:47], a[88:91], a[96:99], v[44:47]
s_add_u32 m0, s42, 4096
v_mfma_f32_16x16x32_bf16 v[44:47], a[92:95], a[100:103], v[44:47]
buffer_load_dwordx4 v4, s[20:23], s44 offen offset:0 lds
v_mfma_f32_16x16x32_bf16 v[48:51], a[64:67], a[104:107], v[48:51]
ds_read_b128 a[96:99], v14 offset:33792
v_mfma_f32_16x16x32_bf16 v[48:51], a[68:71], a[108:111], v[48:51]
ds_read_b128 a[100:103], v14 offset:50176
v_mfma_f32_16x16x32_bf16 v[52:55], a[72:75], a[104:107], v[52:55]
v_accvgpr_read_b32 v30, a25
v_mfma_f32_16x16x32_bf16 v[52:55], a[76:79], a[108:111], v[52:55]
buffer_load_dwordx4 v5, s[20:23], s44 offen offset:1024 lds
v_mfma_f32_16x16x32_bf16 v[56:59], a[80:83], a[104:107], v[56:59]
v_mul_f32_e64 v30, v29, v30
v_mfma_f32_16x16x32_bf16 v[56:59], a[84:87], a[108:111], v[56:59]
v_accvgpr_write_b32 a25, v30
v_mfma_f32_16x16x32_bf16 v[60:63], a[88:91], a[104:107], v[60:63]
v_accvgpr_read_b32 v30, a26
v_mfma_f32_16x16x32_bf16 v[60:63], a[92:95], a[108:111], v[60:63]
buffer_load_dwordx4 v4, s[20:23], s44 offen offset:2048 lds
s_waitcnt lgkmcnt(0)
v_mfma_f32_16x16x32_bf16 v[64:67], a[64:67], a[112:115], v[64:67]
ds_read_b128 a[104:107], v14 offset:34048
v_mfma_f32_16x16x32_bf16 v[64:67], a[68:71], a[116:119], v[64:67]
ds_read_b128 a[108:111], v14 offset:50432
v_mfma_f32_16x16x32_bf16 v[68:71], a[72:75], a[112:115], v[68:71]
v_mul_f32 v30, v29, v30
v_mfma_f32_16x16x32_bf16 v[68:71], a[76:79], a[116:119], v[68:71]
buffer_load_dwordx4 v5, s[20:23], s44 offen offset:3072 lds
v_mfma_f32_16x16x32_bf16 v[72:75], a[80:83], a[112:115], v[72:75]
v_accvgpr_write_b32 a26, v30
v_mfma_f32_16x16x32_bf16 v[72:75], a[84:87], a[116:119], v[72:75]
v_accvgpr_read_b32 v30, a27
v_mfma_f32_16x16x32_bf16 v[76:79], a[88:91], a[112:115], v[76:79]
v_mul_f32_e64 v30, v29, v30
v_mfma_f32_16x16x32_bf16 v[76:79], a[92:95], a[116:119], v[76:79]
v_accvgpr_write_b32 a27, v30
v_mfma_f32_16x16x32_bf16 v[80:83], a[64:67], a[120:123], v[80:83]
ds_read_b128 a[112:115], v14 offset:34304
v_mfma_f32_16x16x32_bf16 v[80:83], a[68:71], a[124:127], v[80:83]
ds_read_b128 a[116:119], v14 offset:50688
v_mfma_f32_16x16x32_bf16 v[84:87], a[72:75], a[120:123], v[84:87]
v_accvgpr_read_b32 v30, a28
v_mfma_f32_16x16x32_bf16 v[84:87], a[76:79], a[124:127], v[84:87]
v_mul_f32_e64 v30, v29, v30
v_mfma_f32_16x16x32_bf16 v[88:91], a[80:83], a[120:123], v[88:91]
v_accvgpr_write_b32 a28, v30
v_mfma_f32_16x16x32_bf16 v[88:91], a[84:87], a[124:127], v[88:91]
v_accvgpr_read_b32 v30, a29
v_mfma_f32_16x16x32_bf16 v[92:95], a[88:91], a[120:123], v[92:95]
v_mul_f32_e64 v30, v29, v30
v_mfma_f32_16x16x32_bf16 v[92:95], a[92:95], a[124:127], v[92:95]
v_accvgpr_write_b32 a29, v30
v_mfma_f32_16x16x32_bf16 v[96:99], a[64:67], a[96:99], v[96:99]
ds_read_b128 a[120:123], v14 offset:34560
v_mfma_f32_16x16x32_bf16 v[96:99], a[68:71], a[100:103], v[96:99]
ds_read_b128 a[124:127], v14 offset:50944
v_mfma_f32_16x16x32_bf16 v[100:103], a[72:75], a[96:99], v[100:103]
v_accvgpr_read_b32 v30, a30
v_mfma_f32_16x16x32_bf16 v[100:103], a[76:79], a[100:103], v[100:103]
v_mul_f32_e64 v30, v29, v30
v_mfma_f32_16x16x32_bf16 v[104:107], a[80:83], a[96:99], v[104:107]
v_accvgpr_write_b32 a30, v30
v_mfma_f32_16x16x32_bf16 v[104:107], a[84:87], a[100:103], v[104:107]
v_accvgpr_read_b32 v30, a31
v_mfma_f32_16x16x32_bf16 v[108:111], a[88:91], a[96:99], v[108:111]
v_mul_f32_e64 v30, v29, v30
v_mfma_f32_16x16x32_bf16 v[108:111], a[92:95], a[100:103], v[108:111]
v_accvgpr_write_b32 a31, v30
s_waitcnt lgkmcnt(0) vmcnt(12)
s_barrier
v_mfma_f32_16x16x32_bf16 v[112:115], a[64:67], a[104:107], v[112:115]
ds_read_b128 a[32:35], v16 offset:32768
ds_read_b128 a[36:39], v17 offset:32768
v_mfma_f32_16x16x32_bf16 v[112:115], a[68:71], a[108:111], v[112:115]
ds_read_b128 a[96:99], v15 offset:0
ds_read_b128 a[100:103], v15 offset:16384
v_mfma_f32_16x16x32_bf16 v[116:119], a[72:75], a[104:107], v[116:119]
ds_read_b128 a[40:43], v16 offset:34816
ds_read_b128 a[44:47], v17 offset:34816
v_mfma_f32_16x16x32_bf16 v[116:119], a[76:79], a[108:111], v[116:119]
ds_read_b128 a[48:51], v16 offset:36864
ds_read_b128 a[52:55], v17 offset:36864
v_mfma_f32_16x16x32_bf16 v[120:123], a[80:83], a[104:107], v[120:123]
ds_read_b128 a[56:59], v16 offset:38912
ds_read_b128 a[60:63], v17 offset:38912
v_mfma_f32_16x16x32_bf16 v[120:123], a[84:87], a[108:111], v[120:123]
v_accvgpr_read_b32 v29, a168
v_accvgpr_read_b32 v13, a169
v_mfma_f32_16x16x32_bf16 v[124:127], a[88:91], a[104:107], v[124:127]
v_lshlrev_b32_e64 v11, 1, v29
v_add_u32 v12, 0x1000, v11
v_mfma_f32_16x16x32_bf16 v[124:127], a[92:95], a[108:111], v[124:127]
v_lshlrev_b32 v13, 1, v13
v_lshlrev_b32 v29, 2, v29
v_mfma_f32_16x16x32_bf16 v[128:131], a[64:67], a[112:115], v[128:131]
ds_read_b128 a[104:107], v15 offset:256
ds_read_b128 a[108:111], v15 offset:16640
v_mfma_f32_16x16x32_bf16 v[128:131], a[68:71], a[116:119], v[128:131]
v_accvgpr_read_b32 v2, a128
v_lshlrev_b32_e64 v2, 16, v2
v_mfma_f32_16x16x32_bf16 v[132:135], a[72:75], a[112:115], v[132:135]
v_accvgpr_read_b32 v3, a130
v_lshlrev_b32_e64 v3, 16, v3
v_mfma_f32_16x16x32_bf16 v[132:135], a[76:79], a[116:119], v[132:135]
v_accvgpr_read_b32 v4, a132
v_lshlrev_b32_e64 v4, 16, v4
v_mfma_f32_16x16x32_bf16 v[136:139], a[80:83], a[112:115], v[136:139]
v_accvgpr_read_b32 v5, a134
v_lshlrev_b32_e64 v5, 16, v5
v_mfma_f32_16x16x32_bf16 v[136:139], a[84:87], a[116:119], v[136:139]
v_accvgpr_read_b32 v6, a136
v_lshlrev_b32_e64 v6, 16, v6
v_mfma_f32_16x16x32_bf16 v[140:143], a[88:91], a[112:115], v[140:143]
v_accvgpr_read_b32 v7, a138
v_lshlrev_b32_e64 v7, 16, v7
v_mfma_f32_16x16x32_bf16 v[140:143], a[92:95], a[116:119], v[140:143]
v_accvgpr_read_b32 v8, a140
v_lshlrev_b32_e64 v8, 16, v8
v_mfma_f32_16x16x32_bf16 v[144:147], a[64:67], a[120:123], v[144:147]
v_accvgpr_read_b32 v9, a142
v_lshlrev_b32_e64 v9, 16, v9
v_mfma_f32_16x16x32_bf16 v[144:147], a[68:71], a[124:127], v[144:147]
v_lshlrev_b32_e64 v10, 4, v0
v_mfma_f32_16x16x32_bf16 v[148:151], a[72:75], a[120:123], v[148:151]
v_mfma_f32_16x16x32_bf16 v[148:151], a[76:79], a[124:127], v[148:151]
v_mfma_f32_16x16x32_bf16 v[152:155], a[80:83], a[120:123], v[152:155]
s_waitcnt vmcnt(0)
s_barrier
v_mfma_f32_16x16x32_bf16 v[152:155], a[84:87], a[124:127], v[152:155]
buffer_load_dwordx2 a[144:145], v11, s[8:11], 0 offen offset:0
ds_read_b128 a[112:115], v14 offset:0
v_mfma_f32_16x16x32_bf16 v[156:159], a[88:91], a[120:123], v[156:159]
ds_read_b128 a[116:119], v14 offset:16384
v_mfma_f32_16x16x32_bf16 v[156:159], a[92:95], a[124:127], v[156:159]
buffer_load_dwordx2 a[146:147], v11, s[8:11], 0 offen offset:32
s_waitcnt lgkmcnt(2)
v_mfma_f32_16x16x32_bf16 v[32:35], a[32:35], a[96:99], v[32:35]
ds_read_b128 a[64:67], v16 offset:0
ds_read_b128 a[68:71], v17 offset:0
v_mfma_f32_16x16x32_bf16 v[32:35], a[36:39], a[100:103], v[32:35]
ds_read_b128 a[72:75], v16 offset:2048
ds_read_b128 a[76:79], v17 offset:2048
v_mfma_f32_16x16x32_bf16 v[36:39], a[40:43], a[96:99], v[36:39]
buffer_load_dwordx2 a[148:149], v11, s[8:11], 0 offen offset:64
ds_read_b128 a[80:83], v16 offset:4096
v_mfma_f32_16x16x32_bf16 v[36:39], a[44:47], a[100:103], v[36:39]
ds_read_b128 a[84:87], v17 offset:4096
ds_read_b128 a[88:91], v16 offset:6144
v_mfma_f32_16x16x32_bf16 v[40:43], a[48:51], a[96:99], v[40:43]
buffer_load_dwordx2 a[150:151], v11, s[8:11], 0 offen offset:96
ds_read_b128 a[92:95], v17 offset:6144
v_mfma_f32_16x16x32_bf16 v[40:43], a[52:55], a[100:103], v[40:43]
ds_read_b128 a[120:123], v14 offset:256
ds_read_b128 a[124:127], v14 offset:16640
v_mfma_f32_16x16x32_bf16 v[44:47], a[56:59], a[96:99], v[44:47]
buffer_load_dwordx2 a[152:153], v12, s[8:11], 0 offen offset:0
v_mfma_f32_16x16x32_bf16 v[44:47], a[60:63], a[100:103], v[44:47]
v_mfma_f32_16x16x32_bf16 v[48:51], a[32:35], a[104:107], v[48:51]
buffer_load_dwordx2 a[154:155], v12, s[8:11], 0 offen offset:32
ds_read_b128 a[96:99], v15 offset:512
v_mfma_f32_16x16x32_bf16 v[48:51], a[36:39], a[108:111], v[48:51]
ds_read_b128 a[100:103], v15 offset:16896
v_mfma_f32_16x16x32_bf16 v[52:55], a[40:43], a[104:107], v[52:55]
buffer_load_dwordx2 a[156:157], v12, s[8:11], 0 offen offset:64
v_mfma_f32_16x16x32_bf16 v[52:55], a[44:47], a[108:111], v[52:55]
v_mfma_f32_16x16x32_bf16 v[56:59], a[48:51], a[104:107], v[56:59]
buffer_load_dwordx2 a[158:159], v12, s[8:11], 0 offen offset:96
v_mfma_f32_16x16x32_bf16 v[56:59], a[52:55], a[108:111], v[56:59]
v_mfma_f32_16x16x32_bf16 v[60:63], a[56:59], a[104:107], v[60:63]
global_load_dwordx2 a[160:161], v13, s[80:81] offset:0
v_mfma_f32_16x16x32_bf16 v[60:63], a[60:63], a[108:111], v[60:63]
s_waitcnt lgkmcnt(0)
v_mfma_f32_16x16x32_bf16 v[32:35], a[64:67], a[112:115], v[32:35]
global_load_dwordx2 a[162:163], v13, s[80:81] offset:32
ds_read_b128 a[104:107], v15 offset:768
v_mfma_f32_16x16x32_bf16 v[32:35], a[68:71], a[116:119], v[32:35]
ds_read_b128 a[108:111], v15 offset:17152
v_mfma_f32_16x16x32_bf16 v[36:39], a[72:75], a[112:115], v[36:39]
global_load_dwordx2 a[164:165], v13, s[80:81] offset:64
v_mfma_f32_16x16x32_bf16 v[36:39], a[76:79], a[116:119], v[36:39]
v_mfma_f32_16x16x32_bf16 v[40:43], a[80:83], a[112:115], v[40:43]
global_load_dwordx2 a[166:167], v13, s[80:81] offset:96
v_mfma_f32_16x16x32_bf16 v[40:43], a[84:87], a[116:119], v[40:43]
v_mfma_f32_16x16x32_bf16 v[44:47], a[88:91], a[112:115], v[44:47]
v_fma_f32 v32, v32, v2, v160
v_fma_f32 v33, v33, v2, v161
v_mfma_f32_16x16x32_bf16 v[44:47], a[92:95], a[116:119], v[44:47]
v_fma_f32 v34, v34, v2, v162
v_fma_f32 v35, v35, v2, v163
v_mfma_f32_16x16x32_bf16 v[48:51], a[64:67], a[120:123], v[48:51]
v_fma_f32 v36, v36, v2, v164
v_fma_f32 v37, v37, v2, v165
v_mfma_f32_16x16x32_bf16 v[48:51], a[68:71], a[124:127], v[48:51]
v_fma_f32 v38, v38, v2, v166
v_fma_f32 v39, v39, v2, v167
v_mfma_f32_16x16x32_bf16 v[52:55], a[72:75], a[120:123], v[52:55]
v_cvt_pk_bf16_f32 v160, v32, v33
v_cvt_pk_bf16_f32 v161, v34, v35
v_mfma_f32_16x16x32_bf16 v[52:55], a[76:79], a[124:127], v[52:55]
v_cvt_pk_bf16_f32 v162, v36, v37
v_cvt_pk_bf16_f32 v163, v38, v39
v_mfma_f32_16x16x32_bf16 v[56:59], a[80:83], a[120:123], v[56:59]
buffer_store_dwordx4 v[160:163], v10, s[20:23], s50 offen offset:0 sc1
ds_read_b128 a[112:115], v14 offset:512
v_mfma_f32_16x16x32_bf16 v[56:59], a[84:87], a[124:127], v[56:59]
ds_read_b128 a[116:119], v14 offset:16896
v_fma_f32 v40, v40, v2, v168
v_mfma_f32_16x16x32_bf16 v[60:63], a[88:91], a[120:123], v[60:63]
v_fma_f32 v41, v41, v2, v169
v_fma_f32 v42, v42, v2, v170
v_mfma_f32_16x16x32_bf16 v[60:63], a[92:95], a[124:127], v[60:63]
v_fma_f32 v43, v43, v2, v171
v_fma_f32 v44, v44, v2, v172
v_mfma_f32_16x16x32_bf16 v[64:67], a[32:35], a[96:99], v[64:67]
v_fma_f32 v45, v45, v2, v173
v_fma_f32 v46, v46, v2, v174
v_mfma_f32_16x16x32_bf16 v[64:67], a[36:39], a[100:103], v[64:67]
v_fma_f32 v47, v47, v2, v175
v_cvt_pk_bf16_f32 v168, v40, v41
v_mfma_f32_16x16x32_bf16 v[68:71], a[40:43], a[96:99], v[68:71]
v_cvt_pk_bf16_f32 v169, v42, v43
v_cvt_pk_bf16_f32 v170, v44, v45
v_mfma_f32_16x16x32_bf16 v[68:71], a[44:47], a[100:103], v[68:71]
v_cvt_pk_bf16_f32 v171, v46, v47
buffer_store_dwordx4 v[168:171], v10, s[20:23], s50 offen offset:1024 sc1
v_mfma_f32_16x16x32_bf16 v[72:75], a[48:51], a[96:99], v[72:75]
v_fma_f32 v48, v48, v3, v176
v_fma_f32 v49, v49, v3, v177
v_mfma_f32_16x16x32_bf16 v[72:75], a[52:55], a[100:103], v[72:75]
v_fma_f32 v50, v50, v3, v178
v_fma_f32 v51, v51, v3, v179
v_mfma_f32_16x16x32_bf16 v[76:79], a[56:59], a[96:99], v[76:79]
v_fma_f32 v52, v52, v3, v180
v_fma_f32 v53, v53, v3, v181
v_mfma_f32_16x16x32_bf16 v[76:79], a[60:63], a[100:103], v[76:79]
v_fma_f32 v54, v54, v3, v182
s_waitcnt lgkmcnt(0)
v_mfma_f32_16x16x32_bf16 v[80:83], a[32:35], a[104:107], v[80:83]
v_fma_f32 v55, v55, v3, v183
v_cvt_pk_bf16_f32 v176, v48, v49
v_mfma_f32_16x16x32_bf16 v[80:83], a[36:39], a[108:111], v[80:83]
v_cvt_pk_bf16_f32 v177, v50, v51
v_cvt_pk_bf16_f32 v178, v52, v53
v_mfma_f32_16x16x32_bf16 v[84:87], a[40:43], a[104:107], v[84:87]
v_cvt_pk_bf16_f32 v179, v54, v55
buffer_store_dwordx4 v[176:179], v10, s[20:23], s50 offen offset:2048 sc1
v_mfma_f32_16x16x32_bf16 v[84:87], a[44:47], a[108:111], v[84:87]
ds_read_b128 a[120:123], v14 offset:768
ds_read_b128 a[124:127], v14 offset:17152
v_mfma_f32_16x16x32_bf16 v[88:91], a[48:51], a[104:107], v[88:91]
v_fma_f32 v56, v56, v3, v184
v_fma_f32 v57, v57, v3, v185
v_mfma_f32_16x16x32_bf16 v[88:91], a[52:55], a[108:111], v[88:91]
v_fma_f32 v58, v58, v3, v186
v_fma_f32 v59, v59, v3, v187
v_mfma_f32_16x16x32_bf16 v[92:95], a[56:59], a[104:107], v[92:95]
v_fma_f32 v60, v60, v3, v188
v_fma_f32 v61, v61, v3, v189
v_mfma_f32_16x16x32_bf16 v[92:95], a[60:63], a[108:111], v[92:95]
v_fma_f32 v62, v62, v3, v190
v_fma_f32 v63, v63, v3, v191
v_mfma_f32_16x16x32_bf16 v[64:67], a[64:67], a[112:115], v[64:67]
v_cvt_pk_bf16_f32 v184, v56, v57
v_cvt_pk_bf16_f32 v185, v58, v59
v_mfma_f32_16x16x32_bf16 v[64:67], a[68:71], a[116:119], v[64:67]
v_cvt_pk_bf16_f32 v186, v60, v61
v_cvt_pk_bf16_f32 v187, v62, v63
v_mfma_f32_16x16x32_bf16 v[68:71], a[72:75], a[112:115], v[68:71]
buffer_store_dwordx4 v[184:187], v10, s[20:23], s50 offen offset:3072 sc1
ds_read_b128 a[96:99], v15 offset:1024
v_mfma_f32_16x16x32_bf16 v[68:71], a[76:79], a[116:119], v[68:71]
ds_read_b128 a[100:103], v15 offset:17408
ds_read_b128 a[104:107], v15 offset:1280
v_mfma_f32_16x16x32_bf16 v[72:75], a[80:83], a[112:115], v[72:75]
ds_read_b128 a[108:111], v15 offset:17664
v_mfma_f32_16x16x32_bf16 v[72:75], a[84:87], a[116:119], v[72:75]
v_mfma_f32_16x16x32_bf16 v[76:79], a[88:91], a[112:115], v[76:79]
v_fma_f32 v64, v64, v4, v192
v_fma_f32 v65, v65, v4, v193
v_mfma_f32_16x16x32_bf16 v[76:79], a[92:95], a[116:119], v[76:79]
v_fma_f32 v66, v66, v4, v194
s_waitcnt lgkmcnt(4)
v_mfma_f32_16x16x32_bf16 v[80:83], a[64:67], a[120:123], v[80:83]
v_fma_f32 v67, v67, v4, v195
v_fma_f32 v68, v68, v4, v196
v_mfma_f32_16x16x32_bf16 v[80:83], a[68:71], a[124:127], v[80:83]
v_fma_f32 v69, v69, v4, v197
v_fma_f32 v70, v70, v4, v198
v_mfma_f32_16x16x32_bf16 v[84:87], a[72:75], a[120:123], v[84:87]
v_fma_f32 v71, v71, v4, v199
v_cvt_pk_bf16_f32 v192, v64, v65
v_mfma_f32_16x16x32_bf16 v[84:87], a[76:79], a[124:127], v[84:87]
v_cvt_pk_bf16_f32 v193, v66, v67
v_cvt_pk_bf16_f32 v194, v68, v69
v_mfma_f32_16x16x32_bf16 v[88:91], a[80:83], a[120:123], v[88:91]
v_cvt_pk_bf16_f32 v195, v70, v71
buffer_store_dwordx4 v[192:195], v10, s[20:23], s51 offen offset:0 sc1
v_mfma_f32_16x16x32_bf16 v[88:91], a[84:87], a[124:127], v[88:91]
ds_read_b128 a[112:115], v14 offset:1024
ds_read_b128 a[116:119], v14 offset:17408
v_mfma_f32_16x16x32_bf16 v[92:95], a[88:91], a[120:123], v[92:95]
v_fma_f32 v72, v72, v4, v200
v_fma_f32 v73, v73, v4, v201
v_mfma_f32_16x16x32_bf16 v[92:95], a[92:95], a[124:127], v[92:95]
v_fma_f32 v74, v74, v4, v202
s_waitcnt lgkmcnt(2)
v_mfma_f32_16x16x32_bf16 v[96:99], a[32:35], a[96:99], v[96:99]
v_fma_f32 v75, v75, v4, v203
v_fma_f32 v76, v76, v4, v204
v_mfma_f32_16x16x32_bf16 v[96:99], a[36:39], a[100:103], v[96:99]
v_fma_f32 v77, v77, v4, v205
v_fma_f32 v78, v78, v4, v206
v_mfma_f32_16x16x32_bf16 v[100:103], a[40:43], a[96:99], v[100:103]
v_fma_f32 v79, v79, v4, v207
v_cvt_pk_bf16_f32 v200, v72, v73
v_mfma_f32_16x16x32_bf16 v[100:103], a[44:47], a[100:103], v[100:103]
v_cvt_pk_bf16_f32 v201, v74, v75
v_cvt_pk_bf16_f32 v202, v76, v77
v_mfma_f32_16x16x32_bf16 v[104:107], a[48:51], a[96:99], v[104:107]
v_cvt_pk_bf16_f32 v203, v78, v79
buffer_store_dwordx4 v[200:203], v10, s[20:23], s51 offen offset:1024 sc1
v_mfma_f32_16x16x32_bf16 v[104:107], a[52:55], a[100:103], v[104:107]
v_fma_f32 v80, v80, v5, v208
v_fma_f32 v81, v81, v5, v209
v_mfma_f32_16x16x32_bf16 v[108:111], a[56:59], a[96:99], v[108:111]
v_fma_f32 v82, v82, v5, v210
v_fma_f32 v83, v83, v5, v211
v_mfma_f32_16x16x32_bf16 v[108:111], a[60:63], a[100:103], v[108:111]
v_fma_f32 v84, v84, v5, v212
v_fma_f32 v85, v85, v5, v213
v_mfma_f32_16x16x32_bf16 v[112:115], a[32:35], a[104:107], v[112:115]
v_fma_f32 v86, v86, v5, v214
v_fma_f32 v87, v87, v5, v215
v_mfma_f32_16x16x32_bf16 v[112:115], a[36:39], a[108:111], v[112:115]
v_cvt_pk_bf16_f32 v208, v80, v81
v_cvt_pk_bf16_f32 v209, v82, v83
v_mfma_f32_16x16x32_bf16 v[116:119], a[40:43], a[104:107], v[116:119]
v_cvt_pk_bf16_f32 v210, v84, v85
v_cvt_pk_bf16_f32 v211, v86, v87
v_mfma_f32_16x16x32_bf16 v[116:119], a[44:47], a[108:111], v[116:119]
buffer_store_dwordx4 v[208:211], v10, s[20:23], s51 offen offset:2048 sc1
ds_read_b128 a[120:123], v14 offset:1280
v_mfma_f32_16x16x32_bf16 v[120:123], a[48:51], a[104:107], v[120:123]
ds_read_b128 a[124:127], v14 offset:17664
v_fma_f32 v88, v88, v5, v216
v_mfma_f32_16x16x32_bf16 v[120:123], a[52:55], a[108:111], v[120:123]
v_fma_f32 v89, v89, v5, v217
v_fma_f32 v90, v90, v5, v218
v_mfma_f32_16x16x32_bf16 v[124:127], a[56:59], a[104:107], v[124:127]
v_fma_f32 v91, v91, v5, v219
v_fma_f32 v92, v92, v5, v220
v_mfma_f32_16x16x32_bf16 v[124:127], a[60:63], a[108:111], v[124:127]
v_fma_f32 v93, v93, v5, v221
s_waitcnt lgkmcnt(2)
v_mfma_f32_16x16x32_bf16 v[96:99], a[64:67], a[112:115], v[96:99]
v_fma_f32 v94, v94, v5, v222
v_fma_f32 v95, v95, v5, v223
v_mfma_f32_16x16x32_bf16 v[96:99], a[68:71], a[116:119], v[96:99]
v_cvt_pk_bf16_f32 v216, v88, v89
v_cvt_pk_bf16_f32 v217, v90, v91
v_mfma_f32_16x16x32_bf16 v[100:103], a[72:75], a[112:115], v[100:103]
v_cvt_pk_bf16_f32 v218, v92, v93
v_cvt_pk_bf16_f32 v219, v94, v95
buffer_store_dwordx4 v[216:219], v10, s[20:23], s51 offen offset:3072 sc1
v_mfma_f32_16x16x32_bf16 v[100:103], a[76:79], a[116:119], v[100:103]
ds_read_b128 a[96:99], v15 offset:1536
ds_read_b128 a[100:103], v15 offset:17920
v_mfma_f32_16x16x32_bf16 v[104:107], a[80:83], a[112:115], v[104:107]
ds_read_b128 a[104:107], v15 offset:1792
ds_read_b128 a[108:111], v15 offset:18176
v_mfma_f32_16x16x32_bf16 v[104:107], a[84:87], a[116:119], v[104:107]
v_mfma_f32_16x16x32_bf16 v[108:111], a[88:91], a[112:115], v[108:111]
v_fma_f32 v96, v96, v6, v224
v_fma_f32 v97, v97, v6, v225
v_mfma_f32_16x16x32_bf16 v[108:111], a[92:95], a[116:119], v[108:111]
v_fma_f32 v98, v98, v6, v226
s_waitcnt lgkmcnt(4)
v_mfma_f32_16x16x32_bf16 v[112:115], a[64:67], a[120:123], v[112:115]
v_fma_f32 v99, v99, v6, v227
v_fma_f32 v100, v100, v6, v228
v_mfma_f32_16x16x32_bf16 v[112:115], a[68:71], a[124:127], v[112:115]
v_fma_f32 v101, v101, v6, v229
v_fma_f32 v102, v102, v6, v230
v_mfma_f32_16x16x32_bf16 v[116:119], a[72:75], a[120:123], v[116:119]
v_fma_f32 v103, v103, v6, v231
v_cvt_pk_bf16_f32 v224, v96, v97
v_mfma_f32_16x16x32_bf16 v[116:119], a[76:79], a[124:127], v[116:119]
v_cvt_pk_bf16_f32 v225, v98, v99
v_cvt_pk_bf16_f32 v226, v100, v101
v_mfma_f32_16x16x32_bf16 v[120:123], a[80:83], a[120:123], v[120:123]
v_cvt_pk_bf16_f32 v227, v102, v103
buffer_store_dwordx4 v[224:227], v10, s[20:23], s52 offen offset:0 sc1
v_mfma_f32_16x16x32_bf16 v[120:123], a[84:87], a[124:127], v[120:123]
ds_read_b128 a[112:115], v14 offset:1536
ds_read_b128 a[116:119], v14 offset:17920
v_mfma_f32_16x16x32_bf16 v[124:127], a[88:91], a[120:123], v[124:127]
v_fma_f32 v104, v104, v6, v232
v_fma_f32 v105, v105, v6, v233
v_mfma_f32_16x16x32_bf16 v[124:127], a[92:95], a[124:127], v[124:127]
v_fma_f32 v106, v106, v6, v234
s_waitcnt lgkmcnt(2)
v_mfma_f32_16x16x32_bf16 v[128:131], a[32:35], a[96:99], v[128:131]
v_fma_f32 v107, v107, v6, v235
v_fma_f32 v108, v108, v6, v236
v_mfma_f32_16x16x32_bf16 v[128:131], a[36:39], a[100:103], v[128:131]
v_fma_f32 v109, v109, v6, v237
v_fma_f32 v110, v110, v6, v238
v_mfma_f32_16x16x32_bf16 v[132:135], a[40:43], a[96:99], v[132:135]
v_fma_f32 v111, v111, v6, v239
v_cvt_pk_bf16_f32 v232, v104, v105
v_mfma_f32_16x16x32_bf16 v[132:135], a[44:47], a[100:103], v[132:135]
v_cvt_pk_bf16_f32 v233, v106, v107
v_cvt_pk_bf16_f32 v234, v108, v109
v_mfma_f32_16x16x32_bf16 v[136:139], a[48:51], a[96:99], v[136:139]
v_cvt_pk_bf16_f32 v235, v110, v111
buffer_store_dwordx4 v[232:235], v10, s[20:23], s52 offen offset:1024 sc1
v_mfma_f32_16x16x32_bf16 v[136:139], a[52:55], a[100:103], v[136:139]
v_fma_f32 v112, v112, v7, v240
v_fma_f32 v113, v113, v7, v241
v_mfma_f32_16x16x32_bf16 v[140:143], a[56:59], a[96:99], v[140:143]
v_fma_f32 v114, v114, v7, v242
v_fma_f32 v115, v115, v7, v243
v_mfma_f32_16x16x32_bf16 v[140:143], a[60:63], a[100:103], v[140:143]
v_fma_f32 v116, v116, v7, v244
v_fma_f32 v117, v117, v7, v245
v_mfma_f32_16x16x32_bf16 v[144:147], a[32:35], a[104:107], v[144:147]
v_fma_f32 v118, v118, v7, v246
v_fma_f32 v119, v119, v7, v247
v_mfma_f32_16x16x32_bf16 v[144:147], a[36:39], a[108:111], v[144:147]
v_cvt_pk_bf16_f32 v240, v112, v113
v_cvt_pk_bf16_f32 v241, v114, v115
v_mfma_f32_16x16x32_bf16 v[148:151], a[40:43], a[104:107], v[148:151]
v_cvt_pk_bf16_f32 v242, v116, v117
v_cvt_pk_bf16_f32 v243, v118, v119
v_mfma_f32_16x16x32_bf16 v[148:151], a[44:47], a[108:111], v[148:151]
buffer_store_dwordx4 v[240:243], v10, s[20:23], s52 offen offset:2048 sc1
ds_read_b128 a[120:123], v14 offset:1792
v_mfma_f32_16x16x32_bf16 v[152:155], a[48:51], a[104:107], v[152:155]
ds_read_b128 a[124:127], v14 offset:18176
v_fma_f32 v120, v120, v7, v248
v_mfma_f32_16x16x32_bf16 v[152:155], a[52:55], a[108:111], v[152:155]
v_fma_f32 v121, v121, v7, v249
v_fma_f32 v122, v122, v7, v250
v_mfma_f32_16x16x32_bf16 v[156:159], a[56:59], a[104:107], v[156:159]
v_fma_f32 v123, v123, v7, v251
v_fma_f32 v124, v124, v7, v252
v_mfma_f32_16x16x32_bf16 v[156:159], a[60:63], a[108:111], v[156:159]
v_fma_f32 v125, v125, v7, v253
s_waitcnt lgkmcnt(2)
v_mfma_f32_16x16x32_bf16 v[128:131], a[64:67], a[112:115], v[128:131]
v_fma_f32 v126, v126, v7, v254
v_fma_f32 v127, v127, v7, v255
v_mfma_f32_16x16x32_bf16 v[128:131], a[68:71], a[116:119], v[128:131]
v_cvt_pk_bf16_f32 v248, v120, v121
v_cvt_pk_bf16_f32 v249, v122, v123
v_mfma_f32_16x16x32_bf16 v[132:135], a[72:75], a[112:115], v[132:135]
v_cvt_pk_bf16_f32 v250, v124, v125
v_cvt_pk_bf16_f32 v251, v126, v127
buffer_store_dwordx4 v[248:251], v10, s[20:23], s52 offen offset:3072 sc1
v_mfma_f32_16x16x32_bf16 v[132:135], a[76:79], a[116:119], v[132:135]
v_mfma_f32_16x16x32_bf16 v[136:139], a[80:83], a[112:115], v[136:139]
v_mfma_f32_16x16x32_bf16 v[136:139], a[84:87], a[116:119], v[136:139]
v_mfma_f32_16x16x32_bf16 v[140:143], a[88:91], a[112:115], v[140:143]
v_mfma_f32_16x16x32_bf16 v[140:143], a[92:95], a[116:119], v[140:143]
s_waitcnt lgkmcnt(0)
v_mfma_f32_16x16x32_bf16 v[144:147], a[64:67], a[120:123], v[144:147]
v_mfma_f32_16x16x32_bf16 v[144:147], a[68:71], a[124:127], v[144:147]
v_mfma_f32_16x16x32_bf16 v[148:151], a[72:75], a[120:123], v[148:151]
v_mfma_f32_16x16x32_bf16 v[148:151], a[76:79], a[124:127], v[148:151]
v_mfma_f32_16x16x32_bf16 v[152:155], a[80:83], a[120:123], v[152:155]
v_mfma_f32_16x16x32_bf16 v[152:155], a[84:87], a[124:127], v[152:155]
v_mfma_f32_16x16x32_bf16 v[156:159], a[88:91], a[120:123], v[156:159]
v_mfma_f32_16x16x32_bf16 v[156:159], a[92:95], a[124:127], v[156:159]
s_waitcnt lgkmcnt(0)
s_nop 0
s_add_u32 s66, s53, 4096
s_add_u32 s67, s53, 8192
buffer_load_dwordx4 v[96:99], v10, s[20:23], s67 offen offset:0 sc1
buffer_load_dwordx4 v[100:103], v10, s[20:23], s67 offen offset:1024 sc1
buffer_load_dwordx4 v[104:107], v10, s[20:23], s67 offen offset:2048 sc1
buffer_load_dwordx4 v[108:111], v10, s[20:23], s67 offen offset:3072 sc1
buffer_load_dwordx4 v[80:83], v10, s[20:23], s66 offen offset:0 sc1
buffer_load_dwordx4 v[84:87], v10, s[20:23], s66 offen offset:1024 sc1
buffer_load_dwordx4 v[88:91], v10, s[20:23], s66 offen offset:2048 sc1
buffer_load_dwordx4 v[92:95], v10, s[20:23], s66 offen offset:3072 sc1
v_accvgpr_read_b32 v32, a0
v_accvgpr_read_b32 v33, a1
v_accvgpr_read_b32 v34, a2
v_accvgpr_read_b32 v35, a3
v_accvgpr_read_b32 v36, a4
v_accvgpr_read_b32 v37, a5
v_accvgpr_read_b32 v38, a6
v_accvgpr_read_b32 v39, a7
v_accvgpr_read_b32 v40, a8
v_accvgpr_read_b32 v41, a9
v_accvgpr_read_b32 v42, a10
v_accvgpr_read_b32 v43, a11
v_accvgpr_read_b32 v44, a12
v_accvgpr_read_b32 v45, a13
v_accvgpr_read_b32 v46, a14
v_accvgpr_read_b32 v47, a15
v_accvgpr_read_b32 v48, a16
v_accvgpr_read_b32 v49, a17
v_accvgpr_read_b32 v50, a18
v_accvgpr_read_b32 v51, a19
v_accvgpr_read_b32 v52, a20
v_accvgpr_read_b32 v53, a21
v_accvgpr_read_b32 v54, a22
v_accvgpr_read_b32 v55, a23
v_accvgpr_read_b32 v56, a24
v_accvgpr_read_b32 v57, a25
v_accvgpr_read_b32 v58, a26
v_accvgpr_read_b32 v59, a27
v_accvgpr_read_b32 v60, a28
v_accvgpr_read_b32 v61, a29
v_accvgpr_read_b32 v62, a30
v_accvgpr_read_b32 v63, a31
v_pk_fma_f32 v[128:129], v[128:129], v[8:9], v[32:33] op_sel:[0,0,0] op_sel_hi:[1,0,1]
v_pk_fma_f32 v[130:131], v[130:131], v[8:9], v[34:35] op_sel:[0,0,0] op_sel_hi:[1,0,1]
v_pk_fma_f32 v[132:133], v[132:133], v[8:9], v[36:37] op_sel:[0,0,0] op_sel_hi:[1,0,1]
v_pk_fma_f32 v[134:135], v[134:135], v[8:9], v[38:39] op_sel:[0,0,0] op_sel_hi:[1,0,1]
v_pk_fma_f32 v[136:137], v[136:137], v[8:9], v[40:41] op_sel:[0,0,0] op_sel_hi:[1,0,1]
v_pk_fma_f32 v[138:139], v[138:139], v[8:9], v[42:43] op_sel:[0,0,0] op_sel_hi:[1,0,1]
v_pk_fma_f32 v[140:141], v[140:141], v[8:9], v[44:45] op_sel:[0,0,0] op_sel_hi:[1,0,1]
v_pk_fma_f32 v[142:143], v[142:143], v[8:9], v[46:47] op_sel:[0,0,0] op_sel_hi:[1,0,1]
v_pk_fma_f32 v[144:145], v[144:145], v[8:9], v[48:49] op_sel:[0,1,0] op_sel_hi:[1,1,1]
v_pk_fma_f32 v[146:147], v[146:147], v[8:9], v[50:51] op_sel:[0,1,0] op_sel_hi:[1,1,1]
v_pk_fma_f32 v[148:149], v[148:149], v[8:9], v[52:53] op_sel:[0,1,0] op_sel_hi:[1,1,1]
v_pk_fma_f32 v[150:151], v[150:151], v[8:9], v[54:55] op_sel:[0,1,0] op_sel_hi:[1,1,1]
v_pk_fma_f32 v[152:153], v[152:153], v[8:9], v[56:57] op_sel:[0,1,0] op_sel_hi:[1,1,1]
v_pk_fma_f32 v[154:155], v[154:155], v[8:9], v[58:59] op_sel:[0,1,0] op_sel_hi:[1,1,1]
v_pk_fma_f32 v[156:157], v[156:157], v[8:9], v[60:61] op_sel:[0,1,0] op_sel_hi:[1,1,1]
v_pk_fma_f32 v[158:159], v[158:159], v[8:9], v[62:63] op_sel:[0,1,0] op_sel_hi:[1,1,1]
buffer_load_dwordx4 v[64:67], v10, s[20:23], s53 offen offset:0 sc1
buffer_load_dwordx4 v[68:71], v10, s[20:23], s53 offen offset:1024 sc1
buffer_load_dwordx4 v[72:75], v10, s[20:23], s53 offen offset:2048 sc1
buffer_load_dwordx4 v[76:79], v10, s[20:23], s53 offen offset:3072 sc1
s_waitcnt vmcnt(24)
v_accvgpr_read_b32 v30, a160
v_accvgpr_read_b32 v31, a161
v_lshlrev_b32 v32, 16, v30
v_and_b32 v33, 0xffff0000, v30
v_lshlrev_b32_e64 v34, 16, v31
v_and_b32 v35, 0xffff0000, v31
v_accvgpr_read_b32 v30, a144
v_accvgpr_read_b32 v31, a145
v_lshlrev_b32_e64 v36, 16, v30
v_and_b32 v37, 0xffff0000, v30
v_lshlrev_b32_e64 v38, 16, v31
v_and_b32 v39, 0xffff0000, v31
v_pk_mul_f32 v[36:37], v[36:37], v[32:33]
v_pk_mul_f32 v[38:39], v[38:39], v[34:35]
v_cvt_pk_bf16_f32 v30, v36, v37
v_cvt_pk_bf16_f32 v31, v38, v39
v_lshlrev_b32_e64 v36, 16, v30
v_and_b32 v37, 0xffff0000, v30
v_lshlrev_b32_e64 v38, 16, v31
v_and_b32 v39, 0xffff0000, v31
v_pk_fma_f32 v[128:129], v[36:37], v[8:9], v[128:129] op_sel:[0,0,0] op_sel_hi:[1,0,1]
v_pk_fma_f32 v[130:131], v[38:39], v[8:9], v[130:131] op_sel:[0,0,0] op_sel_hi:[1,0,1]
v_accvgpr_read_b32 v30, a152
v_accvgpr_read_b32 v31, a153
v_lshlrev_b32_e64 v36, 16, v30
v_and_b32 v37, 0xffff0000, v30
v_lshlrev_b32_e64 v38, 16, v31
v_and_b32 v39, 0xffff0000, v31
v_pk_mul_f32 v[36:37], v[36:37], v[32:33]
v_pk_mul_f32 v[38:39], v[38:39], v[34:35]
v_cvt_pk_bf16_f32 v30, v36, v37
v_cvt_pk_bf16_f32 v31, v38, v39
v_lshlrev_b32_e64 v36, 16, v30
v_and_b32 v37, 0xffff0000, v30
v_lshlrev_b32_e64 v38, 16, v31
v_and_b32 v39, 0xffff0000, v31
v_pk_fma_f32 v[144:145], v[36:37], v[8:9], v[144:145] op_sel:[0,1,0] op_sel_hi:[1,1,1]
v_pk_fma_f32 v[146:147], v[38:39], v[8:9], v[146:147] op_sel:[0,1,0] op_sel_hi:[1,1,1]
v_accvgpr_read_b32 v30, a162
v_accvgpr_read_b32 v31, a163
v_lshlrev_b32_e64 v32, 16, v30
v_and_b32 v33, 0xffff0000, v30
v_lshlrev_b32_e64 v34, 16, v31
v_and_b32 v35, 0xffff0000, v31
v_accvgpr_read_b32 v30, a146
v_accvgpr_read_b32 v31, a147
v_lshlrev_b32_e64 v36, 16, v30
v_and_b32 v37, 0xffff0000, v30
v_lshlrev_b32_e64 v38, 16, v31
v_and_b32 v39, 0xffff0000, v31
v_pk_mul_f32 v[36:37], v[36:37], v[32:33]
v_pk_mul_f32 v[38:39], v[38:39], v[34:35]
v_cvt_pk_bf16_f32 v30, v36, v37
v_cvt_pk_bf16_f32 v31, v38, v39
v_lshlrev_b32_e64 v36, 16, v30
v_and_b32 v37, 0xffff0000, v30
v_lshlrev_b32_e64 v38, 16, v31
v_and_b32 v39, 0xffff0000, v31
v_pk_fma_f32 v[132:133], v[36:37], v[8:9], v[132:133] op_sel:[0,0,0] op_sel_hi:[1,0,1]
v_pk_fma_f32 v[134:135], v[38:39], v[8:9], v[134:135] op_sel:[0,0,0] op_sel_hi:[1,0,1]
v_accvgpr_read_b32 v30, a154
v_accvgpr_read_b32 v31, a155
v_lshlrev_b32_e64 v36, 16, v30
v_and_b32 v37, 0xffff0000, v30
v_lshlrev_b32_e64 v38, 16, v31
v_and_b32 v39, 0xffff0000, v31
v_pk_mul_f32 v[36:37], v[36:37], v[32:33]
v_pk_mul_f32 v[38:39], v[38:39], v[34:35]
v_cvt_pk_bf16_f32 v30, v36, v37
v_cvt_pk_bf16_f32 v31, v38, v39
v_lshlrev_b32_e64 v36, 16, v30
v_and_b32 v37, 0xffff0000, v30
v_lshlrev_b32_e64 v38, 16, v31
v_and_b32 v39, 0xffff0000, v31
v_pk_fma_f32 v[148:149], v[36:37], v[8:9], v[148:149] op_sel:[0,1,0] op_sel_hi:[1,1,1]
v_pk_fma_f32 v[150:151], v[38:39], v[8:9], v[150:151] op_sel:[0,1,0] op_sel_hi:[1,1,1]
v_accvgpr_read_b32 v30, a164
v_accvgpr_read_b32 v31, a165
v_lshlrev_b32_e64 v32, 16, v30
v_and_b32 v33, 0xffff0000, v30
v_lshlrev_b32_e64 v34, 16, v31
v_and_b32 v35, 0xffff0000, v31
v_accvgpr_read_b32 v30, a148
v_accvgpr_read_b32 v31, a149
v_lshlrev_b32_e64 v36, 16, v30
v_and_b32 v37, 0xffff0000, v30
v_lshlrev_b32_e64 v38, 16, v31
v_and_b32 v39, 0xffff0000, v31
v_pk_mul_f32 v[36:37], v[36:37], v[32:33]
v_pk_mul_f32 v[38:39], v[38:39], v[34:35]
v_cvt_pk_bf16_f32 v30, v36, v37
v_cvt_pk_bf16_f32 v31, v38, v39
v_lshlrev_b32_e64 v36, 16, v30
v_and_b32 v37, 0xffff0000, v30
v_lshlrev_b32_e64 v38, 16, v31
v_and_b32 v39, 0xffff0000, v31
v_pk_fma_f32 v[136:137], v[36:37], v[8:9], v[136:137] op_sel:[0,0,0] op_sel_hi:[1,0,1]
v_pk_fma_f32 v[138:139], v[38:39], v[8:9], v[138:139] op_sel:[0,0,0] op_sel_hi:[1,0,1]
v_accvgpr_read_b32 v30, a156
v_accvgpr_read_b32 v31, a157
v_lshlrev_b32_e64 v36, 16, v30
v_and_b32 v37, 0xffff0000, v30
v_lshlrev_b32_e64 v38, 16, v31
v_and_b32 v39, 0xffff0000, v31
v_pk_mul_f32 v[36:37], v[36:37], v[32:33]
v_pk_mul_f32 v[38:39], v[38:39], v[34:35]
v_cvt_pk_bf16_f32 v30, v36, v37
v_cvt_pk_bf16_f32 v31, v38, v39
v_lshlrev_b32_e64 v36, 16, v30
v_and_b32 v37, 0xffff0000, v30
v_lshlrev_b32_e64 v38, 16, v31
v_and_b32 v39, 0xffff0000, v31
v_pk_fma_f32 v[152:153], v[36:37], v[8:9], v[152:153] op_sel:[0,1,0] op_sel_hi:[1,1,1]
v_pk_fma_f32 v[154:155], v[38:39], v[8:9], v[154:155] op_sel:[0,1,0] op_sel_hi:[1,1,1]
v_accvgpr_read_b32 v30, a166
v_accvgpr_read_b32 v31, a167
v_lshlrev_b32_e64 v32, 16, v30
v_and_b32 v33, 0xffff0000, v30
v_lshlrev_b32_e64 v34, 16, v31
v_and_b32 v35, 0xffff0000, v31
v_accvgpr_read_b32 v30, a150
v_accvgpr_read_b32 v31, a151
v_lshlrev_b32_e64 v36, 16, v30
v_and_b32 v37, 0xffff0000, v30
v_lshlrev_b32_e64 v38, 16, v31
v_and_b32 v39, 0xffff0000, v31
v_pk_mul_f32 v[36:37], v[36:37], v[32:33]
v_pk_mul_f32 v[38:39], v[38:39], v[34:35]
v_cvt_pk_bf16_f32 v30, v36, v37
v_cvt_pk_bf16_f32 v31, v38, v39
v_lshlrev_b32_e64 v36, 16, v30
v_and_b32 v37, 0xffff0000, v30
v_lshlrev_b32_e64 v38, 16, v31
v_and_b32 v39, 0xffff0000, v31
v_pk_fma_f32 v[140:141], v[36:37], v[8:9], v[140:141] op_sel:[0,0,0] op_sel_hi:[1,0,1]
v_pk_fma_f32 v[142:143], v[38:39], v[8:9], v[142:143] op_sel:[0,0,0] op_sel_hi:[1,0,1]
v_accvgpr_read_b32 v30, a158
v_accvgpr_read_b32 v31, a159
v_lshlrev_b32_e64 v36, 16, v30
v_and_b32 v37, 0xffff0000, v30
v_lshlrev_b32_e64 v38, 16, v31
v_and_b32 v39, 0xffff0000, v31
v_pk_mul_f32 v[36:37], v[36:37], v[32:33]
v_pk_mul_f32 v[38:39], v[38:39], v[34:35]
v_cvt_pk_bf16_f32 v30, v36, v37
v_cvt_pk_bf16_f32 v31, v38, v39
v_lshlrev_b32_e64 v36, 16, v30
v_and_b32 v37, 0xffff0000, v30
v_lshlrev_b32_e64 v38, 16, v31
v_and_b32 v39, 0xffff0000, v31
v_pk_fma_f32 v[156:157], v[36:37], v[8:9], v[156:157] op_sel:[0,1,0] op_sel_hi:[1,1,1]
v_pk_fma_f32 v[158:159], v[38:39], v[8:9], v[158:159] op_sel:[0,1,0] op_sel_hi:[1,1,1]
s_movk_i32 s69, 0x2000
s_waitcnt vmcnt(8)
v_max3_u32 v30, v96, v97, v98
v_max3_u32 v31, v99, v100, v101
v_max3_u32 v30, v30, v102, v103
v_max3_u32 v31, v31, v104, v105
v_max3_u32 v30, v30, v106, v107
v_max3_u32 v31, v31, v108, v109
v_max3_u32 v30, v30, v110, v111
v_max_u32 v30, v30, v31
v_cmp_eq_u32 vcc, -1, v30
s_nop 3
s_cbranch_vccnz KF_r2_slow
KF_r2_ok:
v_lshlrev_b32_e64 v32, 16, v96
v_and_b32 v33, 0xffff0000, v96
v_lshlrev_b32_e64 v34, 16, v97
v_and_b32 v35, 0xffff0000, v97
v_pk_add_f32 v[128:129], v[128:129], v[32:33]
v_pk_add_f32 v[130:131], v[130:131], v[34:35]
v_lshlrev_b32_e64 v36, 16, v98
v_and_b32 v37, 0xffff0000, v98
v_lshlrev_b32_e64 v38, 16, v99
v_and_b32 v39, 0xffff0000, v99
v_pk_add_f32 v[132:133], v[132:133], v[36:37]
v_pk_add_f32 v[134:135], v[134:135], v[38:39]
v_lshlrev_b32_e64 v32, 16, v100
v_and_b32 v33, 0xffff0000, v100
v_lshlrev_b32_e64 v34, 16, v101
v_and_b32 v35, 0xffff0000, v101
v_pk_add_f32 v[136:137], v[136:137], v[32:33]
v_pk_add_f32 v[138:139], v[138:139], v[34:35]
v_lshlrev_b32_e64 v36, 16, v102
v_and_b32 v37, 0xffff0000, v102
v_lshlrev_b32_e64 v38, 16, v103
v_and_b32 v39, 0xffff0000, v103
v_pk_add_f32 v[140:141], v[140:141], v[36:37]
v_pk_add_f32 v[142:143], v[142:143], v[38:39]
v_lshlrev_b32_e64 v32, 16, v104
v_and_b32 v33, 0xffff0000, v104
v_lshlrev_b32_e64 v34, 16, v105
v_and_b32 v35, 0xffff0000, v105
v_pk_add_f32 v[144:145], v[144:145], v[32:33]
v_pk_add_f32 v[146:147], v[146:147], v[34:35]
v_lshlrev_b32_e64 v36, 16, v106
v_and_b32 v37, 0xffff0000, v106
v_lshlrev_b32_e64 v38, 16, v107
v_and_b32 v39, 0xffff0000, v107
v_pk_add_f32 v[148:149], v[148:149], v[36:37]
v_pk_add_f32 v[150:151], v[150:151], v[38:39]
v_lshlrev_b32_e64 v32, 16, v108
v_and_b32 v33, 0xffff0000, v108
v_lshlrev_b32_e64 v34, 16, v109
v_and_b32 v35, 0xffff0000, v109
v_pk_add_f32 v[152:153], v[152:153], v[32:33]
v_pk_add_f32 v[154:155], v[154:155], v[34:35]
v_lshlrev_b32_e64 v36, 16, v110
v_and_b32 v37, 0xffff0000, v110
v_lshlrev_b32_e64 v38, 16, v111
v_and_b32 v39, 0xffff0000, v111
v_pk_add_f32 v[156:157], v[156:157], v[36:37]
v_pk_add_f32 v[158:159], v[158:159], v[38:39]
s_waitcnt vmcnt(4)
s_nop 0
v_max3_u32 v30, v80, v81, v82
v_max3_u32 v31, v83, v84, v85
v_max3_u32 v30, v30, v86, v87
v_max3_u32 v31, v31, v88, v89
v_max3_u32 v30, v30, v90, v91
v_max3_u32 v31, v31, v92, v93
v_max3_u32 v30, v30, v94, v95
v_max_u32 v30, v30, v31
v_cmp_eq_u32 vcc, -1, v30
s_nop 3
s_cbranch_vccnz KF_r1_slow
KF_r1_ok:
v_lshlrev_b32_e64 v32, 16, v80
v_and_b32 v33, 0xffff0000, v80
v_lshlrev_b32_e64 v34, 16, v81
v_and_b32 v35, 0xffff0000, v81
v_pk_add_f32 v[128:129], v[128:129], v[32:33]
v_pk_add_f32 v[130:131], v[130:131], v[34:35]
v_lshlrev_b32_e64 v36, 16, v82
v_and_b32 v37, 0xffff0000, v82
v_lshlrev_b32_e64 v38, 16, v83
v_and_b32 v39, 0xffff0000, v83
v_pk_add_f32 v[132:133], v[132:133], v[36:37]
v_pk_add_f32 v[134:135], v[134:135], v[38:39]
v_lshlrev_b32_e64 v32, 16, v84
v_and_b32 v33, 0xffff0000, v84
v_lshlrev_b32_e64 v34, 16, v85
v_and_b32 v35, 0xffff0000, v85
v_pk_add_f32 v[136:137], v[136:137], v[32:33]
v_pk_add_f32 v[138:139], v[138:139], v[34:35]
v_lshlrev_b32_e64 v36, 16, v86
v_and_b32 v37, 0xffff0000, v86
v_lshlrev_b32_e64 v38, 16, v87
v_and_b32 v39, 0xffff0000, v87
v_pk_add_f32 v[140:141], v[140:141], v[36:37]
v_pk_add_f32 v[142:143], v[142:143], v[38:39]
v_lshlrev_b32_e64 v32, 16, v88
v_and_b32 v33, 0xffff0000, v88
v_lshlrev_b32_e64 v34, 16, v89
v_and_b32 v35, 0xffff0000, v89
v_pk_add_f32 v[144:145], v[144:145], v[32:33]
v_pk_add_f32 v[146:147], v[146:147], v[34:35]
v_lshlrev_b32_e64 v36, 16, v90
v_and_b32 v37, 0xffff0000, v90
v_lshlrev_b32_e64 v38, 16, v91
v_and_b32 v39, 0xffff0000, v91
v_pk_add_f32 v[148:149], v[148:149], v[36:37]
v_pk_add_f32 v[150:151], v[150:151], v[38:39]
v_lshlrev_b32_e64 v32, 16, v92
v_and_b32 v33, 0xffff0000, v92
v_lshlrev_b32_e64 v34, 16, v93
v_and_b32 v35, 0xffff0000, v93
v_pk_add_f32 v[152:153], v[152:153], v[32:33]
v_pk_add_f32 v[154:155], v[154:155], v[34:35]
v_lshlrev_b32_e64 v36, 16, v94
v_and_b32 v37, 0xffff0000, v94
v_lshlrev_b32_e64 v38, 16, v95
v_and_b32 v39, 0xffff0000, v95
v_pk_add_f32 v[156:157], v[156:157], v[36:37]
v_pk_add_f32 v[158:159], v[158:159], v[38:39]
s_waitcnt vmcnt(0)
s_nop 0
v_max3_u32 v30, v64, v65, v66
v_max3_u32 v31, v67, v68, v69
v_max3_u32 v30, v30, v70, v71
v_max3_u32 v31, v31, v72, v73
v_max3_u32 v30, v30, v74, v75
v_max3_u32 v31, v31, v76, v77
v_max3_u32 v30, v30, v78, v79
v_max_u32 v30, v30, v31
v_cmp_eq_u32 vcc, -1, v30
s_nop 3
s_cbranch_vccnz KF_r0_slow
KF_r0_ok:
v_lshlrev_b32_e64 v32, 16, v64
v_and_b32 v33, 0xffff0000, v64
v_lshlrev_b32_e64 v34, 16, v65
v_and_b32 v35, 0xffff0000, v65
v_pk_add_f32 v[128:129], v[128:129], v[32:33]
v_pk_add_f32 v[130:131], v[130:131], v[34:35]
buffer_store_dwordx4 v[128:131], v29, s[28:31], 0 offen offset:0 sc1
v_lshlrev_b32_e64 v36, 16, v66
v_and_b32 v37, 0xffff0000, v66
v_lshlrev_b32_e64 v38, 16, v67
v_and_b32 v39, 0xffff0000, v67
v_pk_add_f32 v[132:133], v[132:133], v[36:37]
v_pk_add_f32 v[134:135], v[134:135], v[38:39]
buffer_store_dwordx4 v[132:135], v29, s[28:31], 0 offen offset:64 sc1
v_lshlrev_b32_e64 v32, 16, v68
v_and_b32 v33, 0xffff0000, v68
v_lshlrev_b32_e64 v34, 16, v69
v_and_b32 v35, 0xffff0000, v69
v_pk_add_f32 v[136:137], v[136:137], v[32:33]
v_pk_add_f32 v[138:139], v[138:139], v[34:35]
buffer_store_dwordx4 v[136:139], v29, s[28:31], 0 offen offset:128 sc1
v_lshlrev_b32_e64 v36, 16, v70
v_and_b32 v37, 0xffff0000, v70
v_lshlrev_b32_e64 v38, 16, v71
v_and_b32 v39, 0xffff0000, v71
v_pk_add_f32 v[140:141], v[140:141], v[36:37]
v_pk_add_f32 v[142:143], v[142:143], v[38:39]
buffer_store_dwordx4 v[140:143], v29, s[28:31], 0 offen offset:192 sc1
v_lshlrev_b32_e64 v32, 16, v72
v_and_b32 v33, 0xffff0000, v72
v_lshlrev_b32_e64 v34, 16, v73
v_and_b32 v35, 0xffff0000, v73
v_pk_add_f32 v[144:145], v[144:145], v[32:33]
v_pk_add_f32 v[146:147], v[146:147], v[34:35]
buffer_store_dwordx4 v[144:147], v29, s[28:31], s69 offen offset:0 sc1
v_lshlrev_b32_e64 v36, 16, v74
v_and_b32 v37, 0xffff0000, v74
v_lshlrev_b32_e64 v38, 16, v75
v_and_b32 v39, 0xffff0000, v75
v_pk_add_f32 v[148:149], v[148:149], v[36:37]
v_pk_add_f32 v[150:151], v[150:151], v[38:39]
buffer_store_dwordx4 v[148:151], v29, s[28:31], s69 offen offset:64 sc1
v_lshlrev_b32_e64 v32, 16, v76
v_and_b32 v33, 0xffff0000, v76
v_lshlrev_b32_e64 v34, 16, v77
v_and_b32 v35, 0xffff0000, v77
v_pk_add_f32 v[152:153], v[152:153], v[32:33]
v_pk_add_f32 v[154:155], v[154:155], v[34:35]
buffer_store_dwordx4 v[152:155], v29, s[28:31], s69 offen offset:128 sc1
v_lshlrev_b32_e64 v36, 16, v78
v_and_b32 v37, 0xffff0000, v78
v_lshlrev_b32_e64 v38, 16, v79
v_and_b32 v39, 0xffff0000, v79
v_pk_add_f32 v[156:157], v[156:157], v[36:37]
v_pk_add_f32 v[158:159], v[158:159], v[38:39]
buffer_store_dwordx4 v[156:159], v29, s[28:31], s69 offen offset:192 sc1
KF_end:
s_endpgm
KF_tag:
v_accvgpr_read_b32 v30, a250
s_mov_b32 s78, 0x9e3779b1
v_mul_lo_u32 v30, v30, s78
v_mov_b32 v31, 1
v_add_u32 v30, 0x7f4a7c15, v30
buffer_store_dword v30, off, s[20:23], s77 sc1
buffer_store_dwordx2 v[30:31], off, s[24:27], 0 sc1
s_branch KF_notag
KF_tg_slow:
s_mov_b32 s68, 1048576
KF_tg_again:
s_sleep 4
buffer_load_dwordx2 v[2:3], off, s[24:27], 0 sc1
s_waitcnt vmcnt(0)
v_cmp_eq_u32 vcc, 0, v3
s_sub_u32 s68, s68, 1
s_nop 3
s_cbranch_vccz KF_tg_ok
s_cmp_lg_u32 s68, 0
s_cbranch_scc1 KF_tg_again
s_branch KF_tg_ok
KF_f1_slow:
s_mov_b32 s68, 1048576
KF_f1_again:
s_sleep 4
buffer_load_dword v27, v143, s[20:23], s54 offen offset:0 sc1
s_waitcnt vmcnt(0)
v_cmp_ne_u32 vcc, s75, v27
s_sub_u32 s68, s68, 1
s_nop 3
s_cbranch_vccz KF_f1_ok
s_cmp_lg_u32 s68, 0
s_cbranch_scc1 KF_f1_again
s_branch KF_f1_ok
KF_ag_slow:
s_mov_b32 s68, 1048576
KF_ag_again:
s_sleep 4
buffer_load_dwordx4 v[192:195], v136, s[28:31], 0 offen sc1
buffer_load_dwordx4 v[196:199], v137, s[28:31], 0 offen sc1
buffer_load_dwordx4 v[200:203], v138, s[28:31], 0 offen sc1
buffer_load_dwordx4 v[204:207], v139, s[28:31], 0 offen sc1
buffer_load_dwordx4 v[208:211], v140, s[28:31], 0 offen sc1
buffer_load_dwordx4 v[212:215], v141, s[28:31], 0 offen sc1
buffer_load_dwordx4 v[216:219], v142, s[28:31], 0 offen sc1
s_waitcnt vmcnt(0)
v_mov_b32 v164, 0
s_cmp_gt_u32 s4, 6
s_cselect_b32 s69, -1, 0
v_xor_b32 v165, s75, v193
v_xor_b32 v166, s75, v195
v_or_b32_e64 v165, v165, v166
v_and_or_b32 v164, v165, s69, v164
s_cmp_gt_u32 s4, 5
s_cselect_b32 s69, -1, 0
v_xor_b32 v165, s75, v197
v_xor_b32 v166, s75, v199
v_or_b32_e64 v165, v165, v166
v_and_or_b32 v164, v165, s69, v164
s_cmp_gt_u32 s4, 4
s_cselect_b32 s69, -1, 0
v_xor_b32 v165, s75, v201
v_xor_b32 v166, s75, v203
v_or_b32_e64 v165, v165, v166
v_and_or_b32 v164, v165, s69, v164
s_cmp_gt_u32 s4, 3
s_cselect_b32 s69, -1, 0
v_xor_b32 v165, s75, v205
v_xor_b32 v166, s75, v207
v_or_b32_e64 v165, v165, v166
v_and_or_b32 v164, v165, s69, v164
s_cmp_gt_u32 s4, 2
s_cselect_b32 s69, -1, 0
v_xor_b32 v165, s75, v209
v_xor_b32 v166, s75, v211
v_or_b32_e64 v165, v165, v166
v_and_or_b32 v164, v165, s69, v164
s_cmp_gt_u32 s4, 1
s_cselect_b32 s69, -1, 0
v_xor_b32 v165, s75, v213
v_xor_b32 v166, s75, v215
v_or_b32_e64 v165, v165, v166
v_and_or_b32 v164, v165, s69, v164
s_cmp_gt_u32 s4, 0
s_cselect_b32 s69, -1, 0
v_xor_b32 v165, s75, v217
v_xor_b32 v166, s75, v219
v_or_b32_e64 v165, v165, v166
v_and_or_b32 v164, v165, s69, v164
v_cmp_ne_u32 vcc, 0, v164
s_sub_u32 s68, s68, 1
s_nop 3
s_cbranch_vccz KF_ag_ok
s_cmp_lg_u32 s68, 0
s_cbranch_scc1 KF_ag_again
s_branch KF_ag_ok
KF_f2_slow:
s_mov_b32 s68, 1048576
KF_f2_again:
s_sleep 4
buffer_load_dword v29, v27, s[20:23], s54 offen offset:128 sc1
s_waitcnt vmcnt(0)
v_cmp_ne_u32 vcc, s75, v29
s_sub_u32 s68, s68, 1
s_nop 3
s_cbranch_vccz KF_f2_ok
s_cmp_lg_u32 s68, 0
s_cbranch_scc1 KF_f2_again
s_branch KF_f2_ok
KF_g_slow:
s_mov_b32 s68, 1048576
KF_g_again:
s_sleep 4
s_lshl_b32 s69, s4, 11
s_add_u32 s69, s69, 23969792
buffer_load_dwordx2 a[128:129], v23, s[20:23], s69 offen offset:0 sc1
buffer_load_dwordx2 a[130:131], v23, s[20:23], s69 offen offset:128 sc1
buffer_load_dwordx2 a[132:133], v24, s[20:23], s69 offen offset:0 sc1
buffer_load_dwordx2 a[134:135], v24, s[20:23], s69 offen offset:128 sc1
buffer_load_dwordx2 a[136:137], v25, s[20:23], s69 offen offset:0 sc1
buffer_load_dwordx2 a[138:139], v25, s[20:23], s69 offen offset:128 sc1
buffer_load_dwordx2 a[140:141], v26, s[20:23], s69 offen offset:0 sc1
buffer_load_dwordx2 a[142:143], v26, s[20:23], s69 offen offset:128 sc1
s_waitcnt vmcnt(0)
v_mov_b32 v1, 0
v_accvgpr_read_b32 v30, a129
v_xor_b32 v30, s75, v30
v_or_b32 v1, v1, v30
v_accvgpr_read_b32 v30, a131
v_xor_b32 v30, s75, v30
v_or_b32 v1, v1, v30
v_accvgpr_read_b32 v30, a133
v_xor_b32 v30, s75, v30
v_or_b32 v1, v1, v30
v_accvgpr_read_b32 v30, a135
v_xor_b32 v30, s75, v30
v_or_b32 v1, v1, v30
v_accvgpr_read_b32 v30, a137
v_xor_b32 v30, s75, v30
v_or_b32 v1, v1, v30
v_accvgpr_read_b32 v30, a139
v_xor_b32 v30, s75, v30
v_or_b32 v1, v1, v30
v_accvgpr_read_b32 v30, a141
v_xor_b32 v30, s75, v30
v_or_b32 v1, v1, v30
v_accvgpr_read_b32 v30, a143
v_xor_b32 v30, s75, v30
v_or_b32 v1, v1, v30
v_cmp_ne_u32 vcc, 0, v1
s_sub_u32 s68, s68, 1
s_nop 3
s_cbranch_vccz KF_g_ok
s_cmp_lg_u32 s68, 0
s_cbranch_scc1 KF_g_again
s_branch KF_g_ok
KF_f3_slow:
s_mov_b32 s68, 1048576
KF_f3_again:
s_sleep 4
buffer_load_dword v28, v27, s[20:23], s54 offen offset:256 sc1
s_waitcnt vmcnt(0)
v_cmp_ne_u32 vcc, s75, v28
s_sub_u32 s68, s68, 1
s_nop 3
s_cbranch_vccz KF_f3_ok
s_cmp_lg_u32 s68, 0
s_cbranch_scc1 KF_f3_again
s_branch KF_f3_ok
KF_r2_slow:
s_mov_b32 s68, 1048576
KF_r2_again:
s_sleep 4
buffer_load_dwordx4 v[96:99], v10, s[20:23], s67 offen offset:0 sc1
buffer_load_dwordx4 v[100:103], v10, s[20:23], s67 offen offset:1024 sc1
buffer_load_dwordx4 v[104:107], v10, s[20:23], s67 offen offset:2048 sc1
buffer_load_dwordx4 v[108:111], v10, s[20:23], s67 offen offset:3072 sc1
s_waitcnt vmcnt(0)
v_max3_u32 v30, v96, v97, v98
v_max3_u32 v31, v99, v100, v101
v_max3_u32 v30, v30, v102, v103
v_max3_u32 v31, v31, v104, v105
v_max3_u32 v30, v30, v106, v107
v_max3_u32 v31, v31, v108, v109
v_max3_u32 v30, v30, v110, v111
v_max_u32 v30, v30, v31
v_cmp_eq_u32 vcc, -1, v30
s_sub_u32 s68, s68, 1
s_nop 3
s_cbranch_vccz KF_r2_ok
s_cmp_lg_u32 s68, 0
s_cbranch_scc1 KF_r2_again
s_branch KF_r2_ok
KF_r1_slow:
s_mov_b32 s68, 1048576
KF_r1_again:
s_sleep 4
buffer_load_dwordx4 v[80:83], v10, s[20:23], s66 offen offset:0 sc1
buffer_load_dwordx4 v[84:87], v10, s[20:23], s66 offen offset:1024 sc1
buffer_load_dwordx4 v[88:91], v10, s[20:23], s66 offen offset:2048 sc1
buffer_load_dwordx4 v[92:95], v10, s[20:23], s66 offen offset:3072 sc1
s_waitcnt vmcnt(0)
v_max3_u32 v30, v80, v81, v82
v_max3_u32 v31, v83, v84, v85
v_max3_u32 v30, v30, v86, v87
v_max3_u32 v31, v31, v88, v89
v_max3_u32 v30, v30, v90, v91
v_max3_u32 v31, v31, v92, v93
v_max3_u32 v30, v30, v94, v95
v_max_u32 v30, v30, v31
v_cmp_eq_u32 vcc, -1, v30
s_sub_u32 s68, s68, 1
s_nop 3
s_cbranch_vccz KF_r1_ok
s_cmp_lg_u32 s68, 0
s_cbranch_scc1 KF_r1_again
s_branch KF_r1_ok
KF_r0_slow:
s_mov_b32 s68, 1048576
KF_r0_again:
s_sleep 4
buffer_load_dwordx4 v[64:67], v10, s[20:23], s53 offen offset:0 sc1
buffer_load_dwordx4 v[68:71], v10, s[20:23], s53 offen offset:1024 sc1
buffer_load_dwordx4 v[72:75], v10, s[20:23], s53 offen offset:2048 sc1
buffer_load_dwordx4 v[76:79], v10, s[20:23], s53 offen offset:3072 sc1
s_waitcnt vmcnt(0)
v_max3_u32 v30, v64, v65, v66
v_max3_u32 v31, v67, v68, v69
v_max3_u32 v30, v30, v70, v71
v_max3_u32 v31, v31, v72, v73
v_max3_u32 v30, v30, v74, v75
v_max3_u32 v31, v31, v76, v77
v_max3_u32 v30, v30, v78, v79
v_max_u32 v30, v30, v31
v_cmp_eq_u32 vcc, -1, v30
s_sub_u32 s68, s68, 1
s_nop 3
s_cbranch_vccz KF_r0_ok
s_cmp_lg_u32 s68, 0
s_cbranch_scc1 KF_r0_again
KF_last:
s_branch KF_r0_ok
.section .rodata,"a"
.p2align 6
.amdhsa_kernel gated_mix__ssm_conv_s5__glu_gated_geglu__prompt_kernel
  .amdhsa_next_free_vgpr 512
  .amdhsa_next_free_sgpr 102
  .amdhsa_accum_offset 256
  .amdhsa_group_segment_fixed_size 0
  .amdhsa_kernarg_size 136
  .amdhsa_user_sgpr_count 2
  .amdhsa_user_sgpr_kernarg_segment_ptr 1
  .amdhsa_system_sgpr_workgroup_id_x 1
  .amdhsa_float_denorm_mode_32 3
.end_amdhsa_kernel
```
